```python
import torch

def _softmax(x, axis=-1):
    return torch.softmax(x, dim=axis)

def _gelu(x):
    return torch.nn.functional.gelu(x, approximate='tanh')

def _silu(x):
    return torch.nn.functional.silu(x)

def _sigmoid(x):
    return torch.sigmoid(x)

def _layernorm(x, axis=-1, eps=1e-05):
    m = x.mean(dim=axis, keepdim=True)
    v = x.var(dim=axis, keepdim=True, unbiased=False)
    return (x - m) / torch.sqrt(v + eps)

def _scatter_add(tgt, idx, src, axis=0):
    return tgt.clone().index_add_(axis, idx, src)

def _segment_sum(src, seg, n):
    out = torch.zeros((n,) + src.shape[1:], dtype=src.dtype)
    return out.index_add_(0, seg, src)

def _pad(x, pw):
    flat = tuple((v for pair in reversed(pw) for v in pair))
    return torch.nn.functional.pad(x, flat)
kernel_name = 'recurrent_scan__memory_aug_recurrent_mem_tr__dense_activation_mish__prompt'

def setup_inputs():

    _w = lambda a: (lambda t: t.to(torch.bfloat16) if t.is_floating_point() else t)(torch.as_tensor(a))

    def _A_setup():
        B, S, Dm = (1, 2048, 512)
        H, Dh = (32, 128)
        M, seg = (8, 32)
        seg = min(seg, S)
        S = S // seg * seg
        return {'x': _w((lambda *s: torch.randn(*s, dtype=torch.bfloat16) * 0.05)(B, S, Dm)), 'mem0': _w((lambda *s: torch.randn(*s, dtype=torch.bfloat16) * 0.8)(B, M, Dm)), 'Wq': _w((lambda *s: torch.randn(*s, dtype=torch.bfloat16) * 1.6)(Dm, H, Dh) * Dm ** (-0.5)), 'Wk': _w((lambda *s: torch.randn(*s, dtype=torch.bfloat16) * 1.6)(Dm, H, Dh) * Dm ** (-0.5)), 'Wv': _w((lambda *s: torch.randn(*s, dtype=torch.bfloat16) * 0.8)(Dm, H, Dh) * Dm ** (-0.5)), 'Wo': _w((lambda *s: torch.randn(*s, dtype=torch.bfloat16) * 0.8)(H, Dh, Dm) * (H * Dh) ** (-0.5)), 'seg_len': seg}
    _A_in = _A_setup()

    def _B_setup():
        B, S, D, F = (1, 2048, 512, 1792)
        return {'x': _w((lambda *s: torch.randn(*s, dtype=torch.bfloat16) * 0.05)(B, S, D)), 'w1': _w((lambda *s: torch.randn(*s, dtype=torch.bfloat16) * 0.8)(D, F) * D ** (-0.5)), 'b1': _w((lambda *s: torch.randn(*s, dtype=torch.bfloat16) * 0.2)(F)), 'w2': _w((lambda *s: torch.randn(*s, dtype=torch.bfloat16) * 0.2)(F, D) * F ** (-0.5))}
    _B_in = _B_setup()
    return {'A_x': _A_in['x'], 'A_mem0': _A_in['mem0'], 'A_Wq': _A_in['Wq'], 'A_Wk': _A_in['Wk'], 'A_Wv': _A_in['Wv'], 'A_Wo': _A_in['Wo'], 'A_seg_len': _A_in['seg_len'], 'B_x': _B_in['x'], 'B_w1': _B_in['w1'], 'B_b1': _B_in['b1'], 'B_w2': _B_in['w2']}

def reference(A_x, A_mem0, A_Wq, A_Wk, A_Wv, A_Wo, A_seg_len, B_x, B_w1, B_b1, B_w2):

    def _A_ref(x, mem0, Wq, Wk, Wv, Wo, seg_len):
        B, S, Dm = x.shape
        H, Dh = (Wq.shape[1], Wq.shape[2])
        M = mem0.shape[1]
        scale = Dh ** (-0.5)
        n_seg = S // seg_len
        L = M + seg_len
        idx = torch.arange(L)
        mask = (idx[:, None] < M) | (idx[:, None] >= idx[None, :])
        mem = mem0
        outs = []
        for s in range(n_seg):
            xs = x[:, s * seg_len:(s + 1) * seg_len, :].clone()
            h = torch.concatenate([mem, xs], axis=1)
            q = torch.einsum('btd,dhe->bhte', h, Wq)
            k = torch.einsum('btd,dhe->bhte', h, Wk)
            v = torch.einsum('btd,dhe->bhte', h, Wv)
            scores = torch.einsum('bhqe,bhke->bhqk', q, k) * scale
            scores = torch.where(mask[None, None], scores, -1000000000.0)
            p = _softmax(scores, axis=-1)
            o = torch.einsum('bhqk,bhke->bhqe', p, v)
            o = torch.einsum('bhte,hed->btd', o, Wo)
            mem = o[:, :M, :].clone()
            outs.append(o[:, M:, :])
        return torch.concatenate(outs, axis=1)

    def _B_ref(x, w1, b1, w2):
        h = torch.einsum('bsd,df->bsf', x, w1) + b1
        sp = torch.log1p(torch.exp(-torch.abs(h))) + torch.where(h > 0, h, torch.zeros_like(h))
        act = h * torch.tanh(sp)
        return torch.einsum('bsf,fd->bsd', act, w2)
    x = A_x
    xn = _layernorm(x, axis=-1)
    s = _A_ref(xn, A_mem0, A_Wq, A_Wk, A_Wv, A_Wo, A_seg_len)
    g = _silu(_B_ref(xn, B_w1, B_b1, B_w2))
    return x + s * g
```

```asm
; @launch grid=(256,1,1) block=(256,1,1) lds=163840
.amdgcn_target "amdgcn-amd-amdhsa--gfx950"
.text
.globl recurrent_scan__memory_aug_recurrent_mem_tr__dense_activation_mish__prompt_kernel
.p2align 8
.type recurrent_scan__memory_aug_recurrent_mem_tr__dense_activation_mish__prompt_kernel,@function
recurrent_scan__memory_aug_recurrent_mem_tr__dense_activation_mish__prompt_kernel:
    s_cmp_ge_u32 s2, 256
    s_cbranch_scc1 mg_exit
    s_and_b32 s5, s2, 7
    s_lshr_b32 s6, s2, 3
    s_cmp_eq_u32 s5, 0
    s_cbranch_scc1 mg_chain
    s_cmp_le_u32 s5, 2
    s_cbranch_scc1 mg_wo
    s_cmp_eq_u32 s5, 3
    s_cbranch_scc1 mg_f2
    s_sub_u32 s5, s5, 4
    s_cmp_lt_u32 s6, 24
    s_cbranch_scc0 mg_f1sel
    s_mul_i32 s5, s5, 24
    s_add_u32 s5, s5, s6
    s_branch mg_qkv
mg_f1sel:
    s_sub_u32 s6, s6, 24
    s_mul_i32 s5, s5, 8
    s_add_u32 s5, s5, s6
    s_cmp_lt_u32 s5, 14
    s_cbranch_scc1 mg_f1
    s_endpgm
mg_chain:
    s_mov_b32 s3, s6
    s_load_dwordx2 s[68:69], s[0:1], 96
    s_waitcnt lgkmcnt(0)
    s_mov_b32 s64, s68
    s_and_b32 s65, s69, 0xffff
    s_mov_b32 s66, 256
    s_mov_b32 s67, 0x20000
    s_load_dwordx8 s[16:23], s[0:1], 16
    s_load_dwordx2 s[24:25], s[0:1], 8
    s_load_dwordx2 s[26:27], s[0:1], 104
    v_lshrrev_b32 v24, 6, v0
    v_and_b32 v0, 63, v0
    v_readfirstlane_b32 s4, v24
    v_and_b32 v24, 15, v0
    v_lshrrev_b32 v25, 4, v0
    v_lshlrev_b32 v2, 4, v0
    v_and_b32 v26, 1, v0
    v_mul_u32_u24 v26, 0xaaaa, v26
    v_add_u32 v1, 0x4444, v26
    s_lshl_b32 s5, s4, 11
    v_add_u32 v4, s5, v2
    v_add_u32 v5, 147456, v4
    v_xor_b32 v6, 2048, v5
    v_xor_b32 v7, 4096, v5
    v_xor_b32 v8, 6144, v5
    s_lshl_b32 s5, s4, 4
    v_lshrrev_b32 v26, 2, v24
    v_add_u32 v26, s5, v26
    v_lshlrev_b32 v26, 12, v26
    s_lshl_b32 s5, s3, 7
    v_add_u32 v26, s5, v26
    v_and_b32 v27, 3, v24
    v_lshlrev_b32 v27, 5, v27
    v_add_u32 v26, v26, v27
    v_lshlrev_b32 v27, 3, v25
    v_add_u32 v9, v26, v27
    s_and_b32 s7, s4, 1
    s_lshl_b32 s6, s3, 1
    s_add_u32 s6, s6, s7
    s_lshl_b32 s5, s6, 12
    v_add_u32 v10, s5, v2
    s_lshr_b32 s5, s6, 3
    s_lshl_b32 s5, s5, 10
    s_bfe_u32 s7, s6, 0x20001
    s_lshl_b32 s7, s7, 8
    s_add_u32 s5, s5, s7
    s_and_b32 s7, s6, 1
    s_lshl_b32 s7, s7, 4
    s_add_u32 s5, s5, s7
    v_and_b32 v26, 1, v24
    v_lshlrev_b32 v26, 2, v26
    v_lshrrev_b32 v27, 3, v24
    v_lshl_add_u32 v26, v27, 1, v26
    v_and_b32 v27, 1, v25
    v_add_u32 v28, v26, v27
    v_lshlrev_b32 v26, 5, v28
    v_bfe_u32 v30, v24, 1, 2
    v_lshl_add_u32 v26, v30, 2, v26
    v_add_u32 v11, s5, v26
    v_and_b32 v26, 3, v24
    v_bfe_u32 v27, v24, 2, 1
    v_lshlrev_b32 v27, 4, v27
    v_mov_b32 v29, 0x3f80
    v_lshlrev_b32 v29, v27, v29
    v_cmp_eq_u32 vcc, 0, v26
    s_nop 1
    v_cndmask_b32 v12, 0, v29, vcc
    v_cmp_eq_u32 vcc, 1, v26
    s_nop 1
    v_cndmask_b32 v13, 0, v29, vcc
    v_cmp_eq_u32 vcc, 2, v26
    s_nop 1
    v_cndmask_b32 v14, 0, v29, vcc
    v_cmp_eq_u32 vcc, 3, v26
    s_nop 1
    v_cndmask_b32 v15, 0, v29, vcc
    v_mul_u32_u24 v26, 576, v25
    v_lshrrev_b32 v27, 2, v24
    v_lshlrev_b32 v27, 4, v27
    v_add_u32 v26, v26, v27
    v_and_b32 v27, 3, v24
    v_lshlrev_b32 v27, 1, v27
    v_add_u32 v26, v26, v27
    s_lshl_b32 s5, s4, 6
    s_add_u32 s5, s5, 155648
    v_add_u32 v16, s5, v26
    v_and_b32 v26, 7, v24
    v_mul_u32_u24 v26, 288, v26
    v_lshlrev_b32 v27, 4, v25
    v_add_u32 v26, v26, v27
    v_add_u32 v17, 155648, v26
    v_lshrrev_b32 v26, 2, v24
    v_lshlrev_b32 v26, 1, v26
    v_and_b32 v29, 1, v24
    v_add_u32 v29, v26, v29
    v_mul_u32_u24 v26, 288, v29
    v_add_u32 v26, v26, v27
    v_add_u32 v18, 157952, v26
    v_lshlrev_b32 v26, 8, v29
    v_add_u32 v26, v26, v27
    s_lshl_b32 s5, s4, 6
    v_add_u32 v21, s5, v26
    v_lshlrev_b32 v26, 3, v0
    s_lshl_b32 s5, s4, 9
    v_add_u32 v22, s5, v26
    v_and_b32 v26, 7, v24
    v_lshlrev_b32 v26, 4, v26
    v_lshrrev_b32 v27, 1, v25
    v_lshlrev_b32 v27, 7, v27
    v_add_u32 v26, v26, v27
    v_and_b32 v27, 1, v25
    v_lshlrev_b32 v27, 3, v27
    v_add_u32 v26, v26, v27
    s_lshl_b32 s5, s4, 9
    s_add_u32 s5, s5, 160256
    v_add_u32 v19, s5, v26
    s_lshl_b32 s5, s4, 15
    v_add_u32 v20, s5, v2
    s_waitcnt lgkmcnt(0)
    s_mov_b32 s8, s26
    s_and_b32 s9, s27, 0xffff
    s_mov_b32 s10, 268435456
    s_mov_b32 s11, 0x20000
    s_mov_b32 s12, s24
    s_and_b32 s13, s25, 0xffff
    s_mov_b32 s14, 8192
    s_mov_b32 s15, 0x20000
    s_cmp_ge_u32 s4, 2
    s_cbranch_scc1 ch_nopub0
    s_lshr_b32 s5, s6, 2
    s_lshl_b32 s5, s5, 5
    s_and_b32 s7, s6, 3
    s_lshl_b32 s7, s7, 2
    s_add_u32 s5, s5, s7
    s_lshl_b32 s5, s5, 1
    v_lshlrev_b32 v26, 10, v28
    v_lshl_add_u32 v26, v30, 1, v26
    v_add_u32 v26, s5, v26
    buffer_load_ushort v40, v26, s[12:15], 0 offen
    buffer_load_ushort v41, v26, s[12:15], 0 offen offset:32
ch_nopub0:
    v_lshrrev_b32 v26, 4, v0
    v_bfe_u32 v27, v0, 5, 1
    v_lshlrev_b32 v27, 1, v27
    v_and_b32 v28, 15, v0
    v_xor_b32 v27, v27, v28
    v_lshlrev_b32 v27, 4, v27
    v_lshlrev_b32 v26, 13, v26
    v_add_u32 v26, v26, v27
    s_lshl_b32 s5, s3, 8
    v_add_u32 v24, s5, v26
    v_xor_b32 v25, 64, v24
    v_xor_b32 v39, 128, v24
    v_xor_b32 v23, 192, v24
    v_bfe_u32 v28, v0, 2, 2
    v_and_b32 v29, 3, v0
    v_lshrrev_b32 v30, 4, v0
    v_and_b32 v31, 1, v28
    v_lshrrev_b32 v32, 1, v28
    v_and_b32 v33, 1, v30
    v_lshrrev_b32 v34, 1, v30
    v_lshlrev_b32 v35, 4, v31
    v_lshl_add_u32 v35, v34, 3, v35
    v_lshl_add_u32 v35, v32, 2, v35
    v_lshl_add_u32 v35, v33, 1, v35
    v_lshlrev_b32 v35, 8, v35
    v_lshlrev_b32 v36, 2, v31
    v_lshl_add_u32 v36, v32, 1, v36
    v_add_u32 v36, v36, v33
    v_lshlrev_b32 v36, 1, v36
    v_lshrrev_b32 v37, 1, v29
    s_lshl_b32 s5, s4, 2
    v_add_u32 v37, s5, v37
    v_xor_b32 v37, v37, v36
    v_lshlrev_b32 v37, 4, v37
    v_and_b32 v38, 1, v29
    v_lshl_add_u32 v37, v38, 3, v37
    v_add_u32 v35, v35, v37
    s_lshl_b32 s5, s4, 15
    v_add_u32 v26, s5, v35
    v_xor_b32 v27, 32, v26
    s_mov_b32 s12, s16
    s_and_b32 s13, s17, 0xffff
    s_mov_b32 s14, 4194304
    s_mov_b32 s15, 0x20000
    s_lshl_b32 s5, s4, 20
    s_lshl_b32 s6, s4, 15
    s_mov_b32 m0, s6
    s_nop 0
    buffer_load_dwordx4 v24, s[12:15], s5 offen lds
    s_add_u32 s5, s5, 32768
    s_add_u32 s6, s6, 1024
    s_mov_b32 m0, s6
    s_nop 0
    buffer_load_dwordx4 v25, s[12:15], s5 offen lds
    s_add_u32 s5, s5, 32768
    s_add_u32 s6, s6, 1024
    s_mov_b32 m0, s6
    s_nop 0
    buffer_load_dwordx4 v24, s[12:15], s5 offen lds
    s_add_u32 s5, s5, 32768
    s_add_u32 s6, s6, 1024
    s_mov_b32 m0, s6
    s_nop 0
    buffer_load_dwordx4 v25, s[12:15], s5 offen lds
    s_add_u32 s5, s5, 32768
    s_add_u32 s6, s6, 1024
    s_mov_b32 m0, s6
    s_nop 0
    buffer_load_dwordx4 v39, s[12:15], s5 offen lds
    s_add_u32 s5, s5, 32768
    s_add_u32 s6, s6, 1024
    s_mov_b32 m0, s6
    s_nop 0
    buffer_load_dwordx4 v23, s[12:15], s5 offen lds
    s_add_u32 s5, s5, 32768
    s_add_u32 s6, s6, 1024
    s_mov_b32 m0, s6
    s_nop 0
    buffer_load_dwordx4 v39, s[12:15], s5 offen lds
    s_add_u32 s5, s5, 32768
    s_add_u32 s6, s6, 1024
    s_mov_b32 m0, s6
    s_nop 0
    buffer_load_dwordx4 v23, s[12:15], s5 offen lds
    s_add_u32 s5, s5, 32768
    s_add_u32 s6, s6, 1024
    s_mov_b32 m0, s6
    s_nop 0
    buffer_load_dwordx4 v24, s[12:15], s5 offen lds
    s_add_u32 s5, s5, 32768
    s_add_u32 s6, s6, 1024
    s_mov_b32 m0, s6
    s_nop 0
    buffer_load_dwordx4 v25, s[12:15], s5 offen lds
    s_add_u32 s5, s5, 32768
    s_add_u32 s6, s6, 1024
    s_mov_b32 m0, s6
    s_nop 0
    buffer_load_dwordx4 v24, s[12:15], s5 offen lds
    s_add_u32 s5, s5, 32768
    s_add_u32 s6, s6, 1024
    s_mov_b32 m0, s6
    s_nop 0
    buffer_load_dwordx4 v25, s[12:15], s5 offen lds
    s_add_u32 s5, s5, 32768
    s_add_u32 s6, s6, 1024
    s_mov_b32 m0, s6
    s_nop 0
    buffer_load_dwordx4 v39, s[12:15], s5 offen lds
    s_add_u32 s5, s5, 32768
    s_add_u32 s6, s6, 1024
    s_mov_b32 m0, s6
    s_nop 0
    buffer_load_dwordx4 v23, s[12:15], s5 offen lds
    s_add_u32 s5, s5, 32768
    s_add_u32 s6, s6, 1024
    s_mov_b32 m0, s6
    s_nop 0
    buffer_load_dwordx4 v39, s[12:15], s5 offen lds
    s_add_u32 s5, s5, 32768
    s_add_u32 s6, s6, 1024
    s_mov_b32 m0, s6
    s_nop 0
    buffer_load_dwordx4 v23, s[12:15], s5 offen lds
    s_add_u32 s5, s5, 32768
    s_add_u32 s6, s6, 1024
    s_mov_b32 m0, s6
    s_nop 0
    buffer_load_dwordx4 v24, s[12:15], s5 offen lds
    s_add_u32 s5, s5, 32768
    s_add_u32 s6, s6, 1024
    s_mov_b32 m0, s6
    s_nop 0
    buffer_load_dwordx4 v25, s[12:15], s5 offen lds
    s_add_u32 s5, s5, 32768
    s_add_u32 s6, s6, 1024
    s_mov_b32 m0, s6
    s_nop 0
    buffer_load_dwordx4 v24, s[12:15], s5 offen lds
    s_add_u32 s5, s5, 32768
    s_add_u32 s6, s6, 1024
    s_mov_b32 m0, s6
    s_nop 0
    buffer_load_dwordx4 v25, s[12:15], s5 offen lds
    s_add_u32 s5, s5, 32768
    s_add_u32 s6, s6, 1024
    s_mov_b32 m0, s6
    s_nop 0
    buffer_load_dwordx4 v39, s[12:15], s5 offen lds
    s_add_u32 s5, s5, 32768
    s_add_u32 s6, s6, 1024
    s_mov_b32 m0, s6
    s_nop 0
    buffer_load_dwordx4 v23, s[12:15], s5 offen lds
    s_add_u32 s5, s5, 32768
    s_add_u32 s6, s6, 1024
    s_mov_b32 m0, s6
    s_nop 0
    buffer_load_dwordx4 v39, s[12:15], s5 offen lds
    s_add_u32 s5, s5, 32768
    s_add_u32 s6, s6, 1024
    s_mov_b32 m0, s6
    s_nop 0
    buffer_load_dwordx4 v23, s[12:15], s5 offen lds
    s_add_u32 s5, s5, 32768
    s_add_u32 s6, s6, 1024
    s_mov_b32 m0, s6
    s_nop 0
    buffer_load_dwordx4 v24, s[12:15], s5 offen lds
    s_add_u32 s5, s5, 32768
    s_add_u32 s6, s6, 1024
    s_mov_b32 m0, s6
    s_nop 0
    buffer_load_dwordx4 v25, s[12:15], s5 offen lds
    s_add_u32 s5, s5, 32768
    s_add_u32 s6, s6, 1024
    s_mov_b32 m0, s6
    s_nop 0
    buffer_load_dwordx4 v24, s[12:15], s5 offen lds
    s_add_u32 s5, s5, 32768
    s_add_u32 s6, s6, 1024
    s_mov_b32 m0, s6
    s_nop 0
    buffer_load_dwordx4 v25, s[12:15], s5 offen lds
    s_add_u32 s5, s5, 32768
    s_add_u32 s6, s6, 1024
    s_mov_b32 m0, s6
    s_nop 0
    buffer_load_dwordx4 v39, s[12:15], s5 offen lds
    s_add_u32 s5, s5, 32768
    s_add_u32 s6, s6, 1024
    s_mov_b32 m0, s6
    s_nop 0
    buffer_load_dwordx4 v23, s[12:15], s5 offen lds
    s_add_u32 s5, s5, 32768
    s_add_u32 s6, s6, 1024
    s_mov_b32 m0, s6
    s_nop 0
    buffer_load_dwordx4 v39, s[12:15], s5 offen lds
    s_add_u32 s5, s5, 32768
    s_add_u32 s6, s6, 1024
    s_mov_b32 m0, s6
    s_nop 0
    buffer_load_dwordx4 v23, s[12:15], s5 offen lds
    v_mov_b32 v44, -1
    v_mov_b32 v45, -1
    v_mov_b32 v46, -1
    v_mov_b32 v47, -1
    s_lshl_b32 s7, s3, 13
    s_add_u32 s7, s7, 131072
    buffer_store_dwordx4 v[44:47], v4, s[8:11], s7 offen sc1
    buffer_store_dwordx4 v[44:47], v4, s[8:11], s7 offen offset:1024 sc1
    s_add_u32 s7, s7, 0x40000
    buffer_store_dwordx4 v[44:47], v4, s[8:11], s7 offen sc1
    buffer_store_dwordx4 v[44:47], v4, s[8:11], s7 offen offset:1024 sc1
    s_add_u32 s7, s7, 0x40000
    buffer_store_dwordx4 v[44:47], v4, s[8:11], s7 offen sc1
    buffer_store_dwordx4 v[44:47], v4, s[8:11], s7 offen offset:1024 sc1
    s_mov_b32 s7, 73728
    buffer_store_dword v44, v11, s[8:11], s7 offen sc1
    s_mov_b32 s7, 81920
    buffer_store_dword v44, v11, s[8:11], s7 offen sc1
    s_mov_b32 s7, 90112
    buffer_store_dword v44, v11, s[8:11], s7 offen sc1
    s_lshl_b32 s7, s3, 4
    s_add_u32 s7, s7, 1024
    v_mov_b32 v48, 0
    buffer_store_dword v48, off, s[8:11], s7 sc1
    s_waitcnt vmcnt(0)
    s_cmp_ge_u32 s4, 2
    s_cbranch_scc1 ch_nopub1
    v_lshl_or_b32 v40, v41, 16, v40
    s_mov_b32 s7, 65536
    buffer_store_dword v40, v11, s[8:11], s7 offen sc1
ch_nopub1:
    s_barrier
    s_cmp_lg_u32 s4, 0
    s_cbranch_scc1 dba_1
    v_mov_b32 v46, 1
    s_mov_b64 exec, 1
    buffer_atomic_add v46, off, s[64:67], 0 offset:128 sc1
    s_mov_b64 exec, -1
dba_1:
    v_xor_b32 v28, 0, v26
    ds_read_b64_tr_b16 a[0:1], v28 offset:0
    ds_read_b64_tr_b16 a[2:3], v28 offset:256
    ds_read_b64_tr_b16 a[4:5], v28 offset:8192
    ds_read_b64_tr_b16 a[6:7], v28 offset:8448
    v_xor_b32 v28, 16384, v26
    ds_read_b64_tr_b16 a[8:9], v28 offset:0
    ds_read_b64_tr_b16 a[10:11], v28 offset:256
    ds_read_b64_tr_b16 a[12:13], v28 offset:8192
    ds_read_b64_tr_b16 a[14:15], v28 offset:8448
    s_waitcnt lgkmcnt(0)
    v_xor_b32 v28, 32768, v26
    ds_read_b64_tr_b16 a[16:17], v28 offset:0
    ds_read_b64_tr_b16 a[18:19], v28 offset:256
    ds_read_b64_tr_b16 a[20:21], v28 offset:8192
    ds_read_b64_tr_b16 a[22:23], v28 offset:8448
    v_xor_b32 v28, 49152, v26
    ds_read_b64_tr_b16 a[24:25], v28 offset:0
    ds_read_b64_tr_b16 a[26:27], v28 offset:256
    ds_read_b64_tr_b16 a[28:29], v28 offset:8192
    ds_read_b64_tr_b16 a[30:31], v28 offset:8448
    s_waitcnt lgkmcnt(0)
    v_xor_b32 v28, 65536, v26
    ds_read_b64_tr_b16 a[32:33], v28 offset:0
    ds_read_b64_tr_b16 a[34:35], v28 offset:256
    ds_read_b64_tr_b16 a[36:37], v28 offset:8192
    ds_read_b64_tr_b16 a[38:39], v28 offset:8448
    v_xor_b32 v28, 81920, v26
    ds_read_b64_tr_b16 a[40:41], v28 offset:0
    ds_read_b64_tr_b16 a[42:43], v28 offset:256
    ds_read_b64_tr_b16 a[44:45], v28 offset:8192
    ds_read_b64_tr_b16 a[46:47], v28 offset:8448
    s_waitcnt lgkmcnt(0)
    v_xor_b32 v28, 98304, v26
    ds_read_b64_tr_b16 a[48:49], v28 offset:0
    ds_read_b64_tr_b16 a[50:51], v28 offset:256
    ds_read_b64_tr_b16 a[52:53], v28 offset:8192
    ds_read_b64_tr_b16 a[54:55], v28 offset:8448
    v_xor_b32 v28, 114688, v26
    ds_read_b64_tr_b16 a[56:57], v28 offset:0
    ds_read_b64_tr_b16 a[58:59], v28 offset:256
    ds_read_b64_tr_b16 a[60:61], v28 offset:8192
    ds_read_b64_tr_b16 a[62:63], v28 offset:8448
    s_waitcnt lgkmcnt(0)
    v_xor_b32 v28, 0, v27
    ds_read_b64_tr_b16 a[64:65], v28 offset:0
    ds_read_b64_tr_b16 a[66:67], v28 offset:256
    ds_read_b64_tr_b16 a[68:69], v28 offset:8192
    ds_read_b64_tr_b16 a[70:71], v28 offset:8448
    v_xor_b32 v28, 16384, v27
    ds_read_b64_tr_b16 a[72:73], v28 offset:0
    ds_read_b64_tr_b16 a[74:75], v28 offset:256
    ds_read_b64_tr_b16 a[76:77], v28 offset:8192
    ds_read_b64_tr_b16 a[78:79], v28 offset:8448
    s_waitcnt lgkmcnt(0)
    v_xor_b32 v28, 32768, v27
    ds_read_b64_tr_b16 a[80:81], v28 offset:0
    ds_read_b64_tr_b16 a[82:83], v28 offset:256
    ds_read_b64_tr_b16 a[84:85], v28 offset:8192
    ds_read_b64_tr_b16 a[86:87], v28 offset:8448
    v_xor_b32 v28, 49152, v27
    ds_read_b64_tr_b16 a[88:89], v28 offset:0
    ds_read_b64_tr_b16 a[90:91], v28 offset:256
    ds_read_b64_tr_b16 a[92:93], v28 offset:8192
    ds_read_b64_tr_b16 a[94:95], v28 offset:8448
    s_waitcnt lgkmcnt(0)
    v_xor_b32 v28, 65536, v27
    ds_read_b64_tr_b16 a[96:97], v28 offset:0
    ds_read_b64_tr_b16 a[98:99], v28 offset:256
    ds_read_b64_tr_b16 a[100:101], v28 offset:8192
    ds_read_b64_tr_b16 a[102:103], v28 offset:8448
    v_xor_b32 v28, 81920, v27
    ds_read_b64_tr_b16 a[104:105], v28 offset:0
    ds_read_b64_tr_b16 a[106:107], v28 offset:256
    ds_read_b64_tr_b16 a[108:109], v28 offset:8192
    ds_read_b64_tr_b16 a[110:111], v28 offset:8448
    s_waitcnt lgkmcnt(0)
    v_xor_b32 v28, 98304, v27
    ds_read_b64_tr_b16 a[112:113], v28 offset:0
    ds_read_b64_tr_b16 a[114:115], v28 offset:256
    ds_read_b64_tr_b16 a[116:117], v28 offset:8192
    ds_read_b64_tr_b16 a[118:119], v28 offset:8448
    v_xor_b32 v28, 114688, v27
    ds_read_b64_tr_b16 a[120:121], v28 offset:0
    ds_read_b64_tr_b16 a[122:123], v28 offset:256
    ds_read_b64_tr_b16 a[124:125], v28 offset:8192
    ds_read_b64_tr_b16 a[126:127], v28 offset:8448
    s_waitcnt lgkmcnt(0)
    s_waitcnt lgkmcnt(0)
    s_barrier
    s_mov_b32 s12, s18
    s_and_b32 s13, s19, 0xffff
    s_mov_b32 s14, 4194304
    s_mov_b32 s15, 0x20000
    s_lshl_b32 s5, s4, 20
    s_lshl_b32 s6, s4, 15
    s_mov_b32 m0, s6
    s_nop 0
    buffer_load_dwordx4 v24, s[12:15], s5 offen lds
    s_add_u32 s5, s5, 32768
    s_add_u32 s6, s6, 1024
    s_mov_b32 m0, s6
    s_nop 0
    buffer_load_dwordx4 v25, s[12:15], s5 offen lds
    s_add_u32 s5, s5, 32768
    s_add_u32 s6, s6, 1024
    s_mov_b32 m0, s6
    s_nop 0
    buffer_load_dwordx4 v24, s[12:15], s5 offen lds
    s_add_u32 s5, s5, 32768
    s_add_u32 s6, s6, 1024
    s_mov_b32 m0, s6
    s_nop 0
    buffer_load_dwordx4 v25, s[12:15], s5 offen lds
    s_add_u32 s5, s5, 32768
    s_add_u32 s6, s6, 1024
    s_mov_b32 m0, s6
    s_nop 0
    buffer_load_dwordx4 v39, s[12:15], s5 offen lds
    s_add_u32 s5, s5, 32768
    s_add_u32 s6, s6, 1024
    s_mov_b32 m0, s6
    s_nop 0
    buffer_load_dwordx4 v23, s[12:15], s5 offen lds
    s_add_u32 s5, s5, 32768
    s_add_u32 s6, s6, 1024
    s_mov_b32 m0, s6
    s_nop 0
    buffer_load_dwordx4 v39, s[12:15], s5 offen lds
    s_add_u32 s5, s5, 32768
    s_add_u32 s6, s6, 1024
    s_mov_b32 m0, s6
    s_nop 0
    buffer_load_dwordx4 v23, s[12:15], s5 offen lds
    s_add_u32 s5, s5, 32768
    s_add_u32 s6, s6, 1024
    s_mov_b32 m0, s6
    s_nop 0
    buffer_load_dwordx4 v24, s[12:15], s5 offen lds
    s_add_u32 s5, s5, 32768
    s_add_u32 s6, s6, 1024
    s_mov_b32 m0, s6
    s_nop 0
    buffer_load_dwordx4 v25, s[12:15], s5 offen lds
    s_add_u32 s5, s5, 32768
    s_add_u32 s6, s6, 1024
    s_mov_b32 m0, s6
    s_nop 0
    buffer_load_dwordx4 v24, s[12:15], s5 offen lds
    s_add_u32 s5, s5, 32768
    s_add_u32 s6, s6, 1024
    s_mov_b32 m0, s6
    s_nop 0
    buffer_load_dwordx4 v25, s[12:15], s5 offen lds
    s_add_u32 s5, s5, 32768
    s_add_u32 s6, s6, 1024
    s_mov_b32 m0, s6
    s_nop 0
    buffer_load_dwordx4 v39, s[12:15], s5 offen lds
    s_add_u32 s5, s5, 32768
    s_add_u32 s6, s6, 1024
    s_mov_b32 m0, s6
    s_nop 0
    buffer_load_dwordx4 v23, s[12:15], s5 offen lds
    s_add_u32 s5, s5, 32768
    s_add_u32 s6, s6, 1024
    s_mov_b32 m0, s6
    s_nop 0
    buffer_load_dwordx4 v39, s[12:15], s5 offen lds
    s_add_u32 s5, s5, 32768
    s_add_u32 s6, s6, 1024
    s_mov_b32 m0, s6
    s_nop 0
    buffer_load_dwordx4 v23, s[12:15], s5 offen lds
    s_add_u32 s5, s5, 32768
    s_add_u32 s6, s6, 1024
    s_mov_b32 m0, s6
    s_nop 0
    buffer_load_dwordx4 v24, s[12:15], s5 offen lds
    s_add_u32 s5, s5, 32768
    s_add_u32 s6, s6, 1024
    s_mov_b32 m0, s6
    s_nop 0
    buffer_load_dwordx4 v25, s[12:15], s5 offen lds
    s_add_u32 s5, s5, 32768
    s_add_u32 s6, s6, 1024
    s_mov_b32 m0, s6
    s_nop 0
    buffer_load_dwordx4 v24, s[12:15], s5 offen lds
    s_add_u32 s5, s5, 32768
    s_add_u32 s6, s6, 1024
    s_mov_b32 m0, s6
    s_nop 0
    buffer_load_dwordx4 v25, s[12:15], s5 offen lds
    s_add_u32 s5, s5, 32768
    s_add_u32 s6, s6, 1024
    s_mov_b32 m0, s6
    s_nop 0
    buffer_load_dwordx4 v39, s[12:15], s5 offen lds
    s_add_u32 s5, s5, 32768
    s_add_u32 s6, s6, 1024
    s_mov_b32 m0, s6
    s_nop 0
    buffer_load_dwordx4 v23, s[12:15], s5 offen lds
    s_add_u32 s5, s5, 32768
    s_add_u32 s6, s6, 1024
    s_mov_b32 m0, s6
    s_nop 0
    buffer_load_dwordx4 v39, s[12:15], s5 offen lds
    s_add_u32 s5, s5, 32768
    s_add_u32 s6, s6, 1024
    s_mov_b32 m0, s6
    s_nop 0
    buffer_load_dwordx4 v23, s[12:15], s5 offen lds
    s_add_u32 s5, s5, 32768
    s_add_u32 s6, s6, 1024
    s_mov_b32 m0, s6
    s_nop 0
    buffer_load_dwordx4 v24, s[12:15], s5 offen lds
    s_add_u32 s5, s5, 32768
    s_add_u32 s6, s6, 1024
    s_mov_b32 m0, s6
    s_nop 0
    buffer_load_dwordx4 v25, s[12:15], s5 offen lds
    s_add_u32 s5, s5, 32768
    s_add_u32 s6, s6, 1024
    s_mov_b32 m0, s6
    s_nop 0
    buffer_load_dwordx4 v24, s[12:15], s5 offen lds
    s_add_u32 s5, s5, 32768
    s_add_u32 s6, s6, 1024
    s_mov_b32 m0, s6
    s_nop 0
    buffer_load_dwordx4 v25, s[12:15], s5 offen lds
    s_add_u32 s5, s5, 32768
    s_add_u32 s6, s6, 1024
    s_mov_b32 m0, s6
    s_nop 0
    buffer_load_dwordx4 v39, s[12:15], s5 offen lds
    s_add_u32 s5, s5, 32768
    s_add_u32 s6, s6, 1024
    s_mov_b32 m0, s6
    s_nop 0
    buffer_load_dwordx4 v23, s[12:15], s5 offen lds
    s_add_u32 s5, s5, 32768
    s_add_u32 s6, s6, 1024
    s_mov_b32 m0, s6
    s_nop 0
    buffer_load_dwordx4 v39, s[12:15], s5 offen lds
    s_add_u32 s5, s5, 32768
    s_add_u32 s6, s6, 1024
    s_mov_b32 m0, s6
    s_nop 0
    buffer_load_dwordx4 v23, s[12:15], s5 offen lds
    s_waitcnt vmcnt(0)
    s_barrier
    s_cmp_lg_u32 s4, 0
    s_cbranch_scc1 ch_ann
    s_getreg_b32 s70, hwreg(HW_REG_XCC_ID, 0, 4)
    s_mul_i32 s70, s70, 6
    s_lshl_b64 s[70:71], 1, s70
    s_add_u32 s71, s71, 0x10000
    v_mov_b32 v44, s70
    v_mov_b32 v45, s71
    s_mov_b64 exec, 1
    buffer_atomic_add_x2 v[44:45], off, s[64:67], 0 sc1
    s_mov_b64 exec, -1
ch_ann:
    v_xor_b32 v28, 0, v26
    ds_read_b64_tr_b16 a[128:129], v28 offset:0
    ds_read_b64_tr_b16 a[130:131], v28 offset:256
    ds_read_b64_tr_b16 a[132:133], v28 offset:8192
    ds_read_b64_tr_b16 a[134:135], v28 offset:8448
    v_xor_b32 v28, 16384, v26
    ds_read_b64_tr_b16 a[136:137], v28 offset:0
    ds_read_b64_tr_b16 a[138:139], v28 offset:256
    ds_read_b64_tr_b16 a[140:141], v28 offset:8192
    ds_read_b64_tr_b16 a[142:143], v28 offset:8448
    s_waitcnt lgkmcnt(0)
    v_xor_b32 v28, 32768, v26
    ds_read_b64_tr_b16 a[144:145], v28 offset:0
    ds_read_b64_tr_b16 a[146:147], v28 offset:256
    ds_read_b64_tr_b16 a[148:149], v28 offset:8192
    ds_read_b64_tr_b16 a[150:151], v28 offset:8448
    v_xor_b32 v28, 49152, v26
    ds_read_b64_tr_b16 a[152:153], v28 offset:0
    ds_read_b64_tr_b16 a[154:155], v28 offset:256
    ds_read_b64_tr_b16 a[156:157], v28 offset:8192
    ds_read_b64_tr_b16 a[158:159], v28 offset:8448
    s_waitcnt lgkmcnt(0)
    v_xor_b32 v28, 65536, v26
    ds_read_b64_tr_b16 a[160:161], v28 offset:0
    ds_read_b64_tr_b16 a[162:163], v28 offset:256
    ds_read_b64_tr_b16 a[164:165], v28 offset:8192
    ds_read_b64_tr_b16 a[166:167], v28 offset:8448
    v_xor_b32 v28, 81920, v26
    ds_read_b64_tr_b16 a[168:169], v28 offset:0
    ds_read_b64_tr_b16 a[170:171], v28 offset:256
    ds_read_b64_tr_b16 a[172:173], v28 offset:8192
    ds_read_b64_tr_b16 a[174:175], v28 offset:8448
    s_waitcnt lgkmcnt(0)
    v_xor_b32 v28, 98304, v26
    ds_read_b64_tr_b16 a[176:177], v28 offset:0
    ds_read_b64_tr_b16 a[178:179], v28 offset:256
    ds_read_b64_tr_b16 a[180:181], v28 offset:8192
    ds_read_b64_tr_b16 a[182:183], v28 offset:8448
    v_xor_b32 v28, 114688, v26
    ds_read_b64_tr_b16 a[184:185], v28 offset:0
    ds_read_b64_tr_b16 a[186:187], v28 offset:256
    ds_read_b64_tr_b16 a[188:189], v28 offset:8192
    ds_read_b64_tr_b16 a[190:191], v28 offset:8448
    s_waitcnt lgkmcnt(0)
    v_xor_b32 v28, 0, v27
    ds_read_b64_tr_b16 a[192:193], v28 offset:0
    ds_read_b64_tr_b16 a[194:195], v28 offset:256
    ds_read_b64_tr_b16 a[196:197], v28 offset:8192
    ds_read_b64_tr_b16 a[198:199], v28 offset:8448
    v_xor_b32 v28, 16384, v27
    ds_read_b64_tr_b16 a[200:201], v28 offset:0
    ds_read_b64_tr_b16 a[202:203], v28 offset:256
    ds_read_b64_tr_b16 a[204:205], v28 offset:8192
    ds_read_b64_tr_b16 a[206:207], v28 offset:8448
    s_waitcnt lgkmcnt(0)
    v_xor_b32 v28, 32768, v27
    ds_read_b64_tr_b16 a[208:209], v28 offset:0
    ds_read_b64_tr_b16 a[210:211], v28 offset:256
    ds_read_b64_tr_b16 a[212:213], v28 offset:8192
    ds_read_b64_tr_b16 a[214:215], v28 offset:8448
    v_xor_b32 v28, 49152, v27
    ds_read_b64_tr_b16 a[216:217], v28 offset:0
    ds_read_b64_tr_b16 a[218:219], v28 offset:256
    ds_read_b64_tr_b16 a[220:221], v28 offset:8192
    ds_read_b64_tr_b16 a[222:223], v28 offset:8448
    s_waitcnt lgkmcnt(0)
    v_xor_b32 v28, 65536, v27
    ds_read_b64_tr_b16 a[224:225], v28 offset:0
    ds_read_b64_tr_b16 a[226:227], v28 offset:256
    ds_read_b64_tr_b16 a[228:229], v28 offset:8192
    ds_read_b64_tr_b16 a[230:231], v28 offset:8448
    v_xor_b32 v28, 81920, v27
    ds_read_b64_tr_b16 a[232:233], v28 offset:0
    ds_read_b64_tr_b16 a[234:235], v28 offset:256
    ds_read_b64_tr_b16 a[236:237], v28 offset:8192
    ds_read_b64_tr_b16 a[238:239], v28 offset:8448
    s_waitcnt lgkmcnt(0)
    v_xor_b32 v28, 98304, v27
    ds_read_b64_tr_b16 a[240:241], v28 offset:0
    ds_read_b64_tr_b16 a[242:243], v28 offset:256
    ds_read_b64_tr_b16 a[244:245], v28 offset:8192
    ds_read_b64_tr_b16 a[246:247], v28 offset:8448
    v_xor_b32 v28, 114688, v27
    ds_read_b64_tr_b16 a[248:249], v28 offset:0
    ds_read_b64_tr_b16 a[250:251], v28 offset:256
    ds_read_b64_tr_b16 a[252:253], v28 offset:8192
    ds_read_b64_tr_b16 a[254:255], v28 offset:8448
    s_waitcnt lgkmcnt(0)
    s_waitcnt lgkmcnt(0)
    s_barrier
    s_mov_b32 s12, s20
    s_and_b32 s13, s21, 0xffff
    s_mov_b32 s14, 4194304
    s_mov_b32 s15, 0x20000
    s_lshl_b32 s5, s4, 20
    s_lshl_b32 s6, s4, 15
    s_mov_b32 m0, s6
    s_nop 0
    buffer_load_dwordx4 v24, s[12:15], s5 offen lds
    s_add_u32 s5, s5, 32768
    s_add_u32 s6, s6, 1024
    s_mov_b32 m0, s6
    s_nop 0
    buffer_load_dwordx4 v25, s[12:15], s5 offen lds
    s_add_u32 s5, s5, 32768
    s_add_u32 s6, s6, 1024
    s_mov_b32 m0, s6
    s_nop 0
    buffer_load_dwordx4 v24, s[12:15], s5 offen lds
    s_add_u32 s5, s5, 32768
    s_add_u32 s6, s6, 1024
    s_mov_b32 m0, s6
    s_nop 0
    buffer_load_dwordx4 v25, s[12:15], s5 offen lds
    s_add_u32 s5, s5, 32768
    s_add_u32 s6, s6, 1024
    s_mov_b32 m0, s6
    s_nop 0
    buffer_load_dwordx4 v39, s[12:15], s5 offen lds
    s_add_u32 s5, s5, 32768
    s_add_u32 s6, s6, 1024
    s_mov_b32 m0, s6
    s_nop 0
    buffer_load_dwordx4 v23, s[12:15], s5 offen lds
    s_add_u32 s5, s5, 32768
    s_add_u32 s6, s6, 1024
    s_mov_b32 m0, s6
    s_nop 0
    buffer_load_dwordx4 v39, s[12:15], s5 offen lds
    s_add_u32 s5, s5, 32768
    s_add_u32 s6, s6, 1024
    s_mov_b32 m0, s6
    s_nop 0
    buffer_load_dwordx4 v23, s[12:15], s5 offen lds
    s_add_u32 s5, s5, 32768
    s_add_u32 s6, s6, 1024
    s_mov_b32 m0, s6
    s_nop 0
    buffer_load_dwordx4 v24, s[12:15], s5 offen lds
    s_add_u32 s5, s5, 32768
    s_add_u32 s6, s6, 1024
    s_mov_b32 m0, s6
    s_nop 0
    buffer_load_dwordx4 v25, s[12:15], s5 offen lds
    s_add_u32 s5, s5, 32768
    s_add_u32 s6, s6, 1024
    s_mov_b32 m0, s6
    s_nop 0
    buffer_load_dwordx4 v24, s[12:15], s5 offen lds
    s_add_u32 s5, s5, 32768
    s_add_u32 s6, s6, 1024
    s_mov_b32 m0, s6
    s_nop 0
    buffer_load_dwordx4 v25, s[12:15], s5 offen lds
    s_add_u32 s5, s5, 32768
    s_add_u32 s6, s6, 1024
    s_mov_b32 m0, s6
    s_nop 0
    buffer_load_dwordx4 v39, s[12:15], s5 offen lds
    s_add_u32 s5, s5, 32768
    s_add_u32 s6, s6, 1024
    s_mov_b32 m0, s6
    s_nop 0
    buffer_load_dwordx4 v23, s[12:15], s5 offen lds
    s_add_u32 s5, s5, 32768
    s_add_u32 s6, s6, 1024
    s_mov_b32 m0, s6
    s_nop 0
    buffer_load_dwordx4 v39, s[12:15], s5 offen lds
    s_add_u32 s5, s5, 32768
    s_add_u32 s6, s6, 1024
    s_mov_b32 m0, s6
    s_nop 0
    buffer_load_dwordx4 v23, s[12:15], s5 offen lds
    s_add_u32 s5, s5, 32768
    s_add_u32 s6, s6, 1024
    s_mov_b32 m0, s6
    s_nop 0
    buffer_load_dwordx4 v24, s[12:15], s5 offen lds
    s_add_u32 s5, s5, 32768
    s_add_u32 s6, s6, 1024
    s_mov_b32 m0, s6
    s_nop 0
    buffer_load_dwordx4 v25, s[12:15], s5 offen lds
    s_add_u32 s5, s5, 32768
    s_add_u32 s6, s6, 1024
    s_mov_b32 m0, s6
    s_nop 0
    buffer_load_dwordx4 v24, s[12:15], s5 offen lds
    s_add_u32 s5, s5, 32768
    s_add_u32 s6, s6, 1024
    s_mov_b32 m0, s6
    s_nop 0
    buffer_load_dwordx4 v25, s[12:15], s5 offen lds
    s_add_u32 s5, s5, 32768
    s_add_u32 s6, s6, 1024
    s_mov_b32 m0, s6
    s_nop 0
    buffer_load_dwordx4 v39, s[12:15], s5 offen lds
    s_add_u32 s5, s5, 32768
    s_add_u32 s6, s6, 1024
    s_mov_b32 m0, s6
    s_nop 0
    buffer_load_dwordx4 v23, s[12:15], s5 offen lds
    s_add_u32 s5, s5, 32768
    s_add_u32 s6, s6, 1024
    s_mov_b32 m0, s6
    s_nop 0
    buffer_load_dwordx4 v39, s[12:15], s5 offen lds
    s_add_u32 s5, s5, 32768
    s_add_u32 s6, s6, 1024
    s_mov_b32 m0, s6
    s_nop 0
    buffer_load_dwordx4 v23, s[12:15], s5 offen lds
    s_add_u32 s5, s5, 32768
    s_add_u32 s6, s6, 1024
    s_mov_b32 m0, s6
    s_nop 0
    buffer_load_dwordx4 v24, s[12:15], s5 offen lds
    s_add_u32 s5, s5, 32768
    s_add_u32 s6, s6, 1024
    s_mov_b32 m0, s6
    s_nop 0
    buffer_load_dwordx4 v25, s[12:15], s5 offen lds
    s_add_u32 s5, s5, 32768
    s_add_u32 s6, s6, 1024
    s_mov_b32 m0, s6
    s_nop 0
    buffer_load_dwordx4 v24, s[12:15], s5 offen lds
    s_add_u32 s5, s5, 32768
    s_add_u32 s6, s6, 1024
    s_mov_b32 m0, s6
    s_nop 0
    buffer_load_dwordx4 v25, s[12:15], s5 offen lds
    s_add_u32 s5, s5, 32768
    s_add_u32 s6, s6, 1024
    s_mov_b32 m0, s6
    s_nop 0
    buffer_load_dwordx4 v39, s[12:15], s5 offen lds
    s_add_u32 s5, s5, 32768
    s_add_u32 s6, s6, 1024
    s_mov_b32 m0, s6
    s_nop 0
    buffer_load_dwordx4 v23, s[12:15], s5 offen lds
    s_add_u32 s5, s5, 32768
    s_add_u32 s6, s6, 1024
    s_mov_b32 m0, s6
    s_nop 0
    buffer_load_dwordx4 v39, s[12:15], s5 offen lds
    s_add_u32 s5, s5, 32768
    s_add_u32 s6, s6, 1024
    s_mov_b32 m0, s6
    s_nop 0
    buffer_load_dwordx4 v23, s[12:15], s5 offen lds
    s_waitcnt vmcnt(0)
    s_barrier
    v_xor_b32 v28, 0, v26
    ds_read_b64_tr_b16 v[128:129], v28 offset:0
    ds_read_b64_tr_b16 v[130:131], v28 offset:256
    ds_read_b64_tr_b16 v[132:133], v28 offset:8192
    ds_read_b64_tr_b16 v[134:135], v28 offset:8448
    v_xor_b32 v28, 16384, v26
    ds_read_b64_tr_b16 v[136:137], v28 offset:0
    ds_read_b64_tr_b16 v[138:139], v28 offset:256
    ds_read_b64_tr_b16 v[140:141], v28 offset:8192
    ds_read_b64_tr_b16 v[142:143], v28 offset:8448
    s_waitcnt lgkmcnt(0)
    v_xor_b32 v28, 32768, v26
    ds_read_b64_tr_b16 v[144:145], v28 offset:0
    ds_read_b64_tr_b16 v[146:147], v28 offset:256
    ds_read_b64_tr_b16 v[148:149], v28 offset:8192
    ds_read_b64_tr_b16 v[150:151], v28 offset:8448
    v_xor_b32 v28, 49152, v26
    ds_read_b64_tr_b16 v[152:153], v28 offset:0
    ds_read_b64_tr_b16 v[154:155], v28 offset:256
    ds_read_b64_tr_b16 v[156:157], v28 offset:8192
    ds_read_b64_tr_b16 v[158:159], v28 offset:8448
    s_waitcnt lgkmcnt(0)
    v_xor_b32 v28, 65536, v26
    ds_read_b64_tr_b16 v[160:161], v28 offset:0
    ds_read_b64_tr_b16 v[162:163], v28 offset:256
    ds_read_b64_tr_b16 v[164:165], v28 offset:8192
    ds_read_b64_tr_b16 v[166:167], v28 offset:8448
    v_xor_b32 v28, 81920, v26
    ds_read_b64_tr_b16 v[168:169], v28 offset:0
    ds_read_b64_tr_b16 v[170:171], v28 offset:256
    ds_read_b64_tr_b16 v[172:173], v28 offset:8192
    ds_read_b64_tr_b16 v[174:175], v28 offset:8448
    s_waitcnt lgkmcnt(0)
    v_xor_b32 v28, 98304, v26
    ds_read_b64_tr_b16 v[176:177], v28 offset:0
    ds_read_b64_tr_b16 v[178:179], v28 offset:256
    ds_read_b64_tr_b16 v[180:181], v28 offset:8192
    ds_read_b64_tr_b16 v[182:183], v28 offset:8448
    v_xor_b32 v28, 114688, v26
    ds_read_b64_tr_b16 v[184:185], v28 offset:0
    ds_read_b64_tr_b16 v[186:187], v28 offset:256
    ds_read_b64_tr_b16 v[188:189], v28 offset:8192
    ds_read_b64_tr_b16 v[190:191], v28 offset:8448
    s_waitcnt lgkmcnt(0)
    v_xor_b32 v28, 0, v27
    ds_read_b64_tr_b16 v[192:193], v28 offset:0
    ds_read_b64_tr_b16 v[194:195], v28 offset:256
    ds_read_b64_tr_b16 v[196:197], v28 offset:8192
    ds_read_b64_tr_b16 v[198:199], v28 offset:8448
    v_xor_b32 v28, 16384, v27
    ds_read_b64_tr_b16 v[200:201], v28 offset:0
    ds_read_b64_tr_b16 v[202:203], v28 offset:256
    ds_read_b64_tr_b16 v[204:205], v28 offset:8192
    ds_read_b64_tr_b16 v[206:207], v28 offset:8448
    s_waitcnt lgkmcnt(0)
    v_xor_b32 v28, 32768, v27
    ds_read_b64_tr_b16 v[208:209], v28 offset:0
    ds_read_b64_tr_b16 v[210:211], v28 offset:256
    ds_read_b64_tr_b16 v[212:213], v28 offset:8192
    ds_read_b64_tr_b16 v[214:215], v28 offset:8448
    v_xor_b32 v28, 49152, v27
    ds_read_b64_tr_b16 v[216:217], v28 offset:0
    ds_read_b64_tr_b16 v[218:219], v28 offset:256
    ds_read_b64_tr_b16 v[220:221], v28 offset:8192
    ds_read_b64_tr_b16 v[222:223], v28 offset:8448
    s_waitcnt lgkmcnt(0)
    v_xor_b32 v28, 65536, v27
    ds_read_b64_tr_b16 v[224:225], v28 offset:0
    ds_read_b64_tr_b16 v[226:227], v28 offset:256
    ds_read_b64_tr_b16 v[228:229], v28 offset:8192
    ds_read_b64_tr_b16 v[230:231], v28 offset:8448
    v_xor_b32 v28, 81920, v27
    ds_read_b64_tr_b16 v[232:233], v28 offset:0
    ds_read_b64_tr_b16 v[234:235], v28 offset:256
    ds_read_b64_tr_b16 v[236:237], v28 offset:8192
    ds_read_b64_tr_b16 v[238:239], v28 offset:8448
    s_waitcnt lgkmcnt(0)
    v_xor_b32 v28, 98304, v27
    ds_read_b64_tr_b16 v[240:241], v28 offset:0
    ds_read_b64_tr_b16 v[242:243], v28 offset:256
    ds_read_b64_tr_b16 v[244:245], v28 offset:8192
    ds_read_b64_tr_b16 v[246:247], v28 offset:8448
    v_xor_b32 v28, 114688, v27
    ds_read_b64_tr_b16 v[248:249], v28 offset:0
    ds_read_b64_tr_b16 v[250:251], v28 offset:256
    ds_read_b64_tr_b16 v[252:253], v28 offset:8192
    ds_read_b64_tr_b16 v[254:255], v28 offset:8448
    s_waitcnt lgkmcnt(0)
    s_waitcnt lgkmcnt(0)
    s_barrier
    s_mov_b32 s12, s22
    s_and_b32 s13, s23, 0xffff
    s_mov_b32 s14, 4194304
    s_mov_b32 s15, 0x20000
    v_lshrrev_b32 v26, 4, v0
    v_and_b32 v27, 1, v26
    v_lshlrev_b32 v27, 2, v27
    v_and_b32 v28, 15, v0
    v_xor_b32 v27, v27, v28
    v_lshlrev_b32 v27, 4, v27
    v_lshlrev_b32 v26, 10, v26
    v_add_u32 v26, v26, v27
    s_lshl_b32 s5, s4, 8
    v_add_u32 v24, s5, v26
    v_xor_b32 v25, 128, v24
    s_lshl_b32 s5, s3, 17
    s_lshl_b32 s6, s4, 15
    s_mov_b32 m0, s6
    s_nop 0
    buffer_load_dwordx4 v24, s[12:15], s5 offen lds
    s_add_u32 s5, s5, 4096
    s_add_u32 s6, s6, 1024
    s_mov_b32 m0, s6
    s_nop 0
    buffer_load_dwordx4 v25, s[12:15], s5 offen lds
    s_add_u32 s5, s5, 4096
    s_add_u32 s6, s6, 1024
    s_mov_b32 m0, s6
    s_nop 0
    buffer_load_dwordx4 v24, s[12:15], s5 offen lds
    s_add_u32 s5, s5, 4096
    s_add_u32 s6, s6, 1024
    s_mov_b32 m0, s6
    s_nop 0
    buffer_load_dwordx4 v25, s[12:15], s5 offen lds
    s_add_u32 s5, s5, 4096
    s_add_u32 s6, s6, 1024
    s_mov_b32 m0, s6
    s_nop 0
    buffer_load_dwordx4 v24, s[12:15], s5 offen lds
    s_add_u32 s5, s5, 4096
    s_add_u32 s6, s6, 1024
    s_mov_b32 m0, s6
    s_nop 0
    buffer_load_dwordx4 v25, s[12:15], s5 offen lds
    s_add_u32 s5, s5, 4096
    s_add_u32 s6, s6, 1024
    s_mov_b32 m0, s6
    s_nop 0
    buffer_load_dwordx4 v24, s[12:15], s5 offen lds
    s_add_u32 s5, s5, 4096
    s_add_u32 s6, s6, 1024
    s_mov_b32 m0, s6
    s_nop 0
    buffer_load_dwordx4 v25, s[12:15], s5 offen lds
    s_add_u32 s5, s5, 4096
    s_add_u32 s6, s6, 1024
    s_mov_b32 m0, s6
    s_nop 0
    buffer_load_dwordx4 v24, s[12:15], s5 offen lds
    s_add_u32 s5, s5, 4096
    s_add_u32 s6, s6, 1024
    s_mov_b32 m0, s6
    s_nop 0
    buffer_load_dwordx4 v25, s[12:15], s5 offen lds
    s_add_u32 s5, s5, 4096
    s_add_u32 s6, s6, 1024
    s_mov_b32 m0, s6
    s_nop 0
    buffer_load_dwordx4 v24, s[12:15], s5 offen lds
    s_add_u32 s5, s5, 4096
    s_add_u32 s6, s6, 1024
    s_mov_b32 m0, s6
    s_nop 0
    buffer_load_dwordx4 v25, s[12:15], s5 offen lds
    s_add_u32 s5, s5, 4096
    s_add_u32 s6, s6, 1024
    s_mov_b32 m0, s6
    s_nop 0
    buffer_load_dwordx4 v24, s[12:15], s5 offen lds
    s_add_u32 s5, s5, 4096
    s_add_u32 s6, s6, 1024
    s_mov_b32 m0, s6
    s_nop 0
    buffer_load_dwordx4 v25, s[12:15], s5 offen lds
    s_add_u32 s5, s5, 4096
    s_add_u32 s6, s6, 1024
    s_mov_b32 m0, s6
    s_nop 0
    buffer_load_dwordx4 v24, s[12:15], s5 offen lds
    s_add_u32 s5, s5, 4096
    s_add_u32 s6, s6, 1024
    s_mov_b32 m0, s6
    s_nop 0
    buffer_load_dwordx4 v25, s[12:15], s5 offen lds
    s_add_u32 s5, s5, 4096
    s_add_u32 s6, s6, 1024
    s_mov_b32 m0, s6
    s_nop 0
    buffer_load_dwordx4 v24, s[12:15], s5 offen lds
    s_add_u32 s5, s5, 4096
    s_add_u32 s6, s6, 1024
    s_mov_b32 m0, s6
    s_nop 0
    buffer_load_dwordx4 v25, s[12:15], s5 offen lds
    s_add_u32 s5, s5, 4096
    s_add_u32 s6, s6, 1024
    s_mov_b32 m0, s6
    s_nop 0
    buffer_load_dwordx4 v24, s[12:15], s5 offen lds
    s_add_u32 s5, s5, 4096
    s_add_u32 s6, s6, 1024
    s_mov_b32 m0, s6
    s_nop 0
    buffer_load_dwordx4 v25, s[12:15], s5 offen lds
    s_add_u32 s5, s5, 4096
    s_add_u32 s6, s6, 1024
    s_mov_b32 m0, s6
    s_nop 0
    buffer_load_dwordx4 v24, s[12:15], s5 offen lds
    s_add_u32 s5, s5, 4096
    s_add_u32 s6, s6, 1024
    s_mov_b32 m0, s6
    s_nop 0
    buffer_load_dwordx4 v25, s[12:15], s5 offen lds
    s_add_u32 s5, s5, 4096
    s_add_u32 s6, s6, 1024
    s_mov_b32 m0, s6
    s_nop 0
    buffer_load_dwordx4 v24, s[12:15], s5 offen lds
    s_add_u32 s5, s5, 4096
    s_add_u32 s6, s6, 1024
    s_mov_b32 m0, s6
    s_nop 0
    buffer_load_dwordx4 v25, s[12:15], s5 offen lds
    s_add_u32 s5, s5, 4096
    s_add_u32 s6, s6, 1024
    s_mov_b32 m0, s6
    s_nop 0
    buffer_load_dwordx4 v24, s[12:15], s5 offen lds
    s_add_u32 s5, s5, 4096
    s_add_u32 s6, s6, 1024
    s_mov_b32 m0, s6
    s_nop 0
    buffer_load_dwordx4 v25, s[12:15], s5 offen lds
    s_add_u32 s5, s5, 4096
    s_add_u32 s6, s6, 1024
    s_mov_b32 m0, s6
    s_nop 0
    buffer_load_dwordx4 v24, s[12:15], s5 offen lds
    s_add_u32 s5, s5, 4096
    s_add_u32 s6, s6, 1024
    s_mov_b32 m0, s6
    s_nop 0
    buffer_load_dwordx4 v25, s[12:15], s5 offen lds
    s_add_u32 s5, s5, 4096
    s_add_u32 s6, s6, 1024
    s_mov_b32 m0, s6
    s_nop 0
    buffer_load_dwordx4 v24, s[12:15], s5 offen lds
    s_add_u32 s5, s5, 4096
    s_add_u32 s6, s6, 1024
    s_mov_b32 m0, s6
    s_nop 0
    buffer_load_dwordx4 v25, s[12:15], s5 offen lds
    s_add_u32 s5, s5, 4096
    s_add_u32 s6, s6, 1024
    s_mov_b32 m0, s6
    s_nop 0
    buffer_load_dwordx4 v24, s[12:15], s5 offen lds
    s_add_u32 s5, s5, 4096
    s_add_u32 s6, s6, 1024
    s_mov_b32 m0, s6
    s_nop 0
    buffer_load_dwordx4 v25, s[12:15], s5 offen lds
    v_lshlrev_b32 v35, 3, v34
    v_lshl_add_u32 v35, v33, 2, v35
    v_add_u32 v35, v35, v31
    v_lshlrev_b32 v35, 8, v35
    v_lshlrev_b32 v36, 2, v31
    v_lshl_add_u32 v36, v33, 3, v36
    v_lshrrev_b32 v37, 1, v29
    v_lshl_add_u32 v37, v32, 1, v37
    v_xor_b32 v37, v37, v36
    v_lshlrev_b32 v37, 4, v37
    v_lshl_add_u32 v37, v38, 3, v37
    v_add_u32 v35, v35, v37
    s_lshl_b32 s5, s4, 15
    v_add_u32 v28, s5, v35
    buffer_load_dwordx2 v[112:113], off, s[64:67], 0 sc1
    buffer_load_dword v114, off, s[64:67], 0 offset:128 sc1
    s_waitcnt vmcnt(0)
    v_xor_b32 v29, 0, v28
    ds_read_b64_tr_b16 v[48:49], v29 offset:0
    ds_read_b64_tr_b16 v[50:51], v29 offset:512
    ds_read_b64_tr_b16 v[52:53], v29 offset:4096
    ds_read_b64_tr_b16 v[54:55], v29 offset:4608
    ds_read_b64_tr_b16 v[56:57], v29 offset:8192
    ds_read_b64_tr_b16 v[58:59], v29 offset:8704
    ds_read_b64_tr_b16 v[60:61], v29 offset:12288
    ds_read_b64_tr_b16 v[62:63], v29 offset:12800
    s_waitcnt lgkmcnt(0)
    v_xor_b32 v29, 64, v28
    ds_read_b64_tr_b16 v[64:65], v29 offset:0
    ds_read_b64_tr_b16 v[66:67], v29 offset:512
    ds_read_b64_tr_b16 v[68:69], v29 offset:4096
    ds_read_b64_tr_b16 v[70:71], v29 offset:4608
    ds_read_b64_tr_b16 v[72:73], v29 offset:8192
    ds_read_b64_tr_b16 v[74:75], v29 offset:8704
    ds_read_b64_tr_b16 v[76:77], v29 offset:12288
    ds_read_b64_tr_b16 v[78:79], v29 offset:12800
    s_waitcnt lgkmcnt(0)
    v_xor_b32 v29, 128, v28
    ds_read_b64_tr_b16 v[80:81], v29 offset:0
    ds_read_b64_tr_b16 v[82:83], v29 offset:512
    ds_read_b64_tr_b16 v[84:85], v29 offset:4096
    ds_read_b64_tr_b16 v[86:87], v29 offset:4608
    ds_read_b64_tr_b16 v[88:89], v29 offset:8192
    ds_read_b64_tr_b16 v[90:91], v29 offset:8704
    ds_read_b64_tr_b16 v[92:93], v29 offset:12288
    ds_read_b64_tr_b16 v[94:95], v29 offset:12800
    s_waitcnt lgkmcnt(0)
    v_xor_b32 v29, 192, v28
    ds_read_b64_tr_b16 v[96:97], v29 offset:0
    ds_read_b64_tr_b16 v[98:99], v29 offset:512
    ds_read_b64_tr_b16 v[100:101], v29 offset:4096
    ds_read_b64_tr_b16 v[102:103], v29 offset:4608
    ds_read_b64_tr_b16 v[104:105], v29 offset:8192
    ds_read_b64_tr_b16 v[106:107], v29 offset:8704
    ds_read_b64_tr_b16 v[108:109], v29 offset:12288
    ds_read_b64_tr_b16 v[110:111], v29 offset:12800
    s_waitcnt lgkmcnt(0)
    ds_write_b128 v20, v[48:51] offset:0
    ds_write_b128 v20, v[52:55] offset:1024
    ds_write_b128 v20, v[56:59] offset:2048
    ds_write_b128 v20, v[60:63] offset:3072
    ds_write_b128 v20, v[64:67] offset:4096
    ds_write_b128 v20, v[68:71] offset:5120
    ds_write_b128 v20, v[72:75] offset:6144
    ds_write_b128 v20, v[76:79] offset:7168
    ds_write_b128 v20, v[80:83] offset:8192
    ds_write_b128 v20, v[84:87] offset:9216
    ds_write_b128 v20, v[88:91] offset:10240
    ds_write_b128 v20, v[92:95] offset:11264
    ds_write_b128 v20, v[96:99] offset:12288
    ds_write_b128 v20, v[100:103] offset:13312
    ds_write_b128 v20, v[104:107] offset:14336
    ds_write_b128 v20, v[108:111] offset:15360
    s_waitcnt lgkmcnt(0)
    v_xor_b32 v29, 0, v28
    ds_read_b64_tr_b16 v[48:49], v29 offset:16384
    ds_read_b64_tr_b16 v[50:51], v29 offset:16896
    ds_read_b64_tr_b16 v[52:53], v29 offset:20480
    ds_read_b64_tr_b16 v[54:55], v29 offset:20992
    ds_read_b64_tr_b16 v[56:57], v29 offset:24576
    ds_read_b64_tr_b16 v[58:59], v29 offset:25088
    ds_read_b64_tr_b16 v[60:61], v29 offset:28672
    ds_read_b64_tr_b16 v[62:63], v29 offset:29184
    s_waitcnt lgkmcnt(0)
    v_xor_b32 v29, 64, v28
    ds_read_b64_tr_b16 v[64:65], v29 offset:16384
    ds_read_b64_tr_b16 v[66:67], v29 offset:16896
    ds_read_b64_tr_b16 v[68:69], v29 offset:20480
    ds_read_b64_tr_b16 v[70:71], v29 offset:20992
    ds_read_b64_tr_b16 v[72:73], v29 offset:24576
    ds_read_b64_tr_b16 v[74:75], v29 offset:25088
    ds_read_b64_tr_b16 v[76:77], v29 offset:28672
    ds_read_b64_tr_b16 v[78:79], v29 offset:29184
    s_waitcnt lgkmcnt(0)
    v_xor_b32 v29, 128, v28
    ds_read_b64_tr_b16 v[80:81], v29 offset:16384
    ds_read_b64_tr_b16 v[82:83], v29 offset:16896
    ds_read_b64_tr_b16 v[84:85], v29 offset:20480
    ds_read_b64_tr_b16 v[86:87], v29 offset:20992
    ds_read_b64_tr_b16 v[88:89], v29 offset:24576
    ds_read_b64_tr_b16 v[90:91], v29 offset:25088
    ds_read_b64_tr_b16 v[92:93], v29 offset:28672
    ds_read_b64_tr_b16 v[94:95], v29 offset:29184
    s_waitcnt lgkmcnt(0)
    v_xor_b32 v29, 192, v28
    ds_read_b64_tr_b16 v[96:97], v29 offset:16384
    ds_read_b64_tr_b16 v[98:99], v29 offset:16896
    ds_read_b64_tr_b16 v[100:101], v29 offset:20480
    ds_read_b64_tr_b16 v[102:103], v29 offset:20992
    ds_read_b64_tr_b16 v[104:105], v29 offset:24576
    ds_read_b64_tr_b16 v[106:107], v29 offset:25088
    ds_read_b64_tr_b16 v[108:109], v29 offset:28672
    ds_read_b64_tr_b16 v[110:111], v29 offset:29184
    s_waitcnt lgkmcnt(0)
    ds_write_b128 v20, v[48:51] offset:16384
    ds_write_b128 v20, v[52:55] offset:17408
    ds_write_b128 v20, v[56:59] offset:18432
    ds_write_b128 v20, v[60:63] offset:19456
    ds_write_b128 v20, v[64:67] offset:20480
    ds_write_b128 v20, v[68:71] offset:21504
    ds_write_b128 v20, v[72:75] offset:22528
    ds_write_b128 v20, v[76:79] offset:23552
    ds_write_b128 v20, v[80:83] offset:24576
    ds_write_b128 v20, v[84:87] offset:25600
    ds_write_b128 v20, v[88:91] offset:26624
    ds_write_b128 v20, v[92:95] offset:27648
    ds_write_b128 v20, v[96:99] offset:28672
    ds_write_b128 v20, v[100:103] offset:29696
    ds_write_b128 v20, v[104:107] offset:30720
    ds_write_b128 v20, v[108:111] offset:31744
    s_waitcnt lgkmcnt(0)
    s_barrier
    v_and_b32 v24, 0x3e0, v2
    v_lshrrev_b32 v24, 1, v24
    v_add_u32 v0, 160256, v24
    s_mov_b32 s72, 0
ch_xd:
    v_readfirstlane_b32 s70, v112
    v_readfirstlane_b32 s71, v113
    s_nop 0
    s_lshr_b32 s5, s71, 16
    s_cmp_ge_u32 s5, 32
    s_cbranch_scc1 ch_xd_all
    s_add_u32 s72, s72, 1
    s_cmp_gt_u32 s72, 0x20000
    s_cbranch_scc1 mg_chain_slow
    s_sleep 4
    buffer_load_dwordx2 v[112:113], off, s[64:67], 0 sc1
    s_waitcnt vmcnt(0)
    s_branch ch_xd
ch_xd_all:
    s_getreg_b32 s5, hwreg(HW_REG_XCC_ID, 0, 4)
    s_mul_i32 s5, s5, 6
    s_lshr_b64 s[70:71], s[70:71], s5
    s_and_b32 s5, s70, 63
    s_cmp_lg_u32 s5, 32
    s_cbranch_scc1 mg_chain_slow
    s_mov_b32 s32, 0x3e0293ee
    s_mov_b32 s41, 0x3f803f80
    s_mov_b32 s37, 0
    s_mov_b32 s20, 0
    s_mov_b32 s21, 65536
    s_mov_b32 s22, 73728
    s_mov_b32 s23, 90112
    s_mov_b32 s24, 131072
    s_mov_b32 s25, 163840
    s_mov_b32 s43, 147456
    s_mov_b32 s19, 180224
    s_lshl_b32 s5, s3, 13
    s_add_u32 s18, s5, 655360
    s_lshl_b32 s5, s3, 11
    s_add_u32 s29, s5, 5242880
    s_add_u32 s30, s5, 9437184
    s_lshl_b32 s5, s3, 19
    s_add_u32 s27, s5, 33554432
    s_lshl_b32 s5, s3, 4
    s_add_u32 s42, s5, 1024
    s_lshl_b32 s5, s4, 11
    s_add_u32 s28, s5, 131072
    s_mov_b32 s61, 131072
    v_lshlrev_b32 v56, 3, v2
    s_lshl_b32 s5, s3, 13
    s_add_u32 s5, s5, 131072
    s_cmp_eq_u32 s4, 3
    s_cbranch_scc1 ch_pfm
    s_lshl_b32 s6, s4, 18
    s_add_u32 s5, s5, s6
    buffer_load_dword v57, v56, s[8:11], s5 offen sc1
    s_branch ch_pfd
ch_pfm:
    s_mov_b32 s5, 65536
    buffer_load_dword v57, v56, s[8:11], s5 offen sc1
    s_add_u32 s5, s5, 8192
    buffer_load_dword v58, v56, s[8:11], s5 offen sc1
    s_add_u32 s5, s5, 8192
    buffer_load_dword v59, v56, s[8:11], s5 offen sc1
    s_add_u32 s5, s5, 8192
    buffer_load_dword v60, v56, s[8:11], s5 offen sc1
ch_pfd:
    s_mov_b32 s72, 0
ch_fr:
    v_readfirstlane_b32 s5, v114
    s_nop 0
    s_cmp_ge_u32 s5, 174
    s_cbranch_scc1 ch_fr_ok
    s_add_u32 s72, s72, 1
    s_cmp_gt_u32 s72, 0x20000
    s_cbranch_scc1 ch_fr_ok
    s_sleep 4
    buffer_load_dword v114, off, s[64:67], 0 offset:128 sc1
    s_waitcnt vmcnt(0)
    s_branch ch_fr
ch_fr_ok:
    s_lshl_b32 s5, s3, 4
    s_add_u32 s38, s5, 0
    s_mov_b32 s39, 1
    v_mov_b32 v3, 0
    s_nop 0
    v_readfirstlane_b32 s5, v3
    s_nop 0
    s_cmp_ge_u32 s5, s39
    s_cbranch_scc1 ch_f0_2_ok
    s_mov_b32 s33, 0
ch_f0_2:
    v_mov_b32 v3, 0
    buffer_load_dword v3, v3, s[8:11], s38 offen sc1
    s_add_u32 s33, s33, 1
    s_cmp_gt_u32 s33, 0x8000
    s_cbranch_scc1 ch_f0_2_fail
    s_waitcnt vmcnt(0)
    v_readfirstlane_b32 s5, v3
    s_nop 0
    s_cmp_ge_u32 s5, s39
    s_cbranch_scc0 ch_f0_2
    s_branch ch_f0_2_ok
ch_f0_2_fail:
    s_add_u32 s37, s37, 1
    s_waitcnt vmcnt(0)
ch_f0_2_ok:
    s_mov_b32 m0, s28
    s_nop 0
    buffer_load_dwordx4 v4, s[8:11], s27 offen sc1 lds
    buffer_load_dwordx4 v4, s[8:11], s27 offen offset:1024 sc1 lds
    s_add_u32 s38, s38, 4
    v_mov_b32 v3, 0
    buffer_load_dword v3, v3, s[8:11], s38 offen sc1
    s_mov_b32 s16, 2
    s_mov_b32 s17, 1
    s_lshl_b32 s5, s3, 4
    s_lshl_b32 s31, s16, 2
    s_add_u32 s31, s31, s5
    s_add_u32 s31, s31, 0
    s_add_u32 s5, s20, 2
    s_cmp_ge_u32 s5, 64
    s_cselect_b32 s26, 0, s17
    s_add_u32 s16, s16, 1
    s_cmp_eq_u32 s16, 3
    s_cselect_b32 s16, 0, s16
    s_addc_u32 s17, s17, 0
    s_add_u32 s34, s27, 16777216
    s_add_u32 s27, s27, 8192
    s_xor_b32 s28, s28, 8192
    v_mov_b32 v24, 0
    v_mov_b32 v25, 0
    v_mov_b32 v26, 0
    v_mov_b32 v27, 0
    v_mov_b32 v28, 0
    v_mov_b32 v29, 0
    v_mov_b32 v30, 0
    v_mov_b32 v31, 0
    v_mov_b32 v32, 0
    v_mov_b32 v33, 0
    v_mov_b32 v34, 0
    v_mov_b32 v35, 0
    v_mov_b32 v36, 0
    v_mov_b32 v37, 0
    v_mov_b32 v38, 0
    v_mov_b32 v39, 0
    v_mov_b32 v40, 0
    v_mov_b32 v41, 0
    v_mov_b32 v42, 0
    v_mov_b32 v43, 0
    v_mov_b32 v44, 0
    v_mov_b32 v45, 0
    v_mov_b32 v46, 0
    v_mov_b32 v47, 0
    v_mov_b32 v116, -1
    v_mov_b32 v117, -1
    v_mov_b32 v118, -1
    v_mov_b32 v119, -1
    s_waitcnt vmcnt(0)
    s_barrier
    s_mov_b32 s33, 0
    buffer_load_dwordx4 v[48:51], v4, s[8:11], s21 offen sc1
    buffer_load_dwordx4 v[52:55], v4, s[8:11], s21 offen offset:1024 sc1
    v_add_u32 v23, s61, v2
    ds_read_b128 v[80:83], v23 offset:0
    ds_read_b128 v[84:87], v23 offset:1024
    ds_read_b128 v[88:91], v23 offset:2048
    ds_read_b128 v[92:95], v23 offset:3072
    ds_read_b128 v[96:99], v23 offset:4096
    ds_read_b128 v[100:103], v23 offset:5120
    ds_read_b128 v[104:107], v23 offset:6144
    ds_read_b128 v[108:111], v23 offset:7168
    buffer_load_dwordx4 v[120:123], v4, s[8:11], s21 offen sc1
    buffer_load_dwordx4 v[124:127], v4, s[8:11], s21 offen offset:1024 sc1
ch_step:
    s_waitcnt vmcnt(2)
ch_step2:
    v_max3_u32 v23, v48, v49, v50
    v_max3_u32 v56, v51, v52, v53
    v_max3_u32 v23, v23, v54, v55
    v_max_u32 v23, v23, v56
    v_cmp_eq_u32 vcc, -1, v23
    s_cbranch_vccnz ch_pm_retry
ch_pm_ok:
    ds_write_b128 v5, v[48:51]
    v_smfmac_f32_16x16x64_bf16 v[24:27], v[48:51], a[0:7], v1
    ds_write_b128 v5, v[52:55] offset:1024
    buffer_load_dwordx4 v[120:123], v4, s[8:11], s34 offen sc1
    v_smfmac_f32_16x16x64_bf16 v[28:31], v[48:51], a[64:71], v1
    v_readfirstlane_b32 s5, v3
    v_smfmac_f32_16x16x64_bf16 v[32:35], v[48:51], a[128:135], v1
    buffer_load_dwordx4 v[124:127], v4, s[8:11], s34 offen offset:1024 sc1
    s_cmp_ge_u32 s5, s39
    v_smfmac_f32_16x16x64_bf16 v[36:39], v[48:51], a[192:199], v1
    s_cbranch_scc0 ch_fs_slow
ch_fs_ok:
    v_smfmac_f32_16x16x64_bf16 v[40:43], v[48:51], v[128:135], v1
    s_waitcnt lgkmcnt(0)
    s_barrier
    ds_read_b128 v[56:59], v6 offset:0
    v_smfmac_f32_16x16x64_bf16 v[44:47], v[48:51], v[192:199], v1
    ds_read_b128 v[60:63], v6 offset:1024
    v_smfmac_f32_16x16x64_bf16 v[24:27], v[52:55], a[8:15], v1
    ds_read_b128 v[64:67], v7 offset:0
    v_smfmac_f32_16x16x64_bf16 v[28:31], v[52:55], a[72:79], v1
    ds_read_b128 v[68:71], v7 offset:1024
    v_smfmac_f32_16x16x64_bf16 v[32:35], v[52:55], a[136:143], v1
    ds_read_b128 v[72:75], v8 offset:0
    v_smfmac_f32_16x16x64_bf16 v[36:39], v[52:55], a[200:207], v1
    ds_read_b128 v[76:79], v8 offset:1024
    v_smfmac_f32_16x16x64_bf16 v[40:43], v[52:55], v[136:143], v1
    v_smfmac_f32_16x16x64_bf16 v[44:47], v[52:55], v[200:207], v1
    v_mov_b32 v23, s20
    s_waitcnt lgkmcnt(5)
    v_smfmac_f32_16x16x64_bf16 v[24:27], v[56:59], a[16:23], v1
    v_smfmac_f32_16x16x64_bf16 v[28:31], v[56:59], a[80:87], v1
    buffer_store_dword v23, off, s[8:11], s42 sc1
    s_waitcnt lgkmcnt(4)
    v_smfmac_f32_16x16x64_bf16 v[24:27], v[60:63], a[24:31], v1
    v_smfmac_f32_16x16x64_bf16 v[28:31], v[60:63], a[88:95], v1
    buffer_store_dwordx4 v[116:119], v4, s[8:11], s18 offen
    s_waitcnt lgkmcnt(3)
    v_smfmac_f32_16x16x64_bf16 v[24:27], v[64:67], a[32:39], v1
    v_smfmac_f32_16x16x64_bf16 v[28:31], v[64:67], a[96:103], v1
    s_waitcnt lgkmcnt(2)
    v_smfmac_f32_16x16x64_bf16 v[24:27], v[68:71], a[40:47], v1
    v_smfmac_f32_16x16x64_bf16 v[28:31], v[68:71], a[104:111], v1
    buffer_store_dwordx4 v[116:119], v4, s[8:11], s18 offen offset:1024
    s_waitcnt lgkmcnt(1)
    v_smfmac_f32_16x16x64_bf16 v[24:27], v[72:75], a[48:55], v1
    v_smfmac_f32_16x16x64_bf16 v[28:31], v[72:75], a[112:119], v1
    s_waitcnt lgkmcnt(0)
    v_smfmac_f32_16x16x64_bf16 v[24:27], v[76:79], a[56:63], v1
    v_smfmac_f32_16x16x64_bf16 v[28:31], v[76:79], a[120:127], v1
    v_smfmac_f32_16x16x64_bf16 v[32:35], v[56:59], a[144:151], v1
    v_smfmac_f32_16x16x64_bf16 v[36:39], v[56:59], a[208:215], v1
    v_add_f32 v24, v24, v25
    v_add_f32 v26, v26, v27
    v_smfmac_f32_16x16x64_bf16 v[32:35], v[60:63], a[152:159], v1
    v_add_f32 v28, v28, v29
    v_add_f32 v30, v30, v31
    v_smfmac_f32_16x16x64_bf16 v[36:39], v[60:63], a[216:223], v1
    v_cvt_pk_bf16_f32 v24, v24, v26
    v_cvt_pk_bf16_f32 v28, v28, v30
    v_smfmac_f32_16x16x64_bf16 v[32:35], v[64:67], a[160:167], v1
    ds_write_b16 v16, v24
    ds_write_b16_d16_hi v16, v24 offset:288
    v_smfmac_f32_16x16x64_bf16 v[36:39], v[64:67], a[224:231], v1
    ds_write_b16 v16, v28 offset:8
    ds_write_b16_d16_hi v16, v28 offset:296
    v_smfmac_f32_16x16x64_bf16 v[32:35], v[68:71], a[168:175], v1
    s_mov_b32 m0, s28
    s_nop 0
    buffer_load_dwordx4 v4, s[8:11], s27 offen sc1 lds
    v_smfmac_f32_16x16x64_bf16 v[36:39], v[68:71], a[232:239], v1
    buffer_load_dwordx4 v4, s[8:11], s27 offen offset:1024 sc1 lds
    v_smfmac_f32_16x16x64_bf16 v[32:35], v[72:75], a[176:183], v1
    buffer_load_dword v3, off, s[8:11], s31 sc1
    v_smfmac_f32_16x16x64_bf16 v[36:39], v[72:75], a[240:247], v1
    s_waitcnt vmcnt(8) lgkmcnt(0)
    s_barrier
    ds_read_b128 v[48:51], v17 offset:0
    ds_read_b128 v[52:55], v17 offset:64
    v_smfmac_f32_16x16x64_bf16 v[32:35], v[76:79], a[184:191], v1
    ds_read_b128 v[112:115], v17 offset:128
    ds_read_b128 v[116:119], v17 offset:192
    v_smfmac_f32_16x16x64_bf16 v[36:39], v[76:79], a[248:255], v1
    v_smfmac_f32_16x16x64_bf16 v[40:43], v[56:59], v[144:151], v1
    v_smfmac_f32_16x16x64_bf16 v[44:47], v[56:59], v[208:215], v1
    v_add_f32 v32, v32, v33
    v_add_f32 v34, v34, v35
    v_smfmac_f32_16x16x64_bf16 v[40:43], v[60:63], v[152:159], v1
    v_add_f32 v36, v36, v37
    v_add_f32 v38, v38, v39
    v_smfmac_f32_16x16x64_bf16 v[44:47], v[60:63], v[216:223], v1
    v_cvt_pk_bf16_f32 v32, v32, v34
    v_cvt_pk_bf16_f32 v36, v36, v38
    ds_write_b16 v16, v32 offset:2304
    ds_write_b16_d16_hi v16, v32 offset:2592
    v_smfmac_f32_16x16x64_bf16 v[40:43], v[64:67], v[160:167], v1
    ds_write_b16 v16, v36 offset:2312
    ds_write_b16_d16_hi v16, v36 offset:2600
    s_waitcnt lgkmcnt(4)
    v_mfma_f32_16x16x32_bf16 v[24:27], v[80:83], v[48:51], 0
    v_mfma_f32_16x16x32_bf16 v[28:31], v[96:99], v[48:51], 0
    v_mfma_f32_16x16x32_bf16 v[24:27], v[84:87], v[52:55], v[24:27]
    v_mfma_f32_16x16x32_bf16 v[28:31], v[100:103], v[52:55], v[28:31]
    s_waitcnt lgkmcnt(0)
    s_barrier
    v_mfma_f32_16x16x32_bf16 v[24:27], v[88:91], v[112:115], v[24:27]
    v_mov_b32 v32, 0
    v_mov_b32 v33, 0
    v_mfma_f32_16x16x32_bf16 v[28:31], v[104:107], v[112:115], v[28:31]
    v_mov_b32 v34, 0xf149f2ca
    v_mov_b32 v35, 0xf149f2ca
    v_mfma_f32_16x16x32_bf16 v[24:27], v[92:95], v[116:119], v[24:27]
    s_lshl_b32 s5, s4, 6
    v_add_u32 v23, s5, v18
    v_mfma_f32_16x16x32_bf16 v[28:31], v[108:111], v[116:119], v[28:31]
    ds_read_b128 v[80:83], v18 offset:0
    ds_read_b128 v[84:87], v18 offset:64
    ds_read_b128 v[88:91], v18 offset:128
    ds_read_b128 v[92:95], v18 offset:192
    ds_read_b128 v[36:39], v23
    v_smfmac_f32_16x16x64_bf16 v[44:47], v[64:67], v[224:231], v1
    v_smfmac_f32_16x16x64_bf16 v[40:43], v[68:71], v[168:175], v1
    v_smfmac_f32_16x16x64_bf16 v[44:47], v[68:71], v[232:239], v1
    v_smfmac_f32_16x16x64_bf16 v[40:43], v[72:75], v[176:183], v1
    ds_read_b128 v[96:99], v20 offset:2048
    v_smfmac_f32_16x16x64_bf16 v[44:47], v[72:75], v[240:247], v1
    ds_read_b128 v[100:103], v20 offset:3072
    v_smfmac_f32_16x16x64_bf16 v[40:43], v[76:79], v[184:191], v1
    ds_read_b128 v[104:107], v20 offset:16384
    v_smfmac_f32_16x16x64_bf16 v[44:47], v[76:79], v[248:255], v1
    ds_read_b128 v[108:111], v20 offset:17408
    s_waitcnt lgkmcnt(5)
    v_mfma_f32_16x16x32_bf16 v[32:35], v[80:83], v[48:51], v[32:35]
    v_max3_f32 v23, v24, v25, v26
    v_max3_f32 v23, v23, v27, v28
    v_mfma_f32_16x16x32_bf16 v[32:35], v[84:87], v[52:55], v[32:35]
    v_max3_f32 v23, v23, v29, v30
    v_max_f32 v23, v23, v31
    v_mfma_f32_16x16x32_bf16 v[32:35], v[88:91], v[112:115], v[32:35]
    v_add_f32 v40, v40, v41
    v_add_f32 v42, v42, v43
    v_mfma_f32_16x16x32_bf16 v[32:35], v[92:95], v[116:119], v[32:35]
    v_add_f32 v44, v44, v45
    v_add_f32 v46, v46, v47
    v_cvt_pk_bf16_f32 v40, v40, v42
    v_cvt_pk_bf16_f32 v41, v44, v46
    s_waitcnt lgkmcnt(4)
    buffer_store_dwordx4 v[36:39], v21, s[8:11], s29 offen sc1
    buffer_store_dwordx2 v[40:41], v22, s[8:11], s30 offen sc1
    v_mov_b32 v42, v41
    v_mov_b32 v43, 0
    v_max3_f32 v36, v23, v32, v33
    v_mov_b32 v37, v36
    v_mov_b32 v48, s41
    v_mov_b32 v49, s41
    v_permlane32_swap_b32 v36, v37
    v_max_f32 v36, v36, v37
    v_mov_b32 v37, v36
    v_mov_b32 v50, s41
    v_mov_b32 v51, s41
    v_permlane16_swap_b32 v36, v37
    v_max_f32 v36, v36, v37
    v_mul_f32 v36, 0xbe0293ee, v36
    s_cmp_eq_u32 s20, 63
    v_pk_fma_f32 v[24:25], v[24:25], s[32:33], v[36:37] op_sel_hi:[1,0,0]
    v_pk_fma_f32 v[26:27], v[26:27], s[32:33], v[36:37] op_sel_hi:[1,0,0]
    v_pk_fma_f32 v[28:29], v[28:29], s[32:33], v[36:37] op_sel_hi:[1,0,0]
    v_pk_fma_f32 v[30:31], v[30:31], s[32:33], v[36:37] op_sel_hi:[1,0,0]
    v_pk_fma_f32 v[32:33], v[32:33], s[32:33], v[36:37] op_sel_hi:[1,0,0]
    v_exp_f32 v24, v24
    v_exp_f32 v25, v25
    ds_read_b128 v[80:83], v20 offset:18432
    v_exp_f32 v26, v26
    v_exp_f32 v27, v27
    ds_read_b128 v[84:87], v20 offset:19456
    v_exp_f32 v28, v28
    v_exp_f32 v29, v29
    ds_read_b128 v[88:91], v20 offset:4096
    v_exp_f32 v30, v30
    v_exp_f32 v31, v31
    ds_read_b128 v[92:95], v20 offset:5120
    v_exp_f32 v32, v32
    v_exp_f32 v33, v33
    ds_read_b128 v[112:115], v20 offset:6144
    v_cvt_pk_bf16_f32 v24, v24, v25
    v_cvt_pk_bf16_f32 v25, v26, v27
    v_cvt_pk_bf16_f32 v26, v28, v29
    v_cvt_pk_bf16_f32 v27, v30, v31
    v_cvt_pk_bf16_f32 v32, v32, v33
    v_mov_b32 v33, 0
    s_waitcnt vmcnt(8)
    v_mfma_f32_16x16x32_bf16 v[36:39], v[48:51], v[24:27], 0
    s_cbranch_scc1 ch_done
    v_mfma_f32_16x16x32_bf16 v[28:31], v[120:123], v[24:27], 0
    ds_read_b128 v[116:119], v20 offset:7168
    ds_read_b128 v[56:59], v20 offset:20480
    v_mfma_f32_16x16x32_bf16 v[44:47], v[124:127], v[24:27], 0
    ds_read_b128 v[60:63], v20 offset:21504
    ds_read_b128 v[64:67], v20 offset:22528
    v_mfma_f32_16x16x16_bf16 v[36:39], v[48:49], v[32:33], v[36:39]
    ds_read_b128 v[68:71], v20 offset:23552
    ds_read_b128 v[72:75], v20 offset:8192
    v_mfma_f32_16x16x16_bf16 v[28:31], v[40:41], v[32:33], v[28:31]
    ds_read_b128 v[76:79], v20 offset:9216
    v_mfma_f32_16x16x16_bf16 v[44:47], v[42:43], v[32:33], v[44:47]
    v_rcp_f32 v34, v36
    ds_read_b128 v[120:123], v20 offset:10240
    ds_read_b128 v[124:127], v20 offset:11264
    s_nop 0
    v_pk_mul_f32 v[28:29], v[28:29], v[34:35] op_sel_hi:[1,0]
    v_pk_mul_f32 v[30:31], v[30:31], v[34:35] op_sel_hi:[1,0]
    v_cvt_pk_bf16_f32 v28, v28, v29
    v_cvt_pk_bf16_f32 v29, v30, v31
    ds_write_b64 v19, v[28:29]
    v_pk_mul_f32 v[44:45], v[44:45], v[34:35] op_sel_hi:[1,0]
    v_pk_mul_f32 v[46:47], v[46:47], v[34:35] op_sel_hi:[1,0]
    v_cvt_pk_bf16_f32 v44, v44, v45
    v_cvt_pk_bf16_f32 v45, v46, v47
    ds_write_b64 v19, v[44:45] offset:256
    ds_read_b128 v[40:43], v20 offset:0
    ds_read_b128 v[44:47], v20 offset:1024
    v_mov_b32 v36, 0
    v_mov_b32 v37, 0
    v_mov_b32 v38, 0
    v_mov_b32 v39, 0
    s_waitcnt lgkmcnt(2)
    s_barrier
    ds_read_b128 v[24:27], v0 offset:0
    ds_read_b128 v[32:35], v0 offset:512
    ds_read_b128 v[48:51], v0 offset:1024
    ds_read_b128 v[52:55], v0 offset:1536
    v_mov_b32 v28, 0
    v_mov_b32 v29, 0
    v_mov_b32 v30, 0
    v_mov_b32 v31, 0
    s_waitcnt lgkmcnt(3)
    s_nop 0
    v_smfmac_f32_16x16x64_bf16 v[28:31], v[24:27], v[40:47], v1
    s_waitcnt lgkmcnt(2)
    v_smfmac_f32_16x16x64_bf16 v[28:31], v[32:35], v[96:103], v1
    ds_read_b128 v[96:99], v20 offset:24576
    ds_read_b128 v[100:103], v20 offset:25600
    v_mov_b32 v40, 0
    v_mov_b32 v44, 0
    s_waitcnt lgkmcnt(3)
    v_smfmac_f32_16x16x64_bf16 v[28:31], v[48:51], v[104:111], v1
    ds_read_b128 v[104:107], v20 offset:26624
    ds_read_b128 v[108:111], v20 offset:27648
    v_mov_b32 v41, 0
    v_mov_b32 v45, 0
    s_waitcnt lgkmcnt(4)
    v_smfmac_f32_16x16x64_bf16 v[28:31], v[52:55], v[80:87], v1
    ds_read_b128 v[80:83], v20 offset:12288
    ds_read_b128 v[84:87], v20 offset:13312
    v_mov_b32 v42, 0
    v_smfmac_f32_16x16x64_bf16 v[36:39], v[24:27], v[88:95], v1
    ds_read_b128 v[88:91], v20 offset:14336
    ds_read_b128 v[92:95], v20 offset:15360
    v_mov_b32 v43, 0
    v_smfmac_f32_16x16x64_bf16 v[36:39], v[32:35], v[112:119], v1
    ds_read_b128 v[112:115], v20 offset:28672
    ds_read_b128 v[116:119], v20 offset:29696
    v_cvt_pk_bf16_f32 v28, v28, v30
    v_smfmac_f32_16x16x64_bf16 v[36:39], v[48:51], v[56:63], v1
    ds_read_b128 v[56:59], v20 offset:30720
    ds_read_b128 v[60:63], v20 offset:31744
    v_cvt_pk_bf16_f32 v29, v29, v31
    v_smfmac_f32_16x16x64_bf16 v[36:39], v[52:55], v[64:71], v1
    v_mov_b32 v46, 0
    buffer_store_dwordx2 v[28:29], v9, s[8:11], s24 offen
    v_smfmac_f32_16x16x64_bf16 v[40:43], v[24:27], v[72:79], v1
    v_mov_b32 v47, 0
    v_smfmac_f32_16x16x64_bf16 v[40:43], v[32:35], v[120:127], v1
    v_cvt_pk_bf16_f32 v36, v36, v38
    s_waitcnt lgkmcnt(10)
    v_smfmac_f32_16x16x64_bf16 v[40:43], v[48:51], v[96:103], v1
    v_cvt_pk_bf16_f32 v37, v37, v39
    s_waitcnt lgkmcnt(8)
    v_smfmac_f32_16x16x64_bf16 v[40:43], v[52:55], v[104:111], v1
    buffer_store_dwordx2 v[36:37], v9, s[8:11], s43 offen
    s_waitcnt lgkmcnt(6)
    v_smfmac_f32_16x16x64_bf16 v[44:47], v[24:27], v[80:87], v1
    s_waitcnt lgkmcnt(4)
    v_smfmac_f32_16x16x64_bf16 v[44:47], v[32:35], v[88:95], v1
    v_cvt_pk_bf16_f32 v40, v40, v42
    s_waitcnt lgkmcnt(2)
    v_smfmac_f32_16x16x64_bf16 v[44:47], v[48:51], v[112:119], v1
    v_cvt_pk_bf16_f32 v41, v41, v43
    s_waitcnt lgkmcnt(0)
    v_smfmac_f32_16x16x64_bf16 v[44:47], v[52:55], v[56:63], v1
    buffer_store_dwordx2 v[40:41], v9, s[8:11], s25 offen
    s_nop 6
    v_cvt_pk_bf16_f32 v44, v44, v46
    v_cvt_pk_bf16_f32 v45, v45, v47
    buffer_store_dwordx2 v[44:45], v9, s[8:11], s19 offen
    v_mov_b32 v24, 0
    v_mov_b32 v25, 0
    v_mov_b32 v26, 0
    v_mov_b32 v27, 0
    v_mov_b32 v28, 0
    v_mov_b32 v29, 0
    v_mov_b32 v30, 0
    v_mov_b32 v31, 0
    v_mov_b32 v116, -1
    v_mov_b32 v117, -1
    v_mov_b32 v118, -1
    v_mov_b32 v119, -1
    s_mov_b32 s35, s22
    s_mov_b32 s36, s24
    s_mov_b32 s7, s23
    s_mov_b32 s23, s21
    s_mov_b32 s21, s22
    s_add_u32 s5, s22, 0x2000
    s_and_b32 s5, s5, 0x7fff
    s_or_b32 s22, s5, 65536
    s_lshl_b32 s6, s3, 13
    s_add_u32 s18, s24, s6
    s_add_u32 s5, s24, 262144
    s_cmp_ge_u32 s5, 917504
    s_cselect_b32 s24, 131072, s5
    s_add_u32 s25, s24, 32768
    s_add_u32 s43, s24, 16384
    s_add_u32 s19, s24, 49152
    s_add_u32 s29, s29, 65536
    s_add_u32 s30, s30, 65536
    s_add_u32 s34, s27, 16777216
    s_add_u32 s27, s27, 8192
    s_xor_b32 s28, s28, 8192
    s_xor_b32 s61, s61, 8192
    s_mov_b32 s38, s31
    s_mov_b32 s39, s26
    s_lshl_b32 s5, s3, 4
    s_lshl_b32 s31, s16, 2
    s_add_u32 s31, s31, s5
    s_add_u32 s31, s31, 0
    s_add_u32 s5, s20, 3
    s_cmp_ge_u32 s5, 64
    s_cselect_b32 s26, 0, s17
    s_add_u32 s16, s16, 1
    s_cmp_eq_u32 s16, 3
    s_cselect_b32 s16, 0, s16
    s_addc_u32 s17, s17, 0
    s_add_u32 s20, s20, 1
    s_cmp_ge_u32 s4, 2
    s_cbranch_scc1 ch_w23
    s_mov_b32 s33, 0
    buffer_load_dwordx4 v[56:59], v10, s[8:11], s36 offen offset:0 sc1
    buffer_load_dwordx4 v[60:63], v10, s[8:11], s36 offen offset:1024 sc1
    buffer_load_dwordx4 v[64:67], v10, s[8:11], s36 offen offset:2048 sc1
    buffer_load_dwordx4 v[68:71], v10, s[8:11], s36 offen offset:3072 sc1
    v_mov_b32 v32, 0
    v_mov_b32 v33, 0
    v_mov_b32 v34, 0
    v_mov_b32 v35, 0
    v_mov_b32 v36, 0
    v_mov_b32 v37, 0
    v_mov_b32 v38, 0
    v_mov_b32 v39, 0
    v_mov_b32 v40, 0
    v_mov_b32 v41, 0
    v_mov_b32 v42, 0
    v_mov_b32 v43, 0
    v_mov_b32 v44, 0
    v_mov_b32 v45, 0
    v_mov_b32 v46, 0
    v_mov_b32 v47, 0
    buffer_load_dwordx4 v[80:83], v10, s[8:11], s36 offen offset:0 sc1
    buffer_load_dwordx4 v[84:87], v10, s[8:11], s36 offen offset:1024 sc1
    buffer_load_dwordx4 v[88:91], v10, s[8:11], s36 offen offset:2048 sc1
    buffer_load_dwordx4 v[92:95], v10, s[8:11], s36 offen offset:3072 sc1
ch_pi:
    s_waitcnt vmcnt(7)
    v_mfma_f32_16x16x32_bf16 v[72:75], v[12:15], v[56:59], 0
    v_max3_u32 v76, v56, v57, v58
    s_waitcnt vmcnt(6)
    v_mfma_f32_16x16x32_bf16 v[72:75], v[12:15], v[60:63], v[72:75]
    v_max3_u32 v77, v59, v60, v61
    v_max3_u32 v76, v76, v62, v63
    s_waitcnt vmcnt(5)
    v_mfma_f32_16x16x32_bf16 v[72:75], v[12:15], v[64:67], v[72:75]
    v_max3_u32 v77, v77, v64, v65
    v_max3_u32 v76, v76, v66, v67
    s_waitcnt vmcnt(4)
    v_mfma_f32_16x16x32_bf16 v[72:75], v[12:15], v[68:71], v[72:75]
    v_max3_u32 v77, v77, v68, v69
    v_max3_u32 v76, v76, v70, v71
    v_max_u32 v76, v76, v77
    v_cmp_eq_u32 vcc, -1, v76
    s_cbranch_vccnz ch_pi_retry
ch_pi_ok:
    s_mov_b32 vcc_lo, 0xff00ff00
    s_mov_b32 vcc_hi, 0xff00ff00
    s_nop 0
    v_add_f32_dpp v72, v72, v72 row_ror:8 row_mask:0xf bank_mask:0xf
    v_add_f32_dpp v73, v73, v73 row_ror:8 row_mask:0xf bank_mask:0xf
    v_add_f32_dpp v74, v74, v74 row_ror:8 row_mask:0xf bank_mask:0xf
    v_add_f32_dpp v75, v75, v75 row_ror:8 row_mask:0xf bank_mask:0xf
    v_cvt_pk_bf16_f32 v72, v72, v73
    v_cvt_pk_bf16_f32 v73, v74, v75
    v_cndmask_b32 v72, v72, v73, vcc
    buffer_store_dword v72, v11, s[8:11], s35 offen
ch_join:
    s_barrier
    s_sleep 3
    s_mov_b32 s33, 0
    buffer_load_dwordx4 v[48:51], v4, s[8:11], s21 offen sc1
    buffer_load_dwordx4 v[52:55], v4, s[8:11], s21 offen offset:1024 sc1
    s_waitcnt vmcnt(3)
    v_add_u32 v23, s61, v2
    ds_read_b128 v[80:83], v23 offset:0
    ds_read_b128 v[84:87], v23 offset:1024
    ds_read_b128 v[88:91], v23 offset:2048
    ds_read_b128 v[92:95], v23 offset:3072
    ds_read_b128 v[96:99], v23 offset:4096
    ds_read_b128 v[100:103], v23 offset:5120
    ds_read_b128 v[104:107], v23 offset:6144
    ds_read_b128 v[108:111], v23 offset:7168
    s_sleep 1
    buffer_load_dwordx4 v[120:123], v4, s[8:11], s21 offen sc1
    buffer_load_dwordx4 v[124:127], v4, s[8:11], s21 offen offset:1024 sc1
    s_branch ch_step
ch_w23:
    v_mov_b32 v32, 0
    v_mov_b32 v33, 0
    v_mov_b32 v34, 0
    v_mov_b32 v35, 0
    v_mov_b32 v36, 0
    v_mov_b32 v37, 0
    v_mov_b32 v38, 0
    v_mov_b32 v39, 0
    v_mov_b32 v40, 0
    v_mov_b32 v41, 0
    v_mov_b32 v42, 0
    v_mov_b32 v43, 0
    v_mov_b32 v44, 0
    v_mov_b32 v45, 0
    v_mov_b32 v46, 0
    v_mov_b32 v47, 0
    s_waitcnt vmcnt(2)
    buffer_store_dword v116, v11, s[8:11], s7 offen
    s_branch ch_join
ch_pm_retry:
    buffer_load_dwordx4 v[48:51], v4, s[8:11], s21 offen sc1
    buffer_load_dwordx4 v[52:55], v4, s[8:11], s21 offen offset:1024 sc1
    s_waitcnt vmcnt(2)
    v_max3_u32 v23, v120, v121, v122
    v_max3_u32 v56, v123, v124, v125
    v_max3_u32 v23, v23, v126, v127
    v_max_u32 v23, v23, v56
    v_cmp_eq_u32 vcc, -1, v23
    s_cbranch_vccz ch_pm_b
    buffer_load_dwordx4 v[120:123], v4, s[8:11], s21 offen sc1
    buffer_load_dwordx4 v[124:127], v4, s[8:11], s21 offen offset:1024 sc1
    s_add_u32 s33, s33, 1
    s_cmp_gt_u32 s33, 100000
    s_cbranch_scc0 ch_step
    s_add_u32 s37, s37, 1
    s_waitcnt vmcnt(0)
    s_branch ch_pm_ok
ch_pm_b:
    v_mov_b32 v48, v120
    v_mov_b32 v49, v121
    v_mov_b32 v50, v122
    v_mov_b32 v51, v123
    v_mov_b32 v52, v124
    v_mov_b32 v53, v125
    v_mov_b32 v54, v126
    v_mov_b32 v55, v127
    s_branch ch_pm_ok
ch_fs_slow:
    v_readfirstlane_b32 s5, v3
    s_nop 0
    s_cmp_ge_u32 s5, s39
    s_cbranch_scc1 ch_fs_3_ok
    s_mov_b32 s33, 0
ch_fs_3:
    v_mov_b32 v3, 0
    buffer_load_dword v3, v3, s[8:11], s38 offen sc1
    s_add_u32 s33, s33, 1
    s_cmp_gt_u32 s33, 0x8000
    s_cbranch_scc1 ch_fs_3_fail
    s_waitcnt vmcnt(0)
    v_readfirstlane_b32 s5, v3
    s_nop 0
    s_cmp_ge_u32 s5, s39
    s_cbranch_scc0 ch_fs_3
    s_branch ch_fs_3_ok
ch_fs_3_fail:
    s_add_u32 s37, s37, 1
    s_waitcnt vmcnt(0)
ch_fs_3_ok:
    s_branch ch_fs_ok
ch_pi_retry:
    buffer_load_dwordx4 v[56:59], v10, s[8:11], s36 offen offset:0 sc1
    buffer_load_dwordx4 v[60:63], v10, s[8:11], s36 offen offset:1024 sc1
    buffer_load_dwordx4 v[64:67], v10, s[8:11], s36 offen offset:2048 sc1
    buffer_load_dwordx4 v[68:71], v10, s[8:11], s36 offen offset:3072 sc1
    s_waitcnt vmcnt(7)
    v_mfma_f32_16x16x32_bf16 v[72:75], v[12:15], v[80:83], 0
    v_max3_u32 v76, v80, v81, v82
    s_waitcnt vmcnt(6)
    v_mfma_f32_16x16x32_bf16 v[72:75], v[12:15], v[84:87], v[72:75]
    v_max3_u32 v77, v83, v84, v85
    v_max3_u32 v76, v76, v86, v87
    s_waitcnt vmcnt(5)
    v_mfma_f32_16x16x32_bf16 v[72:75], v[12:15], v[88:91], v[72:75]
    v_max3_u32 v77, v77, v88, v89
    v_max3_u32 v76, v76, v90, v91
    s_waitcnt vmcnt(4)
    v_mfma_f32_16x16x32_bf16 v[72:75], v[12:15], v[92:95], v[72:75]
    v_max3_u32 v77, v77, v92, v93
    v_max3_u32 v76, v76, v94, v95
    v_max_u32 v76, v76, v77
    v_cmp_eq_u32 vcc, -1, v76
    s_cbranch_vccz ch_pi_ok
    buffer_load_dwordx4 v[80:83], v10, s[8:11], s36 offen offset:0 sc1
    buffer_load_dwordx4 v[84:87], v10, s[8:11], s36 offen offset:1024 sc1
    buffer_load_dwordx4 v[88:91], v10, s[8:11], s36 offen offset:2048 sc1
    buffer_load_dwordx4 v[92:95], v10, s[8:11], s36 offen offset:3072 sc1
    s_add_u32 s33, s33, 1
    s_cmp_gt_u32 s33, 100000
    s_cbranch_scc0 ch_pi
    s_add_u32 s37, s37, 1
    s_waitcnt vmcnt(0)
    s_branch ch_pi_ok
ch_done:
    s_waitcnt vmcnt(0)
    s_barrier
    s_cmp_lg_u32 s4, 2
    s_cbranch_scc1 ch_nfin
    v_mov_b32 v48, 64
    s_mov_b64 exec, 1
    buffer_store_dword v48, v2, s[8:11], s42 offen sc1
    s_mov_b64 exec, -1
    s_waitcnt vmcnt(0)
ch_nfin:
    s_endpgm
mg_chain_slow:
    s_waitcnt vmcnt(0)
    s_mov_b32 s32, 0x3e0293ee
    s_mov_b32 s41, 0x3f803f80
    s_mov_b32 s37, 0
    s_mov_b32 s20, 0
    s_mov_b32 s21, 65536
    s_mov_b32 s22, 73728
    s_mov_b32 s23, 90112
    s_mov_b32 s24, 131072
    s_mov_b32 s25, 163840
    s_mov_b32 s43, 147456
    s_mov_b32 s19, 180224
    s_lshl_b32 s5, s3, 13
    s_add_u32 s18, s5, 655360
    s_lshl_b32 s5, s3, 11
    s_add_u32 s29, s5, 5242880
    s_add_u32 s30, s5, 9437184
    s_lshl_b32 s5, s3, 19
    s_add_u32 s27, s5, 33554432
    s_lshl_b32 s5, s3, 4
    s_add_u32 s42, s5, 1024
    s_lshl_b32 s5, s4, 11
    s_add_u32 s28, s5, 131072
    s_mov_b32 s61, 131072
    v_lshlrev_b32 v56, 3, v2
    s_lshl_b32 s5, s3, 13
    s_add_u32 s5, s5, 131072
    s_cmp_eq_u32 s4, 3
    s_cbranch_scc1 cs_pfm
    s_lshl_b32 s6, s4, 18
    s_add_u32 s5, s5, s6
    buffer_load_dword v57, v56, s[8:11], s5 offen sc1
    s_branch cs_pfd
cs_pfm:
    s_mov_b32 s5, 65536
    buffer_load_dword v57, v56, s[8:11], s5 offen sc1
    s_add_u32 s5, s5, 8192
    buffer_load_dword v58, v56, s[8:11], s5 offen sc1
    s_add_u32 s5, s5, 8192
    buffer_load_dword v59, v56, s[8:11], s5 offen sc1
    s_add_u32 s5, s5, 8192
    buffer_load_dword v60, v56, s[8:11], s5 offen sc1
cs_pfd:
    s_mov_b32 s72, 0
cs_fr:
    v_readfirstlane_b32 s5, v114
    s_nop 0
    s_cmp_ge_u32 s5, 174
    s_cbranch_scc1 cs_fr_ok
    s_add_u32 s72, s72, 1
    s_cmp_gt_u32 s72, 0x20000
    s_cbranch_scc1 cs_fr_ok
    s_sleep 4
    buffer_load_dword v114, off, s[64:67], 0 offset:128 sc1
    s_waitcnt vmcnt(0)
    s_branch cs_fr
cs_fr_ok:
    s_lshl_b32 s5, s3, 4
    s_add_u32 s38, s5, 0
    s_mov_b32 s39, 1
    v_mov_b32 v3, 0
    s_nop 0
    v_readfirstlane_b32 s5, v3
    s_nop 0
    s_cmp_ge_u32 s5, s39
    s_cbranch_scc1 cs_f0_4_ok
    s_mov_b32 s33, 0
cs_f0_4:
    v_mov_b32 v3, 0
    buffer_load_dword v3, v3, s[8:11], s38 offen sc1
    s_add_u32 s33, s33, 1
    s_cmp_gt_u32 s33, 0x8000
    s_cbranch_scc1 cs_f0_4_fail
    s_waitcnt vmcnt(0)
    v_readfirstlane_b32 s5, v3
    s_nop 0
    s_cmp_ge_u32 s5, s39
    s_cbranch_scc0 cs_f0_4
    s_branch cs_f0_4_ok
cs_f0_4_fail:
    s_add_u32 s37, s37, 1
    s_waitcnt vmcnt(0)
cs_f0_4_ok:
    s_mov_b32 m0, s28
    s_nop 0
    buffer_load_dwordx4 v4, s[8:11], s27 offen sc1 lds
    buffer_load_dwordx4 v4, s[8:11], s27 offen offset:1024 sc1 lds
    s_add_u32 s38, s38, 4
    v_mov_b32 v3, 0
    buffer_load_dword v3, v3, s[8:11], s38 offen sc1
    s_mov_b32 s16, 2
    s_mov_b32 s17, 1
    s_lshl_b32 s5, s3, 4
    s_lshl_b32 s31, s16, 2
    s_add_u32 s31, s31, s5
    s_add_u32 s31, s31, 0
    s_add_u32 s5, s20, 2
    s_cmp_ge_u32 s5, 64
    s_cselect_b32 s26, 0, s17
    s_add_u32 s16, s16, 1
    s_cmp_eq_u32 s16, 3
    s_cselect_b32 s16, 0, s16
    s_addc_u32 s17, s17, 0
    s_add_u32 s34, s27, 16777216
    s_add_u32 s27, s27, 8192
    s_xor_b32 s28, s28, 8192
    v_mov_b32 v24, 0
    v_mov_b32 v25, 0
    v_mov_b32 v26, 0
    v_mov_b32 v27, 0
    v_mov_b32 v28, 0
    v_mov_b32 v29, 0
    v_mov_b32 v30, 0
    v_mov_b32 v31, 0
    v_mov_b32 v32, 0
    v_mov_b32 v33, 0
    v_mov_b32 v34, 0
    v_mov_b32 v35, 0
    v_mov_b32 v36, 0
    v_mov_b32 v37, 0
    v_mov_b32 v38, 0
    v_mov_b32 v39, 0
    v_mov_b32 v40, 0
    v_mov_b32 v41, 0
    v_mov_b32 v42, 0
    v_mov_b32 v43, 0
    v_mov_b32 v44, 0
    v_mov_b32 v45, 0
    v_mov_b32 v46, 0
    v_mov_b32 v47, 0
    v_mov_b32 v116, -1
    v_mov_b32 v117, -1
    v_mov_b32 v118, -1
    v_mov_b32 v119, -1
    s_waitcnt vmcnt(0)
    s_barrier
    s_mov_b32 s33, 0
    buffer_load_dwordx4 v[48:51], v4, s[8:11], s21 offen sc1
    buffer_load_dwordx4 v[52:55], v4, s[8:11], s21 offen offset:1024 sc1
    v_add_u32 v23, s61, v2
    ds_read_b128 v[80:83], v23 offset:0
    ds_read_b128 v[84:87], v23 offset:1024
    ds_read_b128 v[88:91], v23 offset:2048
    ds_read_b128 v[92:95], v23 offset:3072
    ds_read_b128 v[96:99], v23 offset:4096
    ds_read_b128 v[100:103], v23 offset:5120
    ds_read_b128 v[104:107], v23 offset:6144
    ds_read_b128 v[108:111], v23 offset:7168
    buffer_load_dwordx4 v[120:123], v4, s[8:11], s21 offen sc1
    buffer_load_dwordx4 v[124:127], v4, s[8:11], s21 offen offset:1024 sc1
cs_step:
    s_waitcnt vmcnt(2)
cs_step2:
    v_max3_u32 v23, v48, v49, v50
    v_max3_u32 v56, v51, v52, v53
    v_max3_u32 v23, v23, v54, v55
    v_max_u32 v23, v23, v56
    v_cmp_eq_u32 vcc, -1, v23
    s_cbranch_vccnz cs_pm_retry
cs_pm_ok:
    ds_write_b128 v5, v[48:51]
    v_smfmac_f32_16x16x64_bf16 v[24:27], v[48:51], a[0:7], v1
    ds_write_b128 v5, v[52:55] offset:1024
    buffer_load_dwordx4 v[120:123], v4, s[8:11], s34 offen sc1
    v_smfmac_f32_16x16x64_bf16 v[28:31], v[48:51], a[64:71], v1
    v_readfirstlane_b32 s5, v3
    v_smfmac_f32_16x16x64_bf16 v[32:35], v[48:51], a[128:135], v1
    buffer_load_dwordx4 v[124:127], v4, s[8:11], s34 offen offset:1024 sc1
    s_cmp_ge_u32 s5, s39
    v_smfmac_f32_16x16x64_bf16 v[36:39], v[48:51], a[192:199], v1
    s_cbranch_scc0 cs_fs_slow
cs_fs_ok:
    v_smfmac_f32_16x16x64_bf16 v[40:43], v[48:51], v[128:135], v1
    s_waitcnt lgkmcnt(0)
    s_barrier
    ds_read_b128 v[56:59], v6 offset:0
    v_smfmac_f32_16x16x64_bf16 v[44:47], v[48:51], v[192:199], v1
    ds_read_b128 v[60:63], v6 offset:1024
    v_smfmac_f32_16x16x64_bf16 v[24:27], v[52:55], a[8:15], v1
    ds_read_b128 v[64:67], v7 offset:0
    v_smfmac_f32_16x16x64_bf16 v[28:31], v[52:55], a[72:79], v1
    ds_read_b128 v[68:71], v7 offset:1024
    v_smfmac_f32_16x16x64_bf16 v[32:35], v[52:55], a[136:143], v1
    ds_read_b128 v[72:75], v8 offset:0
    v_smfmac_f32_16x16x64_bf16 v[36:39], v[52:55], a[200:207], v1
    ds_read_b128 v[76:79], v8 offset:1024
    v_smfmac_f32_16x16x64_bf16 v[40:43], v[52:55], v[136:143], v1
    v_smfmac_f32_16x16x64_bf16 v[44:47], v[52:55], v[200:207], v1
    v_mov_b32 v23, s20
    s_waitcnt lgkmcnt(5)
    v_smfmac_f32_16x16x64_bf16 v[24:27], v[56:59], a[16:23], v1
    v_smfmac_f32_16x16x64_bf16 v[28:31], v[56:59], a[80:87], v1
    buffer_store_dword v23, off, s[8:11], s42 sc1
    s_waitcnt lgkmcnt(4)
    v_smfmac_f32_16x16x64_bf16 v[24:27], v[60:63], a[24:31], v1
    v_smfmac_f32_16x16x64_bf16 v[28:31], v[60:63], a[88:95], v1
    buffer_store_dwordx4 v[116:119], v4, s[8:11], s18 offen sc1
    s_waitcnt lgkmcnt(3)
    v_smfmac_f32_16x16x64_bf16 v[24:27], v[64:67], a[32:39], v1
    v_smfmac_f32_16x16x64_bf16 v[28:31], v[64:67], a[96:103], v1
    s_waitcnt lgkmcnt(2)
    v_smfmac_f32_16x16x64_bf16 v[24:27], v[68:71], a[40:47], v1
    v_smfmac_f32_16x16x64_bf16 v[28:31], v[68:71], a[104:111], v1
    buffer_store_dwordx4 v[116:119], v4, s[8:11], s18 offen offset:1024 sc1
    s_waitcnt lgkmcnt(1)
    v_smfmac_f32_16x16x64_bf16 v[24:27], v[72:75], a[48:55], v1
    v_smfmac_f32_16x16x64_bf16 v[28:31], v[72:75], a[112:119], v1
    s_waitcnt lgkmcnt(0)
    v_smfmac_f32_16x16x64_bf16 v[24:27], v[76:79], a[56:63], v1
    v_smfmac_f32_16x16x64_bf16 v[28:31], v[76:79], a[120:127], v1
    v_smfmac_f32_16x16x64_bf16 v[32:35], v[56:59], a[144:151], v1
    v_smfmac_f32_16x16x64_bf16 v[36:39], v[56:59], a[208:215], v1
    v_add_f32 v24, v24, v25
    v_add_f32 v26, v26, v27
    v_smfmac_f32_16x16x64_bf16 v[32:35], v[60:63], a[152:159], v1
    v_add_f32 v28, v28, v29
    v_add_f32 v30, v30, v31
    v_smfmac_f32_16x16x64_bf16 v[36:39], v[60:63], a[216:223], v1
    v_cvt_pk_bf16_f32 v24, v24, v26
    v_cvt_pk_bf16_f32 v28, v28, v30
    v_smfmac_f32_16x16x64_bf16 v[32:35], v[64:67], a[160:167], v1
    ds_write_b16 v16, v24
    ds_write_b16_d16_hi v16, v24 offset:288
    v_smfmac_f32_16x16x64_bf16 v[36:39], v[64:67], a[224:231], v1
    ds_write_b16 v16, v28 offset:8
    ds_write_b16_d16_hi v16, v28 offset:296
    v_smfmac_f32_16x16x64_bf16 v[32:35], v[68:71], a[168:175], v1
    s_mov_b32 m0, s28
    s_nop 0
    buffer_load_dwordx4 v4, s[8:11], s27 offen sc1 lds
    v_smfmac_f32_16x16x64_bf16 v[36:39], v[68:71], a[232:239], v1
    buffer_load_dwordx4 v4, s[8:11], s27 offen offset:1024 sc1 lds
    v_smfmac_f32_16x16x64_bf16 v[32:35], v[72:75], a[176:183], v1
    buffer_load_dword v3, off, s[8:11], s31 sc1
    v_smfmac_f32_16x16x64_bf16 v[36:39], v[72:75], a[240:247], v1
    s_waitcnt vmcnt(8) lgkmcnt(0)
    s_barrier
    ds_read_b128 v[48:51], v17 offset:0
    ds_read_b128 v[52:55], v17 offset:64
    v_smfmac_f32_16x16x64_bf16 v[32:35], v[76:79], a[184:191], v1
    ds_read_b128 v[112:115], v17 offset:128
    ds_read_b128 v[116:119], v17 offset:192
    v_smfmac_f32_16x16x64_bf16 v[36:39], v[76:79], a[248:255], v1
    v_smfmac_f32_16x16x64_bf16 v[40:43], v[56:59], v[144:151], v1
    v_smfmac_f32_16x16x64_bf16 v[44:47], v[56:59], v[208:215], v1
    v_add_f32 v32, v32, v33
    v_add_f32 v34, v34, v35
    v_smfmac_f32_16x16x64_bf16 v[40:43], v[60:63], v[152:159], v1
    v_add_f32 v36, v36, v37
    v_add_f32 v38, v38, v39
    v_smfmac_f32_16x16x64_bf16 v[44:47], v[60:63], v[216:223], v1
    v_cvt_pk_bf16_f32 v32, v32, v34
    v_cvt_pk_bf16_f32 v36, v36, v38
    ds_write_b16 v16, v32 offset:2304
    ds_write_b16_d16_hi v16, v32 offset:2592
    v_smfmac_f32_16x16x64_bf16 v[40:43], v[64:67], v[160:167], v1
    ds_write_b16 v16, v36 offset:2312
    ds_write_b16_d16_hi v16, v36 offset:2600
    s_waitcnt lgkmcnt(4)
    v_mfma_f32_16x16x32_bf16 v[24:27], v[80:83], v[48:51], 0
    v_mfma_f32_16x16x32_bf16 v[28:31], v[96:99], v[48:51], 0
    v_mfma_f32_16x16x32_bf16 v[24:27], v[84:87], v[52:55], v[24:27]
    v_mfma_f32_16x16x32_bf16 v[28:31], v[100:103], v[52:55], v[28:31]
    s_waitcnt lgkmcnt(0)
    s_barrier
    v_mfma_f32_16x16x32_bf16 v[24:27], v[88:91], v[112:115], v[24:27]
    v_mov_b32 v32, 0
    v_mov_b32 v33, 0
    v_mfma_f32_16x16x32_bf16 v[28:31], v[104:107], v[112:115], v[28:31]
    v_mov_b32 v34, 0xf149f2ca
    v_mov_b32 v35, 0xf149f2ca
    v_mfma_f32_16x16x32_bf16 v[24:27], v[92:95], v[116:119], v[24:27]
    s_lshl_b32 s5, s4, 6
    v_add_u32 v23, s5, v18
    v_mfma_f32_16x16x32_bf16 v[28:31], v[108:111], v[116:119], v[28:31]
    ds_read_b128 v[80:83], v18 offset:0
    ds_read_b128 v[84:87], v18 offset:64
    ds_read_b128 v[88:91], v18 offset:128
    ds_read_b128 v[92:95], v18 offset:192
    ds_read_b128 v[36:39], v23
    v_smfmac_f32_16x16x64_bf16 v[44:47], v[64:67], v[224:231], v1
    v_smfmac_f32_16x16x64_bf16 v[40:43], v[68:71], v[168:175], v1
    v_smfmac_f32_16x16x64_bf16 v[44:47], v[68:71], v[232:239], v1
    v_smfmac_f32_16x16x64_bf16 v[40:43], v[72:75], v[176:183], v1
    ds_read_b128 v[96:99], v20 offset:2048
    v_smfmac_f32_16x16x64_bf16 v[44:47], v[72:75], v[240:247], v1
    ds_read_b128 v[100:103], v20 offset:3072
    v_smfmac_f32_16x16x64_bf16 v[40:43], v[76:79], v[184:191], v1
    ds_read_b128 v[104:107], v20 offset:16384
    v_smfmac_f32_16x16x64_bf16 v[44:47], v[76:79], v[248:255], v1
    ds_read_b128 v[108:111], v20 offset:17408
    s_waitcnt lgkmcnt(5)
    v_mfma_f32_16x16x32_bf16 v[32:35], v[80:83], v[48:51], v[32:35]
    v_max3_f32 v23, v24, v25, v26
    v_max3_f32 v23, v23, v27, v28
    v_mfma_f32_16x16x32_bf16 v[32:35], v[84:87], v[52:55], v[32:35]
    v_max3_f32 v23, v23, v29, v30
    v_max_f32 v23, v23, v31
    v_mfma_f32_16x16x32_bf16 v[32:35], v[88:91], v[112:115], v[32:35]
    v_add_f32 v40, v40, v41
    v_add_f32 v42, v42, v43
    v_mfma_f32_16x16x32_bf16 v[32:35], v[92:95], v[116:119], v[32:35]
    v_add_f32 v44, v44, v45
    v_add_f32 v46, v46, v47
    v_cvt_pk_bf16_f32 v40, v40, v42
    v_cvt_pk_bf16_f32 v41, v44, v46
    s_waitcnt lgkmcnt(4)
    buffer_store_dwordx4 v[36:39], v21, s[8:11], s29 offen sc1
    buffer_store_dwordx2 v[40:41], v22, s[8:11], s30 offen sc1
    v_mov_b32 v42, v41
    v_mov_b32 v43, 0
    v_max3_f32 v36, v23, v32, v33
    v_mov_b32 v37, v36
    v_mov_b32 v48, s41
    v_mov_b32 v49, s41
    v_permlane32_swap_b32 v36, v37
    v_max_f32 v36, v36, v37
    v_mov_b32 v37, v36
    v_mov_b32 v50, s41
    v_mov_b32 v51, s41
    v_permlane16_swap_b32 v36, v37
    v_max_f32 v36, v36, v37
    v_mul_f32 v36, 0xbe0293ee, v36
    s_cmp_eq_u32 s20, 63
    v_pk_fma_f32 v[24:25], v[24:25], s[32:33], v[36:37] op_sel_hi:[1,0,0]
    v_pk_fma_f32 v[26:27], v[26:27], s[32:33], v[36:37] op_sel_hi:[1,0,0]
    v_pk_fma_f32 v[28:29], v[28:29], s[32:33], v[36:37] op_sel_hi:[1,0,0]
    v_pk_fma_f32 v[30:31], v[30:31], s[32:33], v[36:37] op_sel_hi:[1,0,0]
    v_pk_fma_f32 v[32:33], v[32:33], s[32:33], v[36:37] op_sel_hi:[1,0,0]
    v_exp_f32 v24, v24
    v_exp_f32 v25, v25
    ds_read_b128 v[80:83], v20 offset:18432
    v_exp_f32 v26, v26
    v_exp_f32 v27, v27
    ds_read_b128 v[84:87], v20 offset:19456
    v_exp_f32 v28, v28
    v_exp_f32 v29, v29
    ds_read_b128 v[88:91], v20 offset:4096
    v_exp_f32 v30, v30
    v_exp_f32 v31, v31
    ds_read_b128 v[92:95], v20 offset:5120
    v_exp_f32 v32, v32
    v_exp_f32 v33, v33
    ds_read_b128 v[112:115], v20 offset:6144
    v_cvt_pk_bf16_f32 v24, v24, v25
    v_cvt_pk_bf16_f32 v25, v26, v27
    v_cvt_pk_bf16_f32 v26, v28, v29
    v_cvt_pk_bf16_f32 v27, v30, v31
    v_cvt_pk_bf16_f32 v32, v32, v33
    v_mov_b32 v33, 0
    s_waitcnt vmcnt(8)
    v_mfma_f32_16x16x32_bf16 v[36:39], v[48:51], v[24:27], 0
    s_cbranch_scc1 cs_done
    v_mfma_f32_16x16x32_bf16 v[28:31], v[120:123], v[24:27], 0
    ds_read_b128 v[116:119], v20 offset:7168
    ds_read_b128 v[56:59], v20 offset:20480
    v_mfma_f32_16x16x32_bf16 v[44:47], v[124:127], v[24:27], 0
    ds_read_b128 v[60:63], v20 offset:21504
    ds_read_b128 v[64:67], v20 offset:22528
    v_mfma_f32_16x16x16_bf16 v[36:39], v[48:49], v[32:33], v[36:39]
    ds_read_b128 v[68:71], v20 offset:23552
    ds_read_b128 v[72:75], v20 offset:8192
    v_mfma_f32_16x16x16_bf16 v[28:31], v[40:41], v[32:33], v[28:31]
    ds_read_b128 v[76:79], v20 offset:9216
    v_mfma_f32_16x16x16_bf16 v[44:47], v[42:43], v[32:33], v[44:47]
    v_rcp_f32 v34, v36
    ds_read_b128 v[120:123], v20 offset:10240
    ds_read_b128 v[124:127], v20 offset:11264
    s_nop 0
    v_pk_mul_f32 v[28:29], v[28:29], v[34:35] op_sel_hi:[1,0]
    v_pk_mul_f32 v[30:31], v[30:31], v[34:35] op_sel_hi:[1,0]
    v_cvt_pk_bf16_f32 v28, v28, v29
    v_cvt_pk_bf16_f32 v29, v30, v31
    ds_write_b64 v19, v[28:29]
    v_pk_mul_f32 v[44:45], v[44:45], v[34:35] op_sel_hi:[1,0]
    v_pk_mul_f32 v[46:47], v[46:47], v[34:35] op_sel_hi:[1,0]
    v_cvt_pk_bf16_f32 v44, v44, v45
    v_cvt_pk_bf16_f32 v45, v46, v47
    ds_write_b64 v19, v[44:45] offset:256
    ds_read_b128 v[40:43], v20 offset:0
    ds_read_b128 v[44:47], v20 offset:1024
    v_mov_b32 v36, 0
    v_mov_b32 v37, 0
    v_mov_b32 v38, 0
    v_mov_b32 v39, 0
    s_waitcnt lgkmcnt(2)
    s_barrier
    ds_read_b128 v[24:27], v0 offset:0
    ds_read_b128 v[32:35], v0 offset:512
    ds_read_b128 v[48:51], v0 offset:1024
    ds_read_b128 v[52:55], v0 offset:1536
    v_mov_b32 v28, 0
    v_mov_b32 v29, 0
    v_mov_b32 v30, 0
    v_mov_b32 v31, 0
    s_waitcnt lgkmcnt(3)
    s_nop 0
    v_smfmac_f32_16x16x64_bf16 v[28:31], v[24:27], v[40:47], v1
    s_waitcnt lgkmcnt(2)
    v_smfmac_f32_16x16x64_bf16 v[28:31], v[32:35], v[96:103], v1
    ds_read_b128 v[96:99], v20 offset:24576
    ds_read_b128 v[100:103], v20 offset:25600
    v_mov_b32 v40, 0
    v_mov_b32 v44, 0
    s_waitcnt lgkmcnt(3)
    v_smfmac_f32_16x16x64_bf16 v[28:31], v[48:51], v[104:111], v1
    ds_read_b128 v[104:107], v20 offset:26624
    ds_read_b128 v[108:111], v20 offset:27648
    v_mov_b32 v41, 0
    v_mov_b32 v45, 0
    s_waitcnt lgkmcnt(4)
    v_smfmac_f32_16x16x64_bf16 v[28:31], v[52:55], v[80:87], v1
    ds_read_b128 v[80:83], v20 offset:12288
    ds_read_b128 v[84:87], v20 offset:13312
    v_mov_b32 v42, 0
    v_smfmac_f32_16x16x64_bf16 v[36:39], v[24:27], v[88:95], v1
    ds_read_b128 v[88:91], v20 offset:14336
    ds_read_b128 v[92:95], v20 offset:15360
    v_mov_b32 v43, 0
    v_smfmac_f32_16x16x64_bf16 v[36:39], v[32:35], v[112:119], v1
    ds_read_b128 v[112:115], v20 offset:28672
    ds_read_b128 v[116:119], v20 offset:29696
    v_cvt_pk_bf16_f32 v28, v28, v30
    v_smfmac_f32_16x16x64_bf16 v[36:39], v[48:51], v[56:63], v1
    ds_read_b128 v[56:59], v20 offset:30720
    ds_read_b128 v[60:63], v20 offset:31744
    v_cvt_pk_bf16_f32 v29, v29, v31
    v_smfmac_f32_16x16x64_bf16 v[36:39], v[52:55], v[64:71], v1
    v_mov_b32 v46, 0
    buffer_store_dwordx2 v[28:29], v9, s[8:11], s24 offen sc1
    v_smfmac_f32_16x16x64_bf16 v[40:43], v[24:27], v[72:79], v1
    v_mov_b32 v47, 0
    v_smfmac_f32_16x16x64_bf16 v[40:43], v[32:35], v[120:127], v1
    v_cvt_pk_bf16_f32 v36, v36, v38
    s_waitcnt lgkmcnt(10)
    v_smfmac_f32_16x16x64_bf16 v[40:43], v[48:51], v[96:103], v1
    v_cvt_pk_bf16_f32 v37, v37, v39
    s_waitcnt lgkmcnt(8)
    v_smfmac_f32_16x16x64_bf16 v[40:43], v[52:55], v[104:111], v1
    buffer_store_dwordx2 v[36:37], v9, s[8:11], s43 offen sc1
    s_waitcnt lgkmcnt(6)
    v_smfmac_f32_16x16x64_bf16 v[44:47], v[24:27], v[80:87], v1
    s_waitcnt lgkmcnt(4)
    v_smfmac_f32_16x16x64_bf16 v[44:47], v[32:35], v[88:95], v1
    v_cvt_pk_bf16_f32 v40, v40, v42
    s_waitcnt lgkmcnt(2)
    v_smfmac_f32_16x16x64_bf16 v[44:47], v[48:51], v[112:119], v1
    v_cvt_pk_bf16_f32 v41, v41, v43
    s_waitcnt lgkmcnt(0)
    v_smfmac_f32_16x16x64_bf16 v[44:47], v[52:55], v[56:63], v1
    buffer_store_dwordx2 v[40:41], v9, s[8:11], s25 offen sc1
    s_nop 6
    v_cvt_pk_bf16_f32 v44, v44, v46
    v_cvt_pk_bf16_f32 v45, v45, v47
    buffer_store_dwordx2 v[44:45], v9, s[8:11], s19 offen sc1
    v_mov_b32 v24, 0
    v_mov_b32 v25, 0
    v_mov_b32 v26, 0
    v_mov_b32 v27, 0
    v_mov_b32 v28, 0
    v_mov_b32 v29, 0
    v_mov_b32 v30, 0
    v_mov_b32 v31, 0
    v_mov_b32 v116, -1
    v_mov_b32 v117, -1
    v_mov_b32 v118, -1
    v_mov_b32 v119, -1
    s_mov_b32 s35, s22
    s_mov_b32 s36, s24
    s_mov_b32 s7, s23
    s_mov_b32 s23, s21
    s_mov_b32 s21, s22
    s_add_u32 s5, s22, 0x2000
    s_and_b32 s5, s5, 0x7fff
    s_or_b32 s22, s5, 65536
    s_lshl_b32 s6, s3, 13
    s_add_u32 s18, s24, s6
    s_add_u32 s5, s24, 262144
    s_cmp_ge_u32 s5, 917504
    s_cselect_b32 s24, 131072, s5
    s_add_u32 s25, s24, 32768
    s_add_u32 s43, s24, 16384
    s_add_u32 s19, s24, 49152
    s_add_u32 s29, s29, 65536
    s_add_u32 s30, s30, 65536
    s_add_u32 s34, s27, 16777216
    s_add_u32 s27, s27, 8192
    s_xor_b32 s28, s28, 8192
    s_xor_b32 s61, s61, 8192
    s_mov_b32 s38, s31
    s_mov_b32 s39, s26
    s_lshl_b32 s5, s3, 4
    s_lshl_b32 s31, s16, 2
    s_add_u32 s31, s31, s5
    s_add_u32 s31, s31, 0
    s_add_u32 s5, s20, 3
    s_cmp_ge_u32 s5, 64
    s_cselect_b32 s26, 0, s17
    s_add_u32 s16, s16, 1
    s_cmp_eq_u32 s16, 3
    s_cselect_b32 s16, 0, s16
    s_addc_u32 s17, s17, 0
    s_add_u32 s20, s20, 1
    s_cmp_ge_u32 s4, 2
    s_cbranch_scc1 cs_w23
    s_mov_b32 s33, 0
    buffer_load_dwordx4 v[56:59], v10, s[8:11], s36 offen offset:0 sc1
    buffer_load_dwordx4 v[60:63], v10, s[8:11], s36 offen offset:1024 sc1
    buffer_load_dwordx4 v[64:67], v10, s[8:11], s36 offen offset:2048 sc1
    buffer_load_dwordx4 v[68:71], v10, s[8:11], s36 offen offset:3072 sc1
    v_mov_b32 v32, 0
    v_mov_b32 v33, 0
    v_mov_b32 v34, 0
    v_mov_b32 v35, 0
    v_mov_b32 v36, 0
    v_mov_b32 v37, 0
    v_mov_b32 v38, 0
    v_mov_b32 v39, 0
    v_mov_b32 v40, 0
    v_mov_b32 v41, 0
    v_mov_b32 v42, 0
    v_mov_b32 v43, 0
    v_mov_b32 v44, 0
    v_mov_b32 v45, 0
    v_mov_b32 v46, 0
    v_mov_b32 v47, 0
    buffer_load_dwordx4 v[80:83], v10, s[8:11], s36 offen offset:0 sc1
    buffer_load_dwordx4 v[84:87], v10, s[8:11], s36 offen offset:1024 sc1
    buffer_load_dwordx4 v[88:91], v10, s[8:11], s36 offen offset:2048 sc1
    buffer_load_dwordx4 v[92:95], v10, s[8:11], s36 offen offset:3072 sc1
cs_pi:
    s_waitcnt vmcnt(7)
    v_mfma_f32_16x16x32_bf16 v[72:75], v[12:15], v[56:59], 0
    v_max3_u32 v76, v56, v57, v58
    s_waitcnt vmcnt(6)
    v_mfma_f32_16x16x32_bf16 v[72:75], v[12:15], v[60:63], v[72:75]
    v_max3_u32 v77, v59, v60, v61
    v_max3_u32 v76, v76, v62, v63
    s_waitcnt vmcnt(5)
    v_mfma_f32_16x16x32_bf16 v[72:75], v[12:15], v[64:67], v[72:75]
    v_max3_u32 v77, v77, v64, v65
    v_max3_u32 v76, v76, v66, v67
    s_waitcnt vmcnt(4)
    v_mfma_f32_16x16x32_bf16 v[72:75], v[12:15], v[68:71], v[72:75]
    v_max3_u32 v77, v77, v68, v69
    v_max3_u32 v76, v76, v70, v71
    v_max_u32 v76, v76, v77
    v_cmp_eq_u32 vcc, -1, v76
    s_cbranch_vccnz cs_pi_retry
cs_pi_ok:
    s_mov_b32 vcc_lo, 0xff00ff00
    s_mov_b32 vcc_hi, 0xff00ff00
    s_nop 0
    v_add_f32_dpp v72, v72, v72 row_ror:8 row_mask:0xf bank_mask:0xf
    v_add_f32_dpp v73, v73, v73 row_ror:8 row_mask:0xf bank_mask:0xf
    v_add_f32_dpp v74, v74, v74 row_ror:8 row_mask:0xf bank_mask:0xf
    v_add_f32_dpp v75, v75, v75 row_ror:8 row_mask:0xf bank_mask:0xf
    v_cvt_pk_bf16_f32 v72, v72, v73
    v_cvt_pk_bf16_f32 v73, v74, v75
    v_cndmask_b32 v72, v72, v73, vcc
    buffer_store_dword v72, v11, s[8:11], s35 offen sc1
cs_join:
    s_barrier
    s_mov_b32 s33, 0
    buffer_load_dwordx4 v[48:51], v4, s[8:11], s21 offen sc1
    buffer_load_dwordx4 v[52:55], v4, s[8:11], s21 offen offset:1024 sc1
    s_waitcnt vmcnt(3)
    v_add_u32 v23, s61, v2
    ds_read_b128 v[80:83], v23 offset:0
    ds_read_b128 v[84:87], v23 offset:1024
    ds_read_b128 v[88:91], v23 offset:2048
    ds_read_b128 v[92:95], v23 offset:3072
    ds_read_b128 v[96:99], v23 offset:4096
    ds_read_b128 v[100:103], v23 offset:5120
    ds_read_b128 v[104:107], v23 offset:6144
    ds_read_b128 v[108:111], v23 offset:7168
    buffer_load_dwordx4 v[120:123], v4, s[8:11], s21 offen sc1
    buffer_load_dwordx4 v[124:127], v4, s[8:11], s21 offen offset:1024 sc1
    s_branch cs_step
cs_w23:
    v_mov_b32 v32, 0
    v_mov_b32 v33, 0
    v_mov_b32 v34, 0
    v_mov_b32 v35, 0
    v_mov_b32 v36, 0
    v_mov_b32 v37, 0
    v_mov_b32 v38, 0
    v_mov_b32 v39, 0
    v_mov_b32 v40, 0
    v_mov_b32 v41, 0
    v_mov_b32 v42, 0
    v_mov_b32 v43, 0
    v_mov_b32 v44, 0
    v_mov_b32 v45, 0
    v_mov_b32 v46, 0
    v_mov_b32 v47, 0
    s_waitcnt vmcnt(2)
    buffer_store_dword v116, v11, s[8:11], s7 offen sc1
    s_branch cs_join
cs_pm_retry:
    buffer_load_dwordx4 v[48:51], v4, s[8:11], s21 offen sc1
    buffer_load_dwordx4 v[52:55], v4, s[8:11], s21 offen offset:1024 sc1
    s_waitcnt vmcnt(2)
    v_max3_u32 v23, v120, v121, v122
    v_max3_u32 v56, v123, v124, v125
    v_max3_u32 v23, v23, v126, v127
    v_max_u32 v23, v23, v56
    v_cmp_eq_u32 vcc, -1, v23
    s_cbranch_vccz cs_pm_b
    buffer_load_dwordx4 v[120:123], v4, s[8:11], s21 offen sc1
    buffer_load_dwordx4 v[124:127], v4, s[8:11], s21 offen offset:1024 sc1
    s_add_u32 s33, s33, 1
    s_cmp_gt_u32 s33, 100000
    s_cbranch_scc0 cs_step
    s_add_u32 s37, s37, 1
    s_waitcnt vmcnt(0)
    s_branch cs_pm_ok
cs_pm_b:
    v_mov_b32 v48, v120
    v_mov_b32 v49, v121
    v_mov_b32 v50, v122
    v_mov_b32 v51, v123
    v_mov_b32 v52, v124
    v_mov_b32 v53, v125
    v_mov_b32 v54, v126
    v_mov_b32 v55, v127
    s_branch cs_pm_ok
cs_fs_slow:
    v_readfirstlane_b32 s5, v3
    s_nop 0
    s_cmp_ge_u32 s5, s39
    s_cbranch_scc1 cs_fs_5_ok
    s_mov_b32 s33, 0
cs_fs_5:
    v_mov_b32 v3, 0
    buffer_load_dword v3, v3, s[8:11], s38 offen sc1
    s_add_u32 s33, s33, 1
    s_cmp_gt_u32 s33, 0x8000
    s_cbranch_scc1 cs_fs_5_fail
    s_waitcnt vmcnt(0)
    v_readfirstlane_b32 s5, v3
    s_nop 0
    s_cmp_ge_u32 s5, s39
    s_cbranch_scc0 cs_fs_5
    s_branch cs_fs_5_ok
cs_fs_5_fail:
    s_add_u32 s37, s37, 1
    s_waitcnt vmcnt(0)
cs_fs_5_ok:
    s_branch cs_fs_ok
cs_pi_retry:
    buffer_load_dwordx4 v[56:59], v10, s[8:11], s36 offen offset:0 sc1
    buffer_load_dwordx4 v[60:63], v10, s[8:11], s36 offen offset:1024 sc1
    buffer_load_dwordx4 v[64:67], v10, s[8:11], s36 offen offset:2048 sc1
    buffer_load_dwordx4 v[68:71], v10, s[8:11], s36 offen offset:3072 sc1
    s_waitcnt vmcnt(7)
    v_mfma_f32_16x16x32_bf16 v[72:75], v[12:15], v[80:83], 0
    v_max3_u32 v76, v80, v81, v82
    s_waitcnt vmcnt(6)
    v_mfma_f32_16x16x32_bf16 v[72:75], v[12:15], v[84:87], v[72:75]
    v_max3_u32 v77, v83, v84, v85
    v_max3_u32 v76, v76, v86, v87
    s_waitcnt vmcnt(5)
    v_mfma_f32_16x16x32_bf16 v[72:75], v[12:15], v[88:91], v[72:75]
    v_max3_u32 v77, v77, v88, v89
    v_max3_u32 v76, v76, v90, v91
    s_waitcnt vmcnt(4)
    v_mfma_f32_16x16x32_bf16 v[72:75], v[12:15], v[92:95], v[72:75]
    v_max3_u32 v77, v77, v92, v93
    v_max3_u32 v76, v76, v94, v95
    v_max_u32 v76, v76, v77
    v_cmp_eq_u32 vcc, -1, v76
    s_cbranch_vccz cs_pi_ok
    buffer_load_dwordx4 v[80:83], v10, s[8:11], s36 offen offset:0 sc1
    buffer_load_dwordx4 v[84:87], v10, s[8:11], s36 offen offset:1024 sc1
    buffer_load_dwordx4 v[88:91], v10, s[8:11], s36 offen offset:2048 sc1
    buffer_load_dwordx4 v[92:95], v10, s[8:11], s36 offen offset:3072 sc1
    s_add_u32 s33, s33, 1
    s_cmp_gt_u32 s33, 100000
    s_cbranch_scc0 cs_pi
    s_add_u32 s37, s37, 1
    s_waitcnt vmcnt(0)
    s_branch cs_pi_ok
cs_done:
    s_waitcnt vmcnt(0)
    s_barrier
    s_cmp_lg_u32 s4, 2
    s_cbranch_scc1 cs_nfin
    v_mov_b32 v48, 64
    s_mov_b64 exec, 1
    buffer_store_dword v48, v2, s[8:11], s42 offen sc1
    s_mov_b64 exec, -1
    s_waitcnt vmcnt(0)
cs_nfin:
    s_endpgm
mg_wo:
    s_and_b32 s3, s6, 15
    s_lshr_b32 s6, s6, 4
    s_sub_u32 s5, s5, 1
    s_lshl_b32 s5, s5, 1
    s_add_u32 s16, s5, s6
    s_load_dwordx2 s[68:69], s[0:1], 96
    s_waitcnt lgkmcnt(0)
    s_mov_b32 s64, s68
    s_and_b32 s65, s69, 0xffff
    s_mov_b32 s66, 256
    s_mov_b32 s67, 0x20000
    s_and_b32 s5, s2, 7
    s_cmp_lg_u32 s5, 1
    s_cbranch_scc1 mg_wo_noln
    s_load_dwordx2 s[36:37], s[0:1], 0
    s_load_dwordx2 s[38:39], s[0:1], 104
    v_mov_b32 v100, v0
    v_lshrrev_b32 v1, 6, v0
    v_and_b32 v0, 63, v0
    v_readfirstlane_b32 s20, v1
    s_lshr_b32 s5, s2, 3
    s_lshl_b32 s5, s5, 2
    s_add_u32 s20, s20, s5
    s_waitcnt lgkmcnt(0)
    s_mov_b32 s8, s38
    s_and_b32 s9, s39, 0xffff
    s_mov_b32 s10, 268435456
    s_mov_b32 s11, 0x20000
    s_mov_b32 s12, s36
    s_and_b32 s13, s37, 0xffff
    s_mov_b32 s14, 2097152
    s_mov_b32 s15, 0x20000
    v_and_b32 v1, 15, v0
    v_lshrrev_b32 v2, 4, v0
    v_lshlrev_b32 v3, 10, v1
    v_lshl_add_u32 v3, v2, 4, v3
    s_lshl_b32 s5, s20, 14
    buffer_load_dwordx4 v[8:11], v3, s[12:15], s5 offen offset:0
    buffer_load_dwordx4 v[12:15], v3, s[12:15], s5 offen offset:64
    buffer_load_dwordx4 v[16:19], v3, s[12:15], s5 offen offset:128
    buffer_load_dwordx4 v[20:23], v3, s[12:15], s5 offen offset:192
    buffer_load_dwordx4 v[24:27], v3, s[12:15], s5 offen offset:256
    buffer_load_dwordx4 v[28:31], v3, s[12:15], s5 offen offset:320
    buffer_load_dwordx4 v[32:35], v3, s[12:15], s5 offen offset:384
    buffer_load_dwordx4 v[36:39], v3, s[12:15], s5 offen offset:448
    buffer_load_dwordx4 v[40:43], v3, s[12:15], s5 offen offset:512
    buffer_load_dwordx4 v[44:47], v3, s[12:15], s5 offen offset:576
    buffer_load_dwordx4 v[48:51], v3, s[12:15], s5 offen offset:640
    buffer_load_dwordx4 v[52:55], v3, s[12:15], s5 offen offset:704
    buffer_load_dwordx4 v[56:59], v3, s[12:15], s5 offen offset:768
    buffer_load_dwordx4 v[60:63], v3, s[12:15], s5 offen offset:832
    buffer_load_dwordx4 v[64:67], v3, s[12:15], s5 offen offset:896
    buffer_load_dwordx4 v[68:71], v3, s[12:15], s5 offen offset:960
    s_mov_b32 s6, 0x3f803f80
    v_mov_b32 v4, 0
    v_mov_b32 v5, 0
    s_waitcnt vmcnt(15)
    v_dot2_f32_bf16 v4, v8, s6, v4
    v_dot2_f32_bf16 v5, v9, s6, v5
    v_dot2_f32_bf16 v4, v10, s6, v4
    v_dot2_f32_bf16 v5, v11, s6, v5
    s_waitcnt vmcnt(14)
    v_dot2_f32_bf16 v4, v12, s6, v4
    v_dot2_f32_bf16 v5, v13, s6, v5
    v_dot2_f32_bf16 v4, v14, s6, v4
    v_dot2_f32_bf16 v5, v15, s6, v5
    s_waitcnt vmcnt(13)
    v_dot2_f32_bf16 v4, v16, s6, v4
    v_dot2_f32_bf16 v5, v17, s6, v5
    v_dot2_f32_bf16 v4, v18, s6, v4
    v_dot2_f32_bf16 v5, v19, s6, v5
    s_waitcnt vmcnt(12)
    v_dot2_f32_bf16 v4, v20, s6, v4
    v_dot2_f32_bf16 v5, v21, s6, v5
    v_dot2_f32_bf16 v4, v22, s6, v4
    v_dot2_f32_bf16 v5, v23, s6, v5
    s_waitcnt vmcnt(11)
    v_dot2_f32_bf16 v4, v24, s6, v4
    v_dot2_f32_bf16 v5, v25, s6, v5
    v_dot2_f32_bf16 v4, v26, s6, v4
    v_dot2_f32_bf16 v5, v27, s6, v5
    s_waitcnt vmcnt(10)
    v_dot2_f32_bf16 v4, v28, s6, v4
    v_dot2_f32_bf16 v5, v29, s6, v5
    v_dot2_f32_bf16 v4, v30, s6, v4
    v_dot2_f32_bf16 v5, v31, s6, v5
    s_waitcnt vmcnt(9)
    v_dot2_f32_bf16 v4, v32, s6, v4
    v_dot2_f32_bf16 v5, v33, s6, v5
    v_dot2_f32_bf16 v4, v34, s6, v4
    v_dot2_f32_bf16 v5, v35, s6, v5
    s_waitcnt vmcnt(8)
    v_dot2_f32_bf16 v4, v36, s6, v4
    v_dot2_f32_bf16 v5, v37, s6, v5
    v_dot2_f32_bf16 v4, v38, s6, v4
    v_dot2_f32_bf16 v5, v39, s6, v5
    s_waitcnt vmcnt(7)
    v_dot2_f32_bf16 v4, v40, s6, v4
    v_dot2_f32_bf16 v5, v41, s6, v5
    v_dot2_f32_bf16 v4, v42, s6, v4
    v_dot2_f32_bf16 v5, v43, s6, v5
    s_waitcnt vmcnt(6)
    v_dot2_f32_bf16 v4, v44, s6, v4
    v_dot2_f32_bf16 v5, v45, s6, v5
    v_dot2_f32_bf16 v4, v46, s6, v4
    v_dot2_f32_bf16 v5, v47, s6, v5
    s_waitcnt vmcnt(5)
    v_dot2_f32_bf16 v4, v48, s6, v4
    v_dot2_f32_bf16 v5, v49, s6, v5
    v_dot2_f32_bf16 v4, v50, s6, v4
    v_dot2_f32_bf16 v5, v51, s6, v5
    s_waitcnt vmcnt(4)
    v_dot2_f32_bf16 v4, v52, s6, v4
    v_dot2_f32_bf16 v5, v53, s6, v5
    v_dot2_f32_bf16 v4, v54, s6, v4
    v_dot2_f32_bf16 v5, v55, s6, v5
    s_waitcnt vmcnt(3)
    v_dot2_f32_bf16 v4, v56, s6, v4
    v_dot2_f32_bf16 v5, v57, s6, v5
    v_dot2_f32_bf16 v4, v58, s6, v4
    v_dot2_f32_bf16 v5, v59, s6, v5
    s_waitcnt vmcnt(2)
    v_dot2_f32_bf16 v4, v60, s6, v4
    v_dot2_f32_bf16 v5, v61, s6, v5
    v_dot2_f32_bf16 v4, v62, s6, v4
    v_dot2_f32_bf16 v5, v63, s6, v5
    s_waitcnt vmcnt(1)
    v_dot2_f32_bf16 v4, v64, s6, v4
    v_dot2_f32_bf16 v5, v65, s6, v5
    v_dot2_f32_bf16 v4, v66, s6, v4
    v_dot2_f32_bf16 v5, v67, s6, v5
    s_waitcnt vmcnt(0)
    v_dot2_f32_bf16 v4, v68, s6, v4
    v_dot2_f32_bf16 v5, v69, s6, v5
    v_dot2_f32_bf16 v4, v70, s6, v4
    v_dot2_f32_bf16 v5, v71, s6, v5
    s_nop 2
    v_add_f32 v4, v4, v5
    v_mov_b32 v5, v4
    s_nop 1
    v_permlane32_swap_b32 v4, v5
    v_add_f32 v4, v4, v5
    v_mov_b32 v5, v4
    s_nop 1
    v_permlane16_swap_b32 v4, v5
    v_add_f32 v4, v4, v5
    v_mul_f32 v4, 0x3b000000, v4
    v_mov_b32 v6, 0
    v_mov_b32 v7, 0
    v_lshlrev_b32 v72, 16, v8
    v_and_b32 v73, 0xffff0000, v8
    v_sub_f32 v72, v72, v4
    v_sub_f32 v73, v73, v4
    v_fmac_f32 v6, v72, v72
    v_fmac_f32 v7, v73, v73
    v_lshlrev_b32 v72, 16, v9
    v_and_b32 v73, 0xffff0000, v9
    v_sub_f32 v72, v72, v4
    v_sub_f32 v73, v73, v4
    v_fmac_f32 v6, v72, v72
    v_fmac_f32 v7, v73, v73
    v_lshlrev_b32 v72, 16, v10
    v_and_b32 v73, 0xffff0000, v10
    v_sub_f32 v72, v72, v4
    v_sub_f32 v73, v73, v4
    v_fmac_f32 v6, v72, v72
    v_fmac_f32 v7, v73, v73
    v_lshlrev_b32 v72, 16, v11
    v_and_b32 v73, 0xffff0000, v11
    v_sub_f32 v72, v72, v4
    v_sub_f32 v73, v73, v4
    v_fmac_f32 v6, v72, v72
    v_fmac_f32 v7, v73, v73
    v_lshlrev_b32 v72, 16, v12
    v_and_b32 v73, 0xffff0000, v12
    v_sub_f32 v72, v72, v4
    v_sub_f32 v73, v73, v4
    v_fmac_f32 v6, v72, v72
    v_fmac_f32 v7, v73, v73
    v_lshlrev_b32 v72, 16, v13
    v_and_b32 v73, 0xffff0000, v13
    v_sub_f32 v72, v72, v4
    v_sub_f32 v73, v73, v4
    v_fmac_f32 v6, v72, v72
    v_fmac_f32 v7, v73, v73
    v_lshlrev_b32 v72, 16, v14
    v_and_b32 v73, 0xffff0000, v14
    v_sub_f32 v72, v72, v4
    v_sub_f32 v73, v73, v4
    v_fmac_f32 v6, v72, v72
    v_fmac_f32 v7, v73, v73
    v_lshlrev_b32 v72, 16, v15
    v_and_b32 v73, 0xffff0000, v15
    v_sub_f32 v72, v72, v4
    v_sub_f32 v73, v73, v4
    v_fmac_f32 v6, v72, v72
    v_fmac_f32 v7, v73, v73
    v_lshlrev_b32 v72, 16, v16
    v_and_b32 v73, 0xffff0000, v16
    v_sub_f32 v72, v72, v4
    v_sub_f32 v73, v73, v4
    v_fmac_f32 v6, v72, v72
    v_fmac_f32 v7, v73, v73
    v_lshlrev_b32 v72, 16, v17
    v_and_b32 v73, 0xffff0000, v17
    v_sub_f32 v72, v72, v4
    v_sub_f32 v73, v73, v4
    v_fmac_f32 v6, v72, v72
    v_fmac_f32 v7, v73, v73
    v_lshlrev_b32 v72, 16, v18
    v_and_b32 v73, 0xffff0000, v18
    v_sub_f32 v72, v72, v4
    v_sub_f32 v73, v73, v4
    v_fmac_f32 v6, v72, v72
    v_fmac_f32 v7, v73, v73
    v_lshlrev_b32 v72, 16, v19
    v_and_b32 v73, 0xffff0000, v19
    v_sub_f32 v72, v72, v4
    v_sub_f32 v73, v73, v4
    v_fmac_f32 v6, v72, v72
    v_fmac_f32 v7, v73, v73
    v_lshlrev_b32 v72, 16, v20
    v_and_b32 v73, 0xffff0000, v20
    v_sub_f32 v72, v72, v4
    v_sub_f32 v73, v73, v4
    v_fmac_f32 v6, v72, v72
    v_fmac_f32 v7, v73, v73
    v_lshlrev_b32 v72, 16, v21
    v_and_b32 v73, 0xffff0000, v21
    v_sub_f32 v72, v72, v4
    v_sub_f32 v73, v73, v4
    v_fmac_f32 v6, v72, v72
    v_fmac_f32 v7, v73, v73
    v_lshlrev_b32 v72, 16, v22
    v_and_b32 v73, 0xffff0000, v22
    v_sub_f32 v72, v72, v4
    v_sub_f32 v73, v73, v4
    v_fmac_f32 v6, v72, v72
    v_fmac_f32 v7, v73, v73
    v_lshlrev_b32 v72, 16, v23
    v_and_b32 v73, 0xffff0000, v23
    v_sub_f32 v72, v72, v4
    v_sub_f32 v73, v73, v4
    v_fmac_f32 v6, v72, v72
    v_fmac_f32 v7, v73, v73
    v_lshlrev_b32 v72, 16, v24
    v_and_b32 v73, 0xffff0000, v24
    v_sub_f32 v72, v72, v4
    v_sub_f32 v73, v73, v4
    v_fmac_f32 v6, v72, v72
    v_fmac_f32 v7, v73, v73
    v_lshlrev_b32 v72, 16, v25
    v_and_b32 v73, 0xffff0000, v25
    v_sub_f32 v72, v72, v4
    v_sub_f32 v73, v73, v4
    v_fmac_f32 v6, v72, v72
    v_fmac_f32 v7, v73, v73
    v_lshlrev_b32 v72, 16, v26
    v_and_b32 v73, 0xffff0000, v26
    v_sub_f32 v72, v72, v4
    v_sub_f32 v73, v73, v4
    v_fmac_f32 v6, v72, v72
    v_fmac_f32 v7, v73, v73
    v_lshlrev_b32 v72, 16, v27
    v_and_b32 v73, 0xffff0000, v27
    v_sub_f32 v72, v72, v4
    v_sub_f32 v73, v73, v4
    v_fmac_f32 v6, v72, v72
    v_fmac_f32 v7, v73, v73
    v_lshlrev_b32 v72, 16, v28
    v_and_b32 v73, 0xffff0000, v28
    v_sub_f32 v72, v72, v4
    v_sub_f32 v73, v73, v4
    v_fmac_f32 v6, v72, v72
    v_fmac_f32 v7, v73, v73
    v_lshlrev_b32 v72, 16, v29
    v_and_b32 v73, 0xffff0000, v29
    v_sub_f32 v72, v72, v4
    v_sub_f32 v73, v73, v4
    v_fmac_f32 v6, v72, v72
    v_fmac_f32 v7, v73, v73
    v_lshlrev_b32 v72, 16, v30
    v_and_b32 v73, 0xffff0000, v30
    v_sub_f32 v72, v72, v4
    v_sub_f32 v73, v73, v4
    v_fmac_f32 v6, v72, v72
    v_fmac_f32 v7, v73, v73
    v_lshlrev_b32 v72, 16, v31
    v_and_b32 v73, 0xffff0000, v31
    v_sub_f32 v72, v72, v4
    v_sub_f32 v73, v73, v4
    v_fmac_f32 v6, v72, v72
    v_fmac_f32 v7, v73, v73
    v_lshlrev_b32 v72, 16, v32
    v_and_b32 v73, 0xffff0000, v32
    v_sub_f32 v72, v72, v4
    v_sub_f32 v73, v73, v4
    v_fmac_f32 v6, v72, v72
    v_fmac_f32 v7, v73, v73
    v_lshlrev_b32 v72, 16, v33
    v_and_b32 v73, 0xffff0000, v33
    v_sub_f32 v72, v72, v4
    v_sub_f32 v73, v73, v4
    v_fmac_f32 v6, v72, v72
    v_fmac_f32 v7, v73, v73
    v_lshlrev_b32 v72, 16, v34
    v_and_b32 v73, 0xffff0000, v34
    v_sub_f32 v72, v72, v4
    v_sub_f32 v73, v73, v4
    v_fmac_f32 v6, v72, v72
    v_fmac_f32 v7, v73, v73
    v_lshlrev_b32 v72, 16, v35
    v_and_b32 v73, 0xffff0000, v35
    v_sub_f32 v72, v72, v4
    v_sub_f32 v73, v73, v4
    v_fmac_f32 v6, v72, v72
    v_fmac_f32 v7, v73, v73
    v_lshlrev_b32 v72, 16, v36
    v_and_b32 v73, 0xffff0000, v36
    v_sub_f32 v72, v72, v4
    v_sub_f32 v73, v73, v4
    v_fmac_f32 v6, v72, v72
    v_fmac_f32 v7, v73, v73
    v_lshlrev_b32 v72, 16, v37
    v_and_b32 v73, 0xffff0000, v37
    v_sub_f32 v72, v72, v4
    v_sub_f32 v73, v73, v4
    v_fmac_f32 v6, v72, v72
    v_fmac_f32 v7, v73, v73
    v_lshlrev_b32 v72, 16, v38
    v_and_b32 v73, 0xffff0000, v38
    v_sub_f32 v72, v72, v4
    v_sub_f32 v73, v73, v4
    v_fmac_f32 v6, v72, v72
    v_fmac_f32 v7, v73, v73
    v_lshlrev_b32 v72, 16, v39
    v_and_b32 v73, 0xffff0000, v39
    v_sub_f32 v72, v72, v4
    v_sub_f32 v73, v73, v4
    v_fmac_f32 v6, v72, v72
    v_fmac_f32 v7, v73, v73
    v_lshlrev_b32 v72, 16, v40
    v_and_b32 v73, 0xffff0000, v40
    v_sub_f32 v72, v72, v4
    v_sub_f32 v73, v73, v4
    v_fmac_f32 v6, v72, v72
    v_fmac_f32 v7, v73, v73
    v_lshlrev_b32 v72, 16, v41
    v_and_b32 v73, 0xffff0000, v41
    v_sub_f32 v72, v72, v4
    v_sub_f32 v73, v73, v4
    v_fmac_f32 v6, v72, v72
    v_fmac_f32 v7, v73, v73
    v_lshlrev_b32 v72, 16, v42
    v_and_b32 v73, 0xffff0000, v42
    v_sub_f32 v72, v72, v4
    v_sub_f32 v73, v73, v4
    v_fmac_f32 v6, v72, v72
    v_fmac_f32 v7, v73, v73
    v_lshlrev_b32 v72, 16, v43
    v_and_b32 v73, 0xffff0000, v43
    v_sub_f32 v72, v72, v4
    v_sub_f32 v73, v73, v4
    v_fmac_f32 v6, v72, v72
    v_fmac_f32 v7, v73, v73
    v_lshlrev_b32 v72, 16, v44
    v_and_b32 v73, 0xffff0000, v44
    v_sub_f32 v72, v72, v4
    v_sub_f32 v73, v73, v4
    v_fmac_f32 v6, v72, v72
    v_fmac_f32 v7, v73, v73
    v_lshlrev_b32 v72, 16, v45
    v_and_b32 v73, 0xffff0000, v45
    v_sub_f32 v72, v72, v4
    v_sub_f32 v73, v73, v4
    v_fmac_f32 v6, v72, v72
    v_fmac_f32 v7, v73, v73
    v_lshlrev_b32 v72, 16, v46
    v_and_b32 v73, 0xffff0000, v46
    v_sub_f32 v72, v72, v4
    v_sub_f32 v73, v73, v4
    v_fmac_f32 v6, v72, v72
    v_fmac_f32 v7, v73, v73
    v_lshlrev_b32 v72, 16, v47
    v_and_b32 v73, 0xffff0000, v47
    v_sub_f32 v72, v72, v4
    v_sub_f32 v73, v73, v4
    v_fmac_f32 v6, v72, v72
    v_fmac_f32 v7, v73, v73
    v_lshlrev_b32 v72, 16, v48
    v_and_b32 v73, 0xffff0000, v48
    v_sub_f32 v72, v72, v4
    v_sub_f32 v73, v73, v4
    v_fmac_f32 v6, v72, v72
    v_fmac_f32 v7, v73, v73
    v_lshlrev_b32 v72, 16, v49
    v_and_b32 v73, 0xffff0000, v49
    v_sub_f32 v72, v72, v4
    v_sub_f32 v73, v73, v4
    v_fmac_f32 v6, v72, v72
    v_fmac_f32 v7, v73, v73
    v_lshlrev_b32 v72, 16, v50
    v_and_b32 v73, 0xffff0000, v50
    v_sub_f32 v72, v72, v4
    v_sub_f32 v73, v73, v4
    v_fmac_f32 v6, v72, v72
    v_fmac_f32 v7, v73, v73
    v_lshlrev_b32 v72, 16, v51
    v_and_b32 v73, 0xffff0000, v51
    v_sub_f32 v72, v72, v4
    v_sub_f32 v73, v73, v4
    v_fmac_f32 v6, v72, v72
    v_fmac_f32 v7, v73, v73
    v_lshlrev_b32 v72, 16, v52
    v_and_b32 v73, 0xffff0000, v52
    v_sub_f32 v72, v72, v4
    v_sub_f32 v73, v73, v4
    v_fmac_f32 v6, v72, v72
    v_fmac_f32 v7, v73, v73
    v_lshlrev_b32 v72, 16, v53
    v_and_b32 v73, 0xffff0000, v53
    v_sub_f32 v72, v72, v4
    v_sub_f32 v73, v73, v4
    v_fmac_f32 v6, v72, v72
    v_fmac_f32 v7, v73, v73
    v_lshlrev_b32 v72, 16, v54
    v_and_b32 v73, 0xffff0000, v54
    v_sub_f32 v72, v72, v4
    v_sub_f32 v73, v73, v4
    v_fmac_f32 v6, v72, v72
    v_fmac_f32 v7, v73, v73
    v_lshlrev_b32 v72, 16, v55
    v_and_b32 v73, 0xffff0000, v55
    v_sub_f32 v72, v72, v4
    v_sub_f32 v73, v73, v4
    v_fmac_f32 v6, v72, v72
    v_fmac_f32 v7, v73, v73
    v_lshlrev_b32 v72, 16, v56
    v_and_b32 v73, 0xffff0000, v56
    v_sub_f32 v72, v72, v4
    v_sub_f32 v73, v73, v4
    v_fmac_f32 v6, v72, v72
    v_fmac_f32 v7, v73, v73
    v_lshlrev_b32 v72, 16, v57
    v_and_b32 v73, 0xffff0000, v57
    v_sub_f32 v72, v72, v4
    v_sub_f32 v73, v73, v4
    v_fmac_f32 v6, v72, v72
    v_fmac_f32 v7, v73, v73
    v_lshlrev_b32 v72, 16, v58
    v_and_b32 v73, 0xffff0000, v58
    v_sub_f32 v72, v72, v4
    v_sub_f32 v73, v73, v4
    v_fmac_f32 v6, v72, v72
    v_fmac_f32 v7, v73, v73
    v_lshlrev_b32 v72, 16, v59
    v_and_b32 v73, 0xffff0000, v59
    v_sub_f32 v72, v72, v4
    v_sub_f32 v73, v73, v4
    v_fmac_f32 v6, v72, v72
    v_fmac_f32 v7, v73, v73
    v_lshlrev_b32 v72, 16, v60
    v_and_b32 v73, 0xffff0000, v60
    v_sub_f32 v72, v72, v4
    v_sub_f32 v73, v73, v4
    v_fmac_f32 v6, v72, v72
    v_fmac_f32 v7, v73, v73
    v_lshlrev_b32 v72, 16, v61
    v_and_b32 v73, 0xffff0000, v61
    v_sub_f32 v72, v72, v4
    v_sub_f32 v73, v73, v4
    v_fmac_f32 v6, v72, v72
    v_fmac_f32 v7, v73, v73
    v_lshlrev_b32 v72, 16, v62
    v_and_b32 v73, 0xffff0000, v62
    v_sub_f32 v72, v72, v4
    v_sub_f32 v73, v73, v4
    v_fmac_f32 v6, v72, v72
    v_fmac_f32 v7, v73, v73
    v_lshlrev_b32 v72, 16, v63
    v_and_b32 v73, 0xffff0000, v63
    v_sub_f32 v72, v72, v4
    v_sub_f32 v73, v73, v4
    v_fmac_f32 v6, v72, v72
    v_fmac_f32 v7, v73, v73
    v_lshlrev_b32 v72, 16, v64
    v_and_b32 v73, 0xffff0000, v64
    v_sub_f32 v72, v72, v4
    v_sub_f32 v73, v73, v4
    v_fmac_f32 v6, v72, v72
    v_fmac_f32 v7, v73, v73
    v_lshlrev_b32 v72, 16, v65
    v_and_b32 v73, 0xffff0000, v65
    v_sub_f32 v72, v72, v4
    v_sub_f32 v73, v73, v4
    v_fmac_f32 v6, v72, v72
    v_fmac_f32 v7, v73, v73
    v_lshlrev_b32 v72, 16, v66
    v_and_b32 v73, 0xffff0000, v66
    v_sub_f32 v72, v72, v4
    v_sub_f32 v73, v73, v4
    v_fmac_f32 v6, v72, v72
    v_fmac_f32 v7, v73, v73
    v_lshlrev_b32 v72, 16, v67
    v_and_b32 v73, 0xffff0000, v67
    v_sub_f32 v72, v72, v4
    v_sub_f32 v73, v73, v4
    v_fmac_f32 v6, v72, v72
    v_fmac_f32 v7, v73, v73
    v_lshlrev_b32 v72, 16, v68
    v_and_b32 v73, 0xffff0000, v68
    v_sub_f32 v72, v72, v4
    v_sub_f32 v73, v73, v4
    v_fmac_f32 v6, v72, v72
    v_fmac_f32 v7, v73, v73
    v_lshlrev_b32 v72, 16, v69
    v_and_b32 v73, 0xffff0000, v69
    v_sub_f32 v72, v72, v4
    v_sub_f32 v73, v73, v4
    v_fmac_f32 v6, v72, v72
    v_fmac_f32 v7, v73, v73
    v_lshlrev_b32 v72, 16, v70
    v_and_b32 v73, 0xffff0000, v70
    v_sub_f32 v72, v72, v4
    v_sub_f32 v73, v73, v4
    v_fmac_f32 v6, v72, v72
    v_fmac_f32 v7, v73, v73
    v_lshlrev_b32 v72, 16, v71
    v_and_b32 v73, 0xffff0000, v71
    v_sub_f32 v72, v72, v4
    v_sub_f32 v73, v73, v4
    v_fmac_f32 v6, v72, v72
    v_fmac_f32 v7, v73, v73
    v_add_f32 v6, v6, v7
    v_mov_b32 v7, v6
    s_nop 1
    v_permlane32_swap_b32 v6, v7
    v_add_f32 v6, v6, v7
    v_mov_b32 v7, v6
    s_nop 1
    v_permlane16_swap_b32 v6, v7
    v_add_f32 v6, v6, v7
    v_mul_f32 v6, 0x3b000000, v6
    v_cvt_pk_bf16_f32 v7, v6, v6
    v_lshlrev_b32 v6, 16, v7
    v_add_f32 v6, 0x3727c5ac, v6
    v_cvt_pk_bf16_f32 v7, v6, v6
    v_lshlrev_b32 v6, 16, v7
    v_sqrt_f32 v6, v6
    s_nop 0
    v_cvt_pk_bf16_f32 v7, v6, v6
    v_lshlrev_b32 v6, 16, v7
    v_rcp_f32 v6, v6
    v_cvt_pk_bf16_f32 v7, v4, v4
    v_lshlrev_b32 v4, 16, v7
    v_lshlrev_b32 v72, 16, v8
    v_and_b32 v73, 0xffff0000, v8
    v_sub_f32 v72, v72, v4
    v_sub_f32 v73, v73, v4
    v_cvt_pk_bf16_f32 v72, v72, v73
    v_and_b32 v73, 0xffff0000, v72
    v_lshlrev_b32 v72, 16, v72
    v_mul_f32 v72, v72, v6
    v_mul_f32 v73, v73, v6
    v_cvt_pk_bf16_f32 v8, v72, v73
    v_lshlrev_b32 v72, 16, v9
    v_and_b32 v73, 0xffff0000, v9
    v_sub_f32 v72, v72, v4
    v_sub_f32 v73, v73, v4
    v_cvt_pk_bf16_f32 v72, v72, v73
    v_and_b32 v73, 0xffff0000, v72
    v_lshlrev_b32 v72, 16, v72
    v_mul_f32 v72, v72, v6
    v_mul_f32 v73, v73, v6
    v_cvt_pk_bf16_f32 v9, v72, v73
    v_lshlrev_b32 v72, 16, v10
    v_and_b32 v73, 0xffff0000, v10
    v_sub_f32 v72, v72, v4
    v_sub_f32 v73, v73, v4
    v_cvt_pk_bf16_f32 v72, v72, v73
    v_and_b32 v73, 0xffff0000, v72
    v_lshlrev_b32 v72, 16, v72
    v_mul_f32 v72, v72, v6
    v_mul_f32 v73, v73, v6
    v_cvt_pk_bf16_f32 v10, v72, v73
    v_lshlrev_b32 v72, 16, v11
    v_and_b32 v73, 0xffff0000, v11
    v_sub_f32 v72, v72, v4
    v_sub_f32 v73, v73, v4
    v_cvt_pk_bf16_f32 v72, v72, v73
    v_and_b32 v73, 0xffff0000, v72
    v_lshlrev_b32 v72, 16, v72
    v_mul_f32 v72, v72, v6
    v_mul_f32 v73, v73, v6
    v_cvt_pk_bf16_f32 v11, v72, v73
    v_lshlrev_b32 v72, 16, v12
    v_and_b32 v73, 0xffff0000, v12
    v_sub_f32 v72, v72, v4
    v_sub_f32 v73, v73, v4
    v_cvt_pk_bf16_f32 v72, v72, v73
    v_and_b32 v73, 0xffff0000, v72
    v_lshlrev_b32 v72, 16, v72
    v_mul_f32 v72, v72, v6
    v_mul_f32 v73, v73, v6
    v_cvt_pk_bf16_f32 v12, v72, v73
    v_lshlrev_b32 v72, 16, v13
    v_and_b32 v73, 0xffff0000, v13
    v_sub_f32 v72, v72, v4
    v_sub_f32 v73, v73, v4
    v_cvt_pk_bf16_f32 v72, v72, v73
    v_and_b32 v73, 0xffff0000, v72
    v_lshlrev_b32 v72, 16, v72
    v_mul_f32 v72, v72, v6
    v_mul_f32 v73, v73, v6
    v_cvt_pk_bf16_f32 v13, v72, v73
    v_lshlrev_b32 v72, 16, v14
    v_and_b32 v73, 0xffff0000, v14
    v_sub_f32 v72, v72, v4
    v_sub_f32 v73, v73, v4
    v_cvt_pk_bf16_f32 v72, v72, v73
    v_and_b32 v73, 0xffff0000, v72
    v_lshlrev_b32 v72, 16, v72
    v_mul_f32 v72, v72, v6
    v_mul_f32 v73, v73, v6
    v_cvt_pk_bf16_f32 v14, v72, v73
    v_lshlrev_b32 v72, 16, v15
    v_and_b32 v73, 0xffff0000, v15
    v_sub_f32 v72, v72, v4
    v_sub_f32 v73, v73, v4
    v_cvt_pk_bf16_f32 v72, v72, v73
    v_and_b32 v73, 0xffff0000, v72
    v_lshlrev_b32 v72, 16, v72
    v_mul_f32 v72, v72, v6
    v_mul_f32 v73, v73, v6
    v_cvt_pk_bf16_f32 v15, v72, v73
    v_lshlrev_b32 v72, 16, v16
    v_and_b32 v73, 0xffff0000, v16
    v_sub_f32 v72, v72, v4
    v_sub_f32 v73, v73, v4
    v_cvt_pk_bf16_f32 v72, v72, v73
    v_and_b32 v73, 0xffff0000, v72
    v_lshlrev_b32 v72, 16, v72
    v_mul_f32 v72, v72, v6
    v_mul_f32 v73, v73, v6
    v_cvt_pk_bf16_f32 v16, v72, v73
    v_lshlrev_b32 v72, 16, v17
    v_and_b32 v73, 0xffff0000, v17
    v_sub_f32 v72, v72, v4
    v_sub_f32 v73, v73, v4
    v_cvt_pk_bf16_f32 v72, v72, v73
    v_and_b32 v73, 0xffff0000, v72
    v_lshlrev_b32 v72, 16, v72
    v_mul_f32 v72, v72, v6
    v_mul_f32 v73, v73, v6
    v_cvt_pk_bf16_f32 v17, v72, v73
    v_lshlrev_b32 v72, 16, v18
    v_and_b32 v73, 0xffff0000, v18
    v_sub_f32 v72, v72, v4
    v_sub_f32 v73, v73, v4
    v_cvt_pk_bf16_f32 v72, v72, v73
    v_and_b32 v73, 0xffff0000, v72
    v_lshlrev_b32 v72, 16, v72
    v_mul_f32 v72, v72, v6
    v_mul_f32 v73, v73, v6
    v_cvt_pk_bf16_f32 v18, v72, v73
    v_lshlrev_b32 v72, 16, v19
    v_and_b32 v73, 0xffff0000, v19
    v_sub_f32 v72, v72, v4
    v_sub_f32 v73, v73, v4
    v_cvt_pk_bf16_f32 v72, v72, v73
    v_and_b32 v73, 0xffff0000, v72
    v_lshlrev_b32 v72, 16, v72
    v_mul_f32 v72, v72, v6
    v_mul_f32 v73, v73, v6
    v_cvt_pk_bf16_f32 v19, v72, v73
    v_lshlrev_b32 v72, 16, v20
    v_and_b32 v73, 0xffff0000, v20
    v_sub_f32 v72, v72, v4
    v_sub_f32 v73, v73, v4
    v_cvt_pk_bf16_f32 v72, v72, v73
    v_and_b32 v73, 0xffff0000, v72
    v_lshlrev_b32 v72, 16, v72
    v_mul_f32 v72, v72, v6
    v_mul_f32 v73, v73, v6
    v_cvt_pk_bf16_f32 v20, v72, v73
    v_lshlrev_b32 v72, 16, v21
    v_and_b32 v73, 0xffff0000, v21
    v_sub_f32 v72, v72, v4
    v_sub_f32 v73, v73, v4
    v_cvt_pk_bf16_f32 v72, v72, v73
    v_and_b32 v73, 0xffff0000, v72
    v_lshlrev_b32 v72, 16, v72
    v_mul_f32 v72, v72, v6
    v_mul_f32 v73, v73, v6
    v_cvt_pk_bf16_f32 v21, v72, v73
    v_lshlrev_b32 v72, 16, v22
    v_and_b32 v73, 0xffff0000, v22
    v_sub_f32 v72, v72, v4
    v_sub_f32 v73, v73, v4
    v_cvt_pk_bf16_f32 v72, v72, v73
    v_and_b32 v73, 0xffff0000, v72
    v_lshlrev_b32 v72, 16, v72
    v_mul_f32 v72, v72, v6
    v_mul_f32 v73, v73, v6
    v_cvt_pk_bf16_f32 v22, v72, v73
    v_lshlrev_b32 v72, 16, v23
    v_and_b32 v73, 0xffff0000, v23
    v_sub_f32 v72, v72, v4
    v_sub_f32 v73, v73, v4
    v_cvt_pk_bf16_f32 v72, v72, v73
    v_and_b32 v73, 0xffff0000, v72
    v_lshlrev_b32 v72, 16, v72
    v_mul_f32 v72, v72, v6
    v_mul_f32 v73, v73, v6
    v_cvt_pk_bf16_f32 v23, v72, v73
    v_lshlrev_b32 v72, 16, v24
    v_and_b32 v73, 0xffff0000, v24
    v_sub_f32 v72, v72, v4
    v_sub_f32 v73, v73, v4
    v_cvt_pk_bf16_f32 v72, v72, v73
    v_and_b32 v73, 0xffff0000, v72
    v_lshlrev_b32 v72, 16, v72
    v_mul_f32 v72, v72, v6
    v_mul_f32 v73, v73, v6
    v_cvt_pk_bf16_f32 v24, v72, v73
    v_lshlrev_b32 v72, 16, v25
    v_and_b32 v73, 0xffff0000, v25
    v_sub_f32 v72, v72, v4
    v_sub_f32 v73, v73, v4
    v_cvt_pk_bf16_f32 v72, v72, v73
    v_and_b32 v73, 0xffff0000, v72
    v_lshlrev_b32 v72, 16, v72
    v_mul_f32 v72, v72, v6
    v_mul_f32 v73, v73, v6
    v_cvt_pk_bf16_f32 v25, v72, v73
    v_lshlrev_b32 v72, 16, v26
    v_and_b32 v73, 0xffff0000, v26
    v_sub_f32 v72, v72, v4
    v_sub_f32 v73, v73, v4
    v_cvt_pk_bf16_f32 v72, v72, v73
    v_and_b32 v73, 0xffff0000, v72
    v_lshlrev_b32 v72, 16, v72
    v_mul_f32 v72, v72, v6
    v_mul_f32 v73, v73, v6
    v_cvt_pk_bf16_f32 v26, v72, v73
    v_lshlrev_b32 v72, 16, v27
    v_and_b32 v73, 0xffff0000, v27
    v_sub_f32 v72, v72, v4
    v_sub_f32 v73, v73, v4
    v_cvt_pk_bf16_f32 v72, v72, v73
    v_and_b32 v73, 0xffff0000, v72
    v_lshlrev_b32 v72, 16, v72
    v_mul_f32 v72, v72, v6
    v_mul_f32 v73, v73, v6
    v_cvt_pk_bf16_f32 v27, v72, v73
    v_lshlrev_b32 v72, 16, v28
    v_and_b32 v73, 0xffff0000, v28
    v_sub_f32 v72, v72, v4
    v_sub_f32 v73, v73, v4
    v_cvt_pk_bf16_f32 v72, v72, v73
    v_and_b32 v73, 0xffff0000, v72
    v_lshlrev_b32 v72, 16, v72
    v_mul_f32 v72, v72, v6
    v_mul_f32 v73, v73, v6
    v_cvt_pk_bf16_f32 v28, v72, v73
    v_lshlrev_b32 v72, 16, v29
    v_and_b32 v73, 0xffff0000, v29
    v_sub_f32 v72, v72, v4
    v_sub_f32 v73, v73, v4
    v_cvt_pk_bf16_f32 v72, v72, v73
    v_and_b32 v73, 0xffff0000, v72
    v_lshlrev_b32 v72, 16, v72
    v_mul_f32 v72, v72, v6
    v_mul_f32 v73, v73, v6
    v_cvt_pk_bf16_f32 v29, v72, v73
    v_lshlrev_b32 v72, 16, v30
    v_and_b32 v73, 0xffff0000, v30
    v_sub_f32 v72, v72, v4
    v_sub_f32 v73, v73, v4
    v_cvt_pk_bf16_f32 v72, v72, v73
    v_and_b32 v73, 0xffff0000, v72
    v_lshlrev_b32 v72, 16, v72
    v_mul_f32 v72, v72, v6
    v_mul_f32 v73, v73, v6
    v_cvt_pk_bf16_f32 v30, v72, v73
    v_lshlrev_b32 v72, 16, v31
    v_and_b32 v73, 0xffff0000, v31
    v_sub_f32 v72, v72, v4
    v_sub_f32 v73, v73, v4
    v_cvt_pk_bf16_f32 v72, v72, v73
    v_and_b32 v73, 0xffff0000, v72
    v_lshlrev_b32 v72, 16, v72
    v_mul_f32 v72, v72, v6
    v_mul_f32 v73, v73, v6
    v_cvt_pk_bf16_f32 v31, v72, v73
    v_lshlrev_b32 v72, 16, v32
    v_and_b32 v73, 0xffff0000, v32
    v_sub_f32 v72, v72, v4
    v_sub_f32 v73, v73, v4
    v_cvt_pk_bf16_f32 v72, v72, v73
    v_and_b32 v73, 0xffff0000, v72
    v_lshlrev_b32 v72, 16, v72
    v_mul_f32 v72, v72, v6
    v_mul_f32 v73, v73, v6
    v_cvt_pk_bf16_f32 v32, v72, v73
    v_lshlrev_b32 v72, 16, v33
    v_and_b32 v73, 0xffff0000, v33
    v_sub_f32 v72, v72, v4
    v_sub_f32 v73, v73, v4
    v_cvt_pk_bf16_f32 v72, v72, v73
    v_and_b32 v73, 0xffff0000, v72
    v_lshlrev_b32 v72, 16, v72
    v_mul_f32 v72, v72, v6
    v_mul_f32 v73, v73, v6
    v_cvt_pk_bf16_f32 v33, v72, v73
    v_lshlrev_b32 v72, 16, v34
    v_and_b32 v73, 0xffff0000, v34
    v_sub_f32 v72, v72, v4
    v_sub_f32 v73, v73, v4
    v_cvt_pk_bf16_f32 v72, v72, v73
    v_and_b32 v73, 0xffff0000, v72
    v_lshlrev_b32 v72, 16, v72
    v_mul_f32 v72, v72, v6
    v_mul_f32 v73, v73, v6
    v_cvt_pk_bf16_f32 v34, v72, v73
    v_lshlrev_b32 v72, 16, v35
    v_and_b32 v73, 0xffff0000, v35
    v_sub_f32 v72, v72, v4
    v_sub_f32 v73, v73, v4
    v_cvt_pk_bf16_f32 v72, v72, v73
    v_and_b32 v73, 0xffff0000, v72
    v_lshlrev_b32 v72, 16, v72
    v_mul_f32 v72, v72, v6
    v_mul_f32 v73, v73, v6
    v_cvt_pk_bf16_f32 v35, v72, v73
    v_lshlrev_b32 v72, 16, v36
    v_and_b32 v73, 0xffff0000, v36
    v_sub_f32 v72, v72, v4
    v_sub_f32 v73, v73, v4
    v_cvt_pk_bf16_f32 v72, v72, v73
    v_and_b32 v73, 0xffff0000, v72
    v_lshlrev_b32 v72, 16, v72
    v_mul_f32 v72, v72, v6
    v_mul_f32 v73, v73, v6
    v_cvt_pk_bf16_f32 v36, v72, v73
    v_lshlrev_b32 v72, 16, v37
    v_and_b32 v73, 0xffff0000, v37
    v_sub_f32 v72, v72, v4
    v_sub_f32 v73, v73, v4
    v_cvt_pk_bf16_f32 v72, v72, v73
    v_and_b32 v73, 0xffff0000, v72
    v_lshlrev_b32 v72, 16, v72
    v_mul_f32 v72, v72, v6
    v_mul_f32 v73, v73, v6
    v_cvt_pk_bf16_f32 v37, v72, v73
    v_lshlrev_b32 v72, 16, v38
    v_and_b32 v73, 0xffff0000, v38
    v_sub_f32 v72, v72, v4
    v_sub_f32 v73, v73, v4
    v_cvt_pk_bf16_f32 v72, v72, v73
    v_and_b32 v73, 0xffff0000, v72
    v_lshlrev_b32 v72, 16, v72
    v_mul_f32 v72, v72, v6
    v_mul_f32 v73, v73, v6
    v_cvt_pk_bf16_f32 v38, v72, v73
    v_lshlrev_b32 v72, 16, v39
    v_and_b32 v73, 0xffff0000, v39
    v_sub_f32 v72, v72, v4
    v_sub_f32 v73, v73, v4
    v_cvt_pk_bf16_f32 v72, v72, v73
    v_and_b32 v73, 0xffff0000, v72
    v_lshlrev_b32 v72, 16, v72
    v_mul_f32 v72, v72, v6
    v_mul_f32 v73, v73, v6
    v_cvt_pk_bf16_f32 v39, v72, v73
    v_lshlrev_b32 v72, 16, v40
    v_and_b32 v73, 0xffff0000, v40
    v_sub_f32 v72, v72, v4
    v_sub_f32 v73, v73, v4
    v_cvt_pk_bf16_f32 v72, v72, v73
    v_and_b32 v73, 0xffff0000, v72
    v_lshlrev_b32 v72, 16, v72
    v_mul_f32 v72, v72, v6
    v_mul_f32 v73, v73, v6
    v_cvt_pk_bf16_f32 v40, v72, v73
    v_lshlrev_b32 v72, 16, v41
    v_and_b32 v73, 0xffff0000, v41
    v_sub_f32 v72, v72, v4
    v_sub_f32 v73, v73, v4
    v_cvt_pk_bf16_f32 v72, v72, v73
    v_and_b32 v73, 0xffff0000, v72
    v_lshlrev_b32 v72, 16, v72
    v_mul_f32 v72, v72, v6
    v_mul_f32 v73, v73, v6
    v_cvt_pk_bf16_f32 v41, v72, v73
    v_lshlrev_b32 v72, 16, v42
    v_and_b32 v73, 0xffff0000, v42
    v_sub_f32 v72, v72, v4
    v_sub_f32 v73, v73, v4
    v_cvt_pk_bf16_f32 v72, v72, v73
    v_and_b32 v73, 0xffff0000, v72
    v_lshlrev_b32 v72, 16, v72
    v_mul_f32 v72, v72, v6
    v_mul_f32 v73, v73, v6
    v_cvt_pk_bf16_f32 v42, v72, v73
    v_lshlrev_b32 v72, 16, v43
    v_and_b32 v73, 0xffff0000, v43
    v_sub_f32 v72, v72, v4
    v_sub_f32 v73, v73, v4
    v_cvt_pk_bf16_f32 v72, v72, v73
    v_and_b32 v73, 0xffff0000, v72
    v_lshlrev_b32 v72, 16, v72
    v_mul_f32 v72, v72, v6
    v_mul_f32 v73, v73, v6
    v_cvt_pk_bf16_f32 v43, v72, v73
    v_lshlrev_b32 v72, 16, v44
    v_and_b32 v73, 0xffff0000, v44
    v_sub_f32 v72, v72, v4
    v_sub_f32 v73, v73, v4
    v_cvt_pk_bf16_f32 v72, v72, v73
    v_and_b32 v73, 0xffff0000, v72
    v_lshlrev_b32 v72, 16, v72
    v_mul_f32 v72, v72, v6
    v_mul_f32 v73, v73, v6
    v_cvt_pk_bf16_f32 v44, v72, v73
    v_lshlrev_b32 v72, 16, v45
    v_and_b32 v73, 0xffff0000, v45
    v_sub_f32 v72, v72, v4
    v_sub_f32 v73, v73, v4
    v_cvt_pk_bf16_f32 v72, v72, v73
    v_and_b32 v73, 0xffff0000, v72
    v_lshlrev_b32 v72, 16, v72
    v_mul_f32 v72, v72, v6
    v_mul_f32 v73, v73, v6
    v_cvt_pk_bf16_f32 v45, v72, v73
    v_lshlrev_b32 v72, 16, v46
    v_and_b32 v73, 0xffff0000, v46
    v_sub_f32 v72, v72, v4
    v_sub_f32 v73, v73, v4
    v_cvt_pk_bf16_f32 v72, v72, v73
    v_and_b32 v73, 0xffff0000, v72
    v_lshlrev_b32 v72, 16, v72
    v_mul_f32 v72, v72, v6
    v_mul_f32 v73, v73, v6
    v_cvt_pk_bf16_f32 v46, v72, v73
    v_lshlrev_b32 v72, 16, v47
    v_and_b32 v73, 0xffff0000, v47
    v_sub_f32 v72, v72, v4
    v_sub_f32 v73, v73, v4
    v_cvt_pk_bf16_f32 v72, v72, v73
    v_and_b32 v73, 0xffff0000, v72
    v_lshlrev_b32 v72, 16, v72
    v_mul_f32 v72, v72, v6
    v_mul_f32 v73, v73, v6
    v_cvt_pk_bf16_f32 v47, v72, v73
    v_lshlrev_b32 v72, 16, v48
    v_and_b32 v73, 0xffff0000, v48
    v_sub_f32 v72, v72, v4
    v_sub_f32 v73, v73, v4
    v_cvt_pk_bf16_f32 v72, v72, v73
    v_and_b32 v73, 0xffff0000, v72
    v_lshlrev_b32 v72, 16, v72
    v_mul_f32 v72, v72, v6
    v_mul_f32 v73, v73, v6
    v_cvt_pk_bf16_f32 v48, v72, v73
    v_lshlrev_b32 v72, 16, v49
    v_and_b32 v73, 0xffff0000, v49
    v_sub_f32 v72, v72, v4
    v_sub_f32 v73, v73, v4
    v_cvt_pk_bf16_f32 v72, v72, v73
    v_and_b32 v73, 0xffff0000, v72
    v_lshlrev_b32 v72, 16, v72
    v_mul_f32 v72, v72, v6
    v_mul_f32 v73, v73, v6
    v_cvt_pk_bf16_f32 v49, v72, v73
    v_lshlrev_b32 v72, 16, v50
    v_and_b32 v73, 0xffff0000, v50
    v_sub_f32 v72, v72, v4
    v_sub_f32 v73, v73, v4
    v_cvt_pk_bf16_f32 v72, v72, v73
    v_and_b32 v73, 0xffff0000, v72
    v_lshlrev_b32 v72, 16, v72
    v_mul_f32 v72, v72, v6
    v_mul_f32 v73, v73, v6
    v_cvt_pk_bf16_f32 v50, v72, v73
    v_lshlrev_b32 v72, 16, v51
    v_and_b32 v73, 0xffff0000, v51
    v_sub_f32 v72, v72, v4
    v_sub_f32 v73, v73, v4
    v_cvt_pk_bf16_f32 v72, v72, v73
    v_and_b32 v73, 0xffff0000, v72
    v_lshlrev_b32 v72, 16, v72
    v_mul_f32 v72, v72, v6
    v_mul_f32 v73, v73, v6
    v_cvt_pk_bf16_f32 v51, v72, v73
    v_lshlrev_b32 v72, 16, v52
    v_and_b32 v73, 0xffff0000, v52
    v_sub_f32 v72, v72, v4
    v_sub_f32 v73, v73, v4
    v_cvt_pk_bf16_f32 v72, v72, v73
    v_and_b32 v73, 0xffff0000, v72
    v_lshlrev_b32 v72, 16, v72
    v_mul_f32 v72, v72, v6
    v_mul_f32 v73, v73, v6
    v_cvt_pk_bf16_f32 v52, v72, v73
    v_lshlrev_b32 v72, 16, v53
    v_and_b32 v73, 0xffff0000, v53
    v_sub_f32 v72, v72, v4
    v_sub_f32 v73, v73, v4
    v_cvt_pk_bf16_f32 v72, v72, v73
    v_and_b32 v73, 0xffff0000, v72
    v_lshlrev_b32 v72, 16, v72
    v_mul_f32 v72, v72, v6
    v_mul_f32 v73, v73, v6
    v_cvt_pk_bf16_f32 v53, v72, v73
    v_lshlrev_b32 v72, 16, v54
    v_and_b32 v73, 0xffff0000, v54
    v_sub_f32 v72, v72, v4
    v_sub_f32 v73, v73, v4
    v_cvt_pk_bf16_f32 v72, v72, v73
    v_and_b32 v73, 0xffff0000, v72
    v_lshlrev_b32 v72, 16, v72
    v_mul_f32 v72, v72, v6
    v_mul_f32 v73, v73, v6
    v_cvt_pk_bf16_f32 v54, v72, v73
    v_lshlrev_b32 v72, 16, v55
    v_and_b32 v73, 0xffff0000, v55
    v_sub_f32 v72, v72, v4
    v_sub_f32 v73, v73, v4
    v_cvt_pk_bf16_f32 v72, v72, v73
    v_and_b32 v73, 0xffff0000, v72
    v_lshlrev_b32 v72, 16, v72
    v_mul_f32 v72, v72, v6
    v_mul_f32 v73, v73, v6
    v_cvt_pk_bf16_f32 v55, v72, v73
    v_lshlrev_b32 v72, 16, v56
    v_and_b32 v73, 0xffff0000, v56
    v_sub_f32 v72, v72, v4
    v_sub_f32 v73, v73, v4
    v_cvt_pk_bf16_f32 v72, v72, v73
    v_and_b32 v73, 0xffff0000, v72
    v_lshlrev_b32 v72, 16, v72
    v_mul_f32 v72, v72, v6
    v_mul_f32 v73, v73, v6
    v_cvt_pk_bf16_f32 v56, v72, v73
    v_lshlrev_b32 v72, 16, v57
    v_and_b32 v73, 0xffff0000, v57
    v_sub_f32 v72, v72, v4
    v_sub_f32 v73, v73, v4
    v_cvt_pk_bf16_f32 v72, v72, v73
    v_and_b32 v73, 0xffff0000, v72
    v_lshlrev_b32 v72, 16, v72
    v_mul_f32 v72, v72, v6
    v_mul_f32 v73, v73, v6
    v_cvt_pk_bf16_f32 v57, v72, v73
    v_lshlrev_b32 v72, 16, v58
    v_and_b32 v73, 0xffff0000, v58
    v_sub_f32 v72, v72, v4
    v_sub_f32 v73, v73, v4
    v_cvt_pk_bf16_f32 v72, v72, v73
    v_and_b32 v73, 0xffff0000, v72
    v_lshlrev_b32 v72, 16, v72
    v_mul_f32 v72, v72, v6
    v_mul_f32 v73, v73, v6
    v_cvt_pk_bf16_f32 v58, v72, v73
    v_lshlrev_b32 v72, 16, v59
    v_and_b32 v73, 0xffff0000, v59
    v_sub_f32 v72, v72, v4
    v_sub_f32 v73, v73, v4
    v_cvt_pk_bf16_f32 v72, v72, v73
    v_and_b32 v73, 0xffff0000, v72
    v_lshlrev_b32 v72, 16, v72
    v_mul_f32 v72, v72, v6
    v_mul_f32 v73, v73, v6
    v_cvt_pk_bf16_f32 v59, v72, v73
    v_lshlrev_b32 v72, 16, v60
    v_and_b32 v73, 0xffff0000, v60
    v_sub_f32 v72, v72, v4
    v_sub_f32 v73, v73, v4
    v_cvt_pk_bf16_f32 v72, v72, v73
    v_and_b32 v73, 0xffff0000, v72
    v_lshlrev_b32 v72, 16, v72
    v_mul_f32 v72, v72, v6
    v_mul_f32 v73, v73, v6
    v_cvt_pk_bf16_f32 v60, v72, v73
    v_lshlrev_b32 v72, 16, v61
    v_and_b32 v73, 0xffff0000, v61
    v_sub_f32 v72, v72, v4
    v_sub_f32 v73, v73, v4
    v_cvt_pk_bf16_f32 v72, v72, v73
    v_and_b32 v73, 0xffff0000, v72
    v_lshlrev_b32 v72, 16, v72
    v_mul_f32 v72, v72, v6
    v_mul_f32 v73, v73, v6
    v_cvt_pk_bf16_f32 v61, v72, v73
    v_lshlrev_b32 v72, 16, v62
    v_and_b32 v73, 0xffff0000, v62
    v_sub_f32 v72, v72, v4
    v_sub_f32 v73, v73, v4
    v_cvt_pk_bf16_f32 v72, v72, v73
    v_and_b32 v73, 0xffff0000, v72
    v_lshlrev_b32 v72, 16, v72
    v_mul_f32 v72, v72, v6
    v_mul_f32 v73, v73, v6
    v_cvt_pk_bf16_f32 v62, v72, v73
    v_lshlrev_b32 v72, 16, v63
    v_and_b32 v73, 0xffff0000, v63
    v_sub_f32 v72, v72, v4
    v_sub_f32 v73, v73, v4
    v_cvt_pk_bf16_f32 v72, v72, v73
    v_and_b32 v73, 0xffff0000, v72
    v_lshlrev_b32 v72, 16, v72
    v_mul_f32 v72, v72, v6
    v_mul_f32 v73, v73, v6
    v_cvt_pk_bf16_f32 v63, v72, v73
    v_lshlrev_b32 v72, 16, v64
    v_and_b32 v73, 0xffff0000, v64
    v_sub_f32 v72, v72, v4
    v_sub_f32 v73, v73, v4
    v_cvt_pk_bf16_f32 v72, v72, v73
    v_and_b32 v73, 0xffff0000, v72
    v_lshlrev_b32 v72, 16, v72
    v_mul_f32 v72, v72, v6
    v_mul_f32 v73, v73, v6
    v_cvt_pk_bf16_f32 v64, v72, v73
    v_lshlrev_b32 v72, 16, v65
    v_and_b32 v73, 0xffff0000, v65
    v_sub_f32 v72, v72, v4
    v_sub_f32 v73, v73, v4
    v_cvt_pk_bf16_f32 v72, v72, v73
    v_and_b32 v73, 0xffff0000, v72
    v_lshlrev_b32 v72, 16, v72
    v_mul_f32 v72, v72, v6
    v_mul_f32 v73, v73, v6
    v_cvt_pk_bf16_f32 v65, v72, v73
    v_lshlrev_b32 v72, 16, v66
    v_and_b32 v73, 0xffff0000, v66
    v_sub_f32 v72, v72, v4
    v_sub_f32 v73, v73, v4
    v_cvt_pk_bf16_f32 v72, v72, v73
    v_and_b32 v73, 0xffff0000, v72
    v_lshlrev_b32 v72, 16, v72
    v_mul_f32 v72, v72, v6
    v_mul_f32 v73, v73, v6
    v_cvt_pk_bf16_f32 v66, v72, v73
    v_lshlrev_b32 v72, 16, v67
    v_and_b32 v73, 0xffff0000, v67
    v_sub_f32 v72, v72, v4
    v_sub_f32 v73, v73, v4
    v_cvt_pk_bf16_f32 v72, v72, v73
    v_and_b32 v73, 0xffff0000, v72
    v_lshlrev_b32 v72, 16, v72
    v_mul_f32 v72, v72, v6
    v_mul_f32 v73, v73, v6
    v_cvt_pk_bf16_f32 v67, v72, v73
    v_lshlrev_b32 v72, 16, v68
    v_and_b32 v73, 0xffff0000, v68
    v_sub_f32 v72, v72, v4
    v_sub_f32 v73, v73, v4
    v_cvt_pk_bf16_f32 v72, v72, v73
    v_and_b32 v73, 0xffff0000, v72
    v_lshlrev_b32 v72, 16, v72
    v_mul_f32 v72, v72, v6
    v_mul_f32 v73, v73, v6
    v_cvt_pk_bf16_f32 v68, v72, v73
    v_lshlrev_b32 v72, 16, v69
    v_and_b32 v73, 0xffff0000, v69
    v_sub_f32 v72, v72, v4
    v_sub_f32 v73, v73, v4
    v_cvt_pk_bf16_f32 v72, v72, v73
    v_and_b32 v73, 0xffff0000, v72
    v_lshlrev_b32 v72, 16, v72
    v_mul_f32 v72, v72, v6
    v_mul_f32 v73, v73, v6
    v_cvt_pk_bf16_f32 v69, v72, v73
    v_lshlrev_b32 v72, 16, v70
    v_and_b32 v73, 0xffff0000, v70
    v_sub_f32 v72, v72, v4
    v_sub_f32 v73, v73, v4
    v_cvt_pk_bf16_f32 v72, v72, v73
    v_and_b32 v73, 0xffff0000, v72
    v_lshlrev_b32 v72, 16, v72
    v_mul_f32 v72, v72, v6
    v_mul_f32 v73, v73, v6
    v_cvt_pk_bf16_f32 v70, v72, v73
    v_lshlrev_b32 v72, 16, v71
    v_and_b32 v73, 0xffff0000, v71
    v_sub_f32 v72, v72, v4
    v_sub_f32 v73, v73, v4
    v_cvt_pk_bf16_f32 v72, v72, v73
    v_and_b32 v73, 0xffff0000, v72
    v_lshlrev_b32 v72, 16, v72
    v_mul_f32 v72, v72, v6
    v_mul_f32 v73, v73, v6
    v_cvt_pk_bf16_f32 v71, v72, v73
    v_lshlrev_b32 v3, 4, v0
    s_lshl_b32 s5, s20, 14
    s_add_u32 s5, s5, 1048576
    buffer_store_dwordx4 v[8:11], v3, s[8:11], s5 offen offset:0 sc1
    buffer_store_dwordx4 v[12:15], v3, s[8:11], s5 offen offset:1024 sc1
    buffer_store_dwordx4 v[16:19], v3, s[8:11], s5 offen offset:2048 sc1
    buffer_store_dwordx4 v[20:23], v3, s[8:11], s5 offen offset:3072 sc1
    s_add_u32 s5, s5, 4096
    buffer_store_dwordx4 v[24:27], v3, s[8:11], s5 offen offset:0 sc1
    buffer_store_dwordx4 v[28:31], v3, s[8:11], s5 offen offset:1024 sc1
    buffer_store_dwordx4 v[32:35], v3, s[8:11], s5 offen offset:2048 sc1
    buffer_store_dwordx4 v[36:39], v3, s[8:11], s5 offen offset:3072 sc1
    s_add_u32 s5, s5, 4096
    buffer_store_dwordx4 v[40:43], v3, s[8:11], s5 offen offset:0 sc1
    buffer_store_dwordx4 v[44:47], v3, s[8:11], s5 offen offset:1024 sc1
    buffer_store_dwordx4 v[48:51], v3, s[8:11], s5 offen offset:2048 sc1
    buffer_store_dwordx4 v[52:55], v3, s[8:11], s5 offen offset:3072 sc1
    s_add_u32 s5, s5, 4096
    buffer_store_dwordx4 v[56:59], v3, s[8:11], s5 offen offset:0 sc1
    buffer_store_dwordx4 v[60:63], v3, s[8:11], s5 offen offset:1024 sc1
    buffer_store_dwordx4 v[64:67], v3, s[8:11], s5 offen offset:2048 sc1
    buffer_store_dwordx4 v[68:71], v3, s[8:11], s5 offen offset:3072 sc1
    s_waitcnt vmcnt(0)
    v_mov_b32 v4, 1
    s_mov_b64 exec, 1
    buffer_atomic_add v4, off, s[64:67], 0 offset:64 sc1
    s_mov_b64 exec, -1
dba_6:
    v_mov_b32 v0, v100
mg_wo_noln:
    s_load_dwordx2 s[36:37], s[0:1], 40
    s_load_dwordx2 s[38:39], s[0:1], 104
    s_load_dwordx2 s[40:41], s[0:1], 0
    s_load_dwordx2 s[42:43], s[0:1], 88
    v_lshrrev_b32 v24, 6, v0
    v_and_b32 v0, 63, v0
    v_readfirstlane_b32 s4, v24
    v_lshlrev_b32 v1, 4, v0
    v_and_b32 v24, 15, v0
    v_lshrrev_b32 v25, 4, v0
    v_lshlrev_b32 v26, 10, v24
    v_lshl_add_u32 v26, v25, 3, v26
    s_and_b32 s5, s4, 1
    s_lshl_b32 s5, s5, 5
    s_lshl_b32 s6, s3, 6
    s_add_u32 s5, s5, s6
    s_and_b32 s6, s16, 1
    s_lshl_b32 s6, s6, 14
    s_add_u32 s5, s5, s6
    v_add_u32 v2, s5, v26
    s_waitcnt lgkmcnt(0)
    s_mov_b32 s8, s38
    s_and_b32 s9, s39, 0xffff
    s_mov_b32 s10, 268435456
    s_mov_b32 s11, 0x20000
    s_mov_b32 s12, s36
    s_and_b32 s13, s37, 0xffff
    s_mov_b32 s14, 4194304
    s_mov_b32 s15, 0x20000
    s_mov_b32 s24, s40
    s_and_b32 s25, s41, 0xffff
    s_mov_b32 s26, 2097152
    s_mov_b32 s27, 0x20000
    s_mov_b32 s32, s42
    s_and_b32 s33, s43, 0xffff
    s_mov_b32 s34, 2097152
    s_mov_b32 s35, 0x20000
    v_and_b32 v26, 31, v0
    v_lshlrev_b32 v26, 2, v26
    v_add_u32 v3, 2048, v26
    v_lshrrev_b32 v26, 2, v0
    v_lshlrev_b32 v26, 10, v26
    v_bfe_u32 v27, v0, 4, 1
    v_lshlrev_b32 v27, 1, v27
    v_and_b32 v28, 3, v0
    v_xor_b32 v27, v27, v28
    v_lshl_add_u32 v24, v27, 4, v26
    v_bfe_u32 v28, v0, 2, 2
    v_lshl_add_u32 v28, v25, 2, v28
    v_lshlrev_b32 v28, 6, v28
    v_and_b32 v29, 1, v25
    v_lshlrev_b32 v29, 1, v29
    v_bfe_u32 v30, v0, 1, 1
    v_xor_b32 v29, v29, v30
    v_lshl_add_u32 v28, v29, 4, v28
    v_and_b32 v29, 1, v0
    v_lshl_add_u32 v28, v29, 3, v28
    s_lshl_b32 s5, s4, 15
    v_add_u32 v26, s5, v28
    v_xor_b32 v27, 32, v26
    s_mul_i32 s5, s4, 1048576
    s_lshl_b32 s6, s3, 6
    s_add_u32 s5, s5, s6
    s_lshl_b32 s6, s4, 15
    s_mov_b32 m0, s6
    s_nop 0
    buffer_load_dwordx4 v24, s[12:15], s5 offen lds
    s_add_u32 s5, s5, 16384
    s_add_u32 s6, s6, 1024
    s_mov_b32 m0, s6
    s_nop 0
    buffer_load_dwordx4 v24, s[12:15], s5 offen lds
    s_add_u32 s5, s5, 16384
    s_add_u32 s6, s6, 1024
    s_mov_b32 m0, s6
    s_nop 0
    buffer_load_dwordx4 v24, s[12:15], s5 offen lds
    s_add_u32 s5, s5, 16384
    s_add_u32 s6, s6, 1024
    s_mov_b32 m0, s6
    s_nop 0
    buffer_load_dwordx4 v24, s[12:15], s5 offen lds
    s_add_u32 s5, s5, 16384
    s_add_u32 s6, s6, 1024
    s_mov_b32 m0, s6
    s_nop 0
    buffer_load_dwordx4 v24, s[12:15], s5 offen lds
    s_add_u32 s5, s5, 16384
    s_add_u32 s6, s6, 1024
    s_mov_b32 m0, s6
    s_nop 0
    buffer_load_dwordx4 v24, s[12:15], s5 offen lds
    s_add_u32 s5, s5, 16384
    s_add_u32 s6, s6, 1024
    s_mov_b32 m0, s6
    s_nop 0
    buffer_load_dwordx4 v24, s[12:15], s5 offen lds
    s_add_u32 s5, s5, 16384
    s_add_u32 s6, s6, 1024
    s_mov_b32 m0, s6
    s_nop 0
    buffer_load_dwordx4 v24, s[12:15], s5 offen lds
    s_add_u32 s5, s5, 16384
    s_add_u32 s6, s6, 1024
    s_mov_b32 m0, s6
    s_nop 0
    buffer_load_dwordx4 v24, s[12:15], s5 offen lds
    s_add_u32 s5, s5, 16384
    s_add_u32 s6, s6, 1024
    s_mov_b32 m0, s6
    s_nop 0
    buffer_load_dwordx4 v24, s[12:15], s5 offen lds
    s_add_u32 s5, s5, 16384
    s_add_u32 s6, s6, 1024
    s_mov_b32 m0, s6
    s_nop 0
    buffer_load_dwordx4 v24, s[12:15], s5 offen lds
    s_add_u32 s5, s5, 16384
    s_add_u32 s6, s6, 1024
    s_mov_b32 m0, s6
    s_nop 0
    buffer_load_dwordx4 v24, s[12:15], s5 offen lds
    s_add_u32 s5, s5, 16384
    s_add_u32 s6, s6, 1024
    s_mov_b32 m0, s6
    s_nop 0
    buffer_load_dwordx4 v24, s[12:15], s5 offen lds
    s_add_u32 s5, s5, 16384
    s_add_u32 s6, s6, 1024
    s_mov_b32 m0, s6
    s_nop 0
    buffer_load_dwordx4 v24, s[12:15], s5 offen lds
    s_add_u32 s5, s5, 16384
    s_add_u32 s6, s6, 1024
    s_mov_b32 m0, s6
    s_nop 0
    buffer_load_dwordx4 v24, s[12:15], s5 offen lds
    s_add_u32 s5, s5, 16384
    s_add_u32 s6, s6, 1024
    s_mov_b32 m0, s6
    s_nop 0
    buffer_load_dwordx4 v24, s[12:15], s5 offen lds
    s_add_u32 s5, s5, 16384
    s_add_u32 s6, s6, 1024
    s_mov_b32 m0, s6
    s_nop 0
    buffer_load_dwordx4 v24, s[12:15], s5 offen lds
    s_add_u32 s5, s5, 16384
    s_add_u32 s6, s6, 1024
    s_mov_b32 m0, s6
    s_nop 0
    buffer_load_dwordx4 v24, s[12:15], s5 offen lds
    s_add_u32 s5, s5, 16384
    s_add_u32 s6, s6, 1024
    s_mov_b32 m0, s6
    s_nop 0
    buffer_load_dwordx4 v24, s[12:15], s5 offen lds
    s_add_u32 s5, s5, 16384
    s_add_u32 s6, s6, 1024
    s_mov_b32 m0, s6
    s_nop 0
    buffer_load_dwordx4 v24, s[12:15], s5 offen lds
    s_add_u32 s5, s5, 16384
    s_add_u32 s6, s6, 1024
    s_mov_b32 m0, s6
    s_nop 0
    buffer_load_dwordx4 v24, s[12:15], s5 offen lds
    s_add_u32 s5, s5, 16384
    s_add_u32 s6, s6, 1024
    s_mov_b32 m0, s6
    s_nop 0
    buffer_load_dwordx4 v24, s[12:15], s5 offen lds
    s_add_u32 s5, s5, 16384
    s_add_u32 s6, s6, 1024
    s_mov_b32 m0, s6
    s_nop 0
    buffer_load_dwordx4 v24, s[12:15], s5 offen lds
    s_add_u32 s5, s5, 16384
    s_add_u32 s6, s6, 1024
    s_mov_b32 m0, s6
    s_nop 0
    buffer_load_dwordx4 v24, s[12:15], s5 offen lds
    s_add_u32 s5, s5, 16384
    s_add_u32 s6, s6, 1024
    s_mov_b32 m0, s6
    s_nop 0
    buffer_load_dwordx4 v24, s[12:15], s5 offen lds
    s_add_u32 s5, s5, 16384
    s_add_u32 s6, s6, 1024
    s_mov_b32 m0, s6
    s_nop 0
    buffer_load_dwordx4 v24, s[12:15], s5 offen lds
    s_add_u32 s5, s5, 16384
    s_add_u32 s6, s6, 1024
    s_mov_b32 m0, s6
    s_nop 0
    buffer_load_dwordx4 v24, s[12:15], s5 offen lds
    s_add_u32 s5, s5, 16384
    s_add_u32 s6, s6, 1024
    s_mov_b32 m0, s6
    s_nop 0
    buffer_load_dwordx4 v24, s[12:15], s5 offen lds
    s_add_u32 s5, s5, 16384
    s_add_u32 s6, s6, 1024
    s_mov_b32 m0, s6
    s_nop 0
    buffer_load_dwordx4 v24, s[12:15], s5 offen lds
    s_add_u32 s5, s5, 16384
    s_add_u32 s6, s6, 1024
    s_mov_b32 m0, s6
    s_nop 0
    buffer_load_dwordx4 v24, s[12:15], s5 offen lds
    s_add_u32 s5, s5, 16384
    s_add_u32 s6, s6, 1024
    s_mov_b32 m0, s6
    s_nop 0
    buffer_load_dwordx4 v24, s[12:15], s5 offen lds
    s_add_u32 s5, s5, 16384
    s_add_u32 s6, s6, 1024
    s_mov_b32 m0, s6
    s_nop 0
    buffer_load_dwordx4 v24, s[12:15], s5 offen lds
    s_waitcnt vmcnt(0)
    ds_read_b64_tr_b16 a[0:1], v26 offset:0
    ds_read_b64_tr_b16 a[2:3], v26 offset:1024
    ds_read_b64_tr_b16 a[4:5], v27 offset:0
    ds_read_b64_tr_b16 a[6:7], v27 offset:1024
    ds_read_b64_tr_b16 a[8:9], v26 offset:2048
    ds_read_b64_tr_b16 a[10:11], v26 offset:3072
    ds_read_b64_tr_b16 a[12:13], v27 offset:2048
    ds_read_b64_tr_b16 a[14:15], v27 offset:3072
    s_waitcnt lgkmcnt(4)
    ds_read_b64_tr_b16 a[16:17], v26 offset:4096
    ds_read_b64_tr_b16 a[18:19], v26 offset:5120
    ds_read_b64_tr_b16 a[20:21], v27 offset:4096
    ds_read_b64_tr_b16 a[22:23], v27 offset:5120
    ds_read_b64_tr_b16 a[24:25], v26 offset:6144
    ds_read_b64_tr_b16 a[26:27], v26 offset:7168
    ds_read_b64_tr_b16 a[28:29], v27 offset:6144
    ds_read_b64_tr_b16 a[30:31], v27 offset:7168
    s_waitcnt lgkmcnt(4)
    ds_read_b64_tr_b16 a[32:33], v26 offset:8192
    ds_read_b64_tr_b16 a[34:35], v26 offset:9216
    ds_read_b64_tr_b16 a[36:37], v27 offset:8192
    ds_read_b64_tr_b16 a[38:39], v27 offset:9216
    ds_read_b64_tr_b16 a[40:41], v26 offset:10240
    ds_read_b64_tr_b16 a[42:43], v26 offset:11264
    ds_read_b64_tr_b16 a[44:45], v27 offset:10240
    ds_read_b64_tr_b16 a[46:47], v27 offset:11264
    s_waitcnt lgkmcnt(4)
    ds_read_b64_tr_b16 a[48:49], v26 offset:12288
    ds_read_b64_tr_b16 a[50:51], v26 offset:13312
    ds_read_b64_tr_b16 a[52:53], v27 offset:12288
    ds_read_b64_tr_b16 a[54:55], v27 offset:13312
    ds_read_b64_tr_b16 a[56:57], v26 offset:14336
    ds_read_b64_tr_b16 a[58:59], v26 offset:15360
    ds_read_b64_tr_b16 a[60:61], v27 offset:14336
    ds_read_b64_tr_b16 a[62:63], v27 offset:15360
    s_waitcnt lgkmcnt(4)
    ds_read_b64_tr_b16 a[64:65], v26 offset:16384
    ds_read_b64_tr_b16 a[66:67], v26 offset:17408
    ds_read_b64_tr_b16 a[68:69], v27 offset:16384
    ds_read_b64_tr_b16 a[70:71], v27 offset:17408
    ds_read_b64_tr_b16 a[72:73], v26 offset:18432
    ds_read_b64_tr_b16 a[74:75], v26 offset:19456
    ds_read_b64_tr_b16 a[76:77], v27 offset:18432
    ds_read_b64_tr_b16 a[78:79], v27 offset:19456
    s_waitcnt lgkmcnt(4)
    ds_read_b64_tr_b16 a[80:81], v26 offset:20480
    ds_read_b64_tr_b16 a[82:83], v26 offset:21504
    ds_read_b64_tr_b16 a[84:85], v27 offset:20480
    ds_read_b64_tr_b16 a[86:87], v27 offset:21504
    ds_read_b64_tr_b16 a[88:89], v26 offset:22528
    ds_read_b64_tr_b16 a[90:91], v26 offset:23552
    ds_read_b64_tr_b16 a[92:93], v27 offset:22528
    ds_read_b64_tr_b16 a[94:95], v27 offset:23552
    s_waitcnt lgkmcnt(4)
    ds_read_b64_tr_b16 a[96:97], v26 offset:24576
    ds_read_b64_tr_b16 a[98:99], v26 offset:25600
    ds_read_b64_tr_b16 a[100:101], v27 offset:24576
    ds_read_b64_tr_b16 a[102:103], v27 offset:25600
    ds_read_b64_tr_b16 a[104:105], v26 offset:26624
    ds_read_b64_tr_b16 a[106:107], v26 offset:27648
    ds_read_b64_tr_b16 a[108:109], v27 offset:26624
    ds_read_b64_tr_b16 a[110:111], v27 offset:27648
    s_waitcnt lgkmcnt(4)
    ds_read_b64_tr_b16 a[112:113], v26 offset:28672
    ds_read_b64_tr_b16 a[114:115], v26 offset:29696
    ds_read_b64_tr_b16 a[116:117], v27 offset:28672
    ds_read_b64_tr_b16 a[118:119], v27 offset:29696
    ds_read_b64_tr_b16 a[120:121], v26 offset:30720
    ds_read_b64_tr_b16 a[122:123], v26 offset:31744
    ds_read_b64_tr_b16 a[124:125], v27 offset:30720
    ds_read_b64_tr_b16 a[126:127], v27 offset:31744
    s_waitcnt lgkmcnt(4)
    s_waitcnt lgkmcnt(0)
    s_mul_i32 s5, s4, 1048576
    s_lshl_b32 s6, s3, 6
    s_add_u32 s5, s5, s6
    s_add_u32 s5, s5, 524288
    s_lshl_b32 s6, s4, 15
    s_mov_b32 m0, s6
    s_nop 0
    buffer_load_dwordx4 v24, s[12:15], s5 offen lds
    s_add_u32 s5, s5, 16384
    s_add_u32 s6, s6, 1024
    s_mov_b32 m0, s6
    s_nop 0
    buffer_load_dwordx4 v24, s[12:15], s5 offen lds
    s_add_u32 s5, s5, 16384
    s_add_u32 s6, s6, 1024
    s_mov_b32 m0, s6
    s_nop 0
    buffer_load_dwordx4 v24, s[12:15], s5 offen lds
    s_add_u32 s5, s5, 16384
    s_add_u32 s6, s6, 1024
    s_mov_b32 m0, s6
    s_nop 0
    buffer_load_dwordx4 v24, s[12:15], s5 offen lds
    s_add_u32 s5, s5, 16384
    s_add_u32 s6, s6, 1024
    s_mov_b32 m0, s6
    s_nop 0
    buffer_load_dwordx4 v24, s[12:15], s5 offen lds
    s_add_u32 s5, s5, 16384
    s_add_u32 s6, s6, 1024
    s_mov_b32 m0, s6
    s_nop 0
    buffer_load_dwordx4 v24, s[12:15], s5 offen lds
    s_add_u32 s5, s5, 16384
    s_add_u32 s6, s6, 1024
    s_mov_b32 m0, s6
    s_nop 0
    buffer_load_dwordx4 v24, s[12:15], s5 offen lds
    s_add_u32 s5, s5, 16384
    s_add_u32 s6, s6, 1024
    s_mov_b32 m0, s6
    s_nop 0
    buffer_load_dwordx4 v24, s[12:15], s5 offen lds
    s_add_u32 s5, s5, 16384
    s_add_u32 s6, s6, 1024
    s_mov_b32 m0, s6
    s_nop 0
    buffer_load_dwordx4 v24, s[12:15], s5 offen lds
    s_add_u32 s5, s5, 16384
    s_add_u32 s6, s6, 1024
    s_mov_b32 m0, s6
    s_nop 0
    buffer_load_dwordx4 v24, s[12:15], s5 offen lds
    s_add_u32 s5, s5, 16384
    s_add_u32 s6, s6, 1024
    s_mov_b32 m0, s6
    s_nop 0
    buffer_load_dwordx4 v24, s[12:15], s5 offen lds
    s_add_u32 s5, s5, 16384
    s_add_u32 s6, s6, 1024
    s_mov_b32 m0, s6
    s_nop 0
    buffer_load_dwordx4 v24, s[12:15], s5 offen lds
    s_add_u32 s5, s5, 16384
    s_add_u32 s6, s6, 1024
    s_mov_b32 m0, s6
    s_nop 0
    buffer_load_dwordx4 v24, s[12:15], s5 offen lds
    s_add_u32 s5, s5, 16384
    s_add_u32 s6, s6, 1024
    s_mov_b32 m0, s6
    s_nop 0
    buffer_load_dwordx4 v24, s[12:15], s5 offen lds
    s_add_u32 s5, s5, 16384
    s_add_u32 s6, s6, 1024
    s_mov_b32 m0, s6
    s_nop 0
    buffer_load_dwordx4 v24, s[12:15], s5 offen lds
    s_add_u32 s5, s5, 16384
    s_add_u32 s6, s6, 1024
    s_mov_b32 m0, s6
    s_nop 0
    buffer_load_dwordx4 v24, s[12:15], s5 offen lds
    s_add_u32 s5, s5, 16384
    s_add_u32 s6, s6, 1024
    s_mov_b32 m0, s6
    s_nop 0
    buffer_load_dwordx4 v24, s[12:15], s5 offen lds
    s_add_u32 s5, s5, 16384
    s_add_u32 s6, s6, 1024
    s_mov_b32 m0, s6
    s_nop 0
    buffer_load_dwordx4 v24, s[12:15], s5 offen lds
    s_add_u32 s5, s5, 16384
    s_add_u32 s6, s6, 1024
    s_mov_b32 m0, s6
    s_nop 0
    buffer_load_dwordx4 v24, s[12:15], s5 offen lds
    s_add_u32 s5, s5, 16384
    s_add_u32 s6, s6, 1024
    s_mov_b32 m0, s6
    s_nop 0
    buffer_load_dwordx4 v24, s[12:15], s5 offen lds
    s_add_u32 s5, s5, 16384
    s_add_u32 s6, s6, 1024
    s_mov_b32 m0, s6
    s_nop 0
    buffer_load_dwordx4 v24, s[12:15], s5 offen lds
    s_add_u32 s5, s5, 16384
    s_add_u32 s6, s6, 1024
    s_mov_b32 m0, s6
    s_nop 0
    buffer_load_dwordx4 v24, s[12:15], s5 offen lds
    s_add_u32 s5, s5, 16384
    s_add_u32 s6, s6, 1024
    s_mov_b32 m0, s6
    s_nop 0
    buffer_load_dwordx4 v24, s[12:15], s5 offen lds
    s_add_u32 s5, s5, 16384
    s_add_u32 s6, s6, 1024
    s_mov_b32 m0, s6
    s_nop 0
    buffer_load_dwordx4 v24, s[12:15], s5 offen lds
    s_add_u32 s5, s5, 16384
    s_add_u32 s6, s6, 1024
    s_mov_b32 m0, s6
    s_nop 0
    buffer_load_dwordx4 v24, s[12:15], s5 offen lds
    s_add_u32 s5, s5, 16384
    s_add_u32 s6, s6, 1024
    s_mov_b32 m0, s6
    s_nop 0
    buffer_load_dwordx4 v24, s[12:15], s5 offen lds
    s_add_u32 s5, s5, 16384
    s_add_u32 s6, s6, 1024
    s_mov_b32 m0, s6
    s_nop 0
    buffer_load_dwordx4 v24, s[12:15], s5 offen lds
    s_add_u32 s5, s5, 16384
    s_add_u32 s6, s6, 1024
    s_mov_b32 m0, s6
    s_nop 0
    buffer_load_dwordx4 v24, s[12:15], s5 offen lds
    s_add_u32 s5, s5, 16384
    s_add_u32 s6, s6, 1024
    s_mov_b32 m0, s6
    s_nop 0
    buffer_load_dwordx4 v24, s[12:15], s5 offen lds
    s_add_u32 s5, s5, 16384
    s_add_u32 s6, s6, 1024
    s_mov_b32 m0, s6
    s_nop 0
    buffer_load_dwordx4 v24, s[12:15], s5 offen lds
    s_add_u32 s5, s5, 16384
    s_add_u32 s6, s6, 1024
    s_mov_b32 m0, s6
    s_nop 0
    buffer_load_dwordx4 v24, s[12:15], s5 offen lds
    s_add_u32 s5, s5, 16384
    s_add_u32 s6, s6, 1024
    s_mov_b32 m0, s6
    s_nop 0
    buffer_load_dwordx4 v24, s[12:15], s5 offen lds
    s_waitcnt vmcnt(0)
    ds_read_b64_tr_b16 a[128:129], v26 offset:0
    ds_read_b64_tr_b16 a[130:131], v26 offset:1024
    ds_read_b64_tr_b16 a[132:133], v27 offset:0
    ds_read_b64_tr_b16 a[134:135], v27 offset:1024
    ds_read_b64_tr_b16 a[136:137], v26 offset:2048
    ds_read_b64_tr_b16 a[138:139], v26 offset:3072
    ds_read_b64_tr_b16 a[140:141], v27 offset:2048
    ds_read_b64_tr_b16 a[142:143], v27 offset:3072
    s_waitcnt lgkmcnt(4)
    ds_read_b64_tr_b16 a[144:145], v26 offset:4096
    ds_read_b64_tr_b16 a[146:147], v26 offset:5120
    ds_read_b64_tr_b16 a[148:149], v27 offset:4096
    ds_read_b64_tr_b16 a[150:151], v27 offset:5120
    ds_read_b64_tr_b16 a[152:153], v26 offset:6144
    ds_read_b64_tr_b16 a[154:155], v26 offset:7168
    ds_read_b64_tr_b16 a[156:157], v27 offset:6144
    ds_read_b64_tr_b16 a[158:159], v27 offset:7168
    s_waitcnt lgkmcnt(4)
    ds_read_b64_tr_b16 a[160:161], v26 offset:8192
    ds_read_b64_tr_b16 a[162:163], v26 offset:9216
    ds_read_b64_tr_b16 a[164:165], v27 offset:8192
    ds_read_b64_tr_b16 a[166:167], v27 offset:9216
    ds_read_b64_tr_b16 a[168:169], v26 offset:10240
    ds_read_b64_tr_b16 a[170:171], v26 offset:11264
    ds_read_b64_tr_b16 a[172:173], v27 offset:10240
    ds_read_b64_tr_b16 a[174:175], v27 offset:11264
    s_waitcnt lgkmcnt(4)
    ds_read_b64_tr_b16 a[176:177], v26 offset:12288
    ds_read_b64_tr_b16 a[178:179], v26 offset:13312
    ds_read_b64_tr_b16 a[180:181], v27 offset:12288
    ds_read_b64_tr_b16 a[182:183], v27 offset:13312
    ds_read_b64_tr_b16 a[184:185], v26 offset:14336
    ds_read_b64_tr_b16 a[186:187], v26 offset:15360
    ds_read_b64_tr_b16 a[188:189], v27 offset:14336
    ds_read_b64_tr_b16 a[190:191], v27 offset:15360
    s_waitcnt lgkmcnt(4)
    ds_read_b64_tr_b16 a[192:193], v26 offset:16384
    ds_read_b64_tr_b16 a[194:195], v26 offset:17408
    ds_read_b64_tr_b16 a[196:197], v27 offset:16384
    ds_read_b64_tr_b16 a[198:199], v27 offset:17408
    ds_read_b64_tr_b16 a[200:201], v26 offset:18432
    ds_read_b64_tr_b16 a[202:203], v26 offset:19456
    ds_read_b64_tr_b16 a[204:205], v27 offset:18432
    ds_read_b64_tr_b16 a[206:207], v27 offset:19456
    s_waitcnt lgkmcnt(4)
    ds_read_b64_tr_b16 a[208:209], v26 offset:20480
    ds_read_b64_tr_b16 a[210:211], v26 offset:21504
    ds_read_b64_tr_b16 a[212:213], v27 offset:20480
    ds_read_b64_tr_b16 a[214:215], v27 offset:21504
    ds_read_b64_tr_b16 a[216:217], v26 offset:22528
    ds_read_b64_tr_b16 a[218:219], v26 offset:23552
    ds_read_b64_tr_b16 a[220:221], v27 offset:22528
    ds_read_b64_tr_b16 a[222:223], v27 offset:23552
    s_waitcnt lgkmcnt(4)
    ds_read_b64_tr_b16 a[224:225], v26 offset:24576
    ds_read_b64_tr_b16 a[226:227], v26 offset:25600
    ds_read_b64_tr_b16 a[228:229], v27 offset:24576
    ds_read_b64_tr_b16 a[230:231], v27 offset:25600
    ds_read_b64_tr_b16 a[232:233], v26 offset:26624
    ds_read_b64_tr_b16 a[234:235], v26 offset:27648
    ds_read_b64_tr_b16 a[236:237], v27 offset:26624
    ds_read_b64_tr_b16 a[238:239], v27 offset:27648
    s_waitcnt lgkmcnt(4)
    ds_read_b64_tr_b16 a[240:241], v26 offset:28672
    ds_read_b64_tr_b16 a[242:243], v26 offset:29696
    ds_read_b64_tr_b16 a[244:245], v27 offset:28672
    ds_read_b64_tr_b16 a[246:247], v27 offset:29696
    ds_read_b64_tr_b16 a[248:249], v26 offset:30720
    ds_read_b64_tr_b16 a[250:251], v26 offset:31744
    ds_read_b64_tr_b16 a[252:253], v27 offset:30720
    ds_read_b64_tr_b16 a[254:255], v27 offset:31744
    s_waitcnt lgkmcnt(4)
    s_waitcnt lgkmcnt(0)
    s_barrier
    s_cmp_lg_u32 s4, 0
    s_cbranch_scc1 dbw_7_x
    s_mov_b32 s70, 0
dbw_7:
    buffer_load_dword v40, off, s[64:67], 0 offset:128 sc1
    s_add_u32 s70, s70, 1
    s_cmp_gt_u32 s70, 0x10000
    s_cbranch_scc1 dbw_7_y
    s_waitcnt vmcnt(0)
    v_readfirstlane_b32 s71, v40
    s_nop 0
    s_cmp_ge_u32 s71, 174
    s_cbranch_scc1 dbw_7_x
    s_sleep 8
    s_branch dbw_7
dbw_7_y:
    s_waitcnt vmcnt(0)
dbw_7_x:
    s_barrier
    s_lshr_b32 s17, s16, 1
    s_mov_b32 s30, 0
    s_mov_b32 s18, 0
wo_loop:
    s_lshl_b32 s22, s17, 15
    s_mul_hi_u32 s20, s17, 2147483648
    s_mul_i32 s5, s20, 2
    s_sub_u32 s5, s17, s5
    s_lshl_b32 s5, s5, 6
    s_lshl_b32 s6, s3, 2
    s_add_u32 s5, s5, s6
    s_add_u32 s21, s5, 3328
    s_add_u32 s20, s20, 1
    v_mov_b32 v5, 0
    s_mov_b32 s31, 0
wo_g_8:
    buffer_load_dword v6, v5, s[8:11], s21 offen sc1
    s_add_u32 s31, s31, 1
    s_cmp_gt_u32 s31, 0x8000
    s_cbranch_scc1 wo_g_8_fail
    s_waitcnt vmcnt(0)
    v_cmp_gt_u32 vcc, s20, v6
    s_cbranch_vccz wo_g_8_ok
    s_sleep 2
    s_branch wo_g_8
wo_g_8_fail:
    s_add_u32 s30, s30, 1
    s_waitcnt vmcnt(0)
wo_g_8_ok:
    s_add_u32 s5, s22, 3145728
    buffer_load_dwordx2 v[24:25], v2, s[8:11], s5 offen sc1
    buffer_load_dwordx2 v[26:27], v2, s[24:27], s22 offen
    s_mul_hi_u32 s20, s17, 1431655766
    s_mul_i32 s5, s20, 3
    s_sub_u32 s5, s17, s5
    s_mul_i32 s21, s5, 128
    s_add_u32 s20, s20, 1
    s_mul_i32 s19, s17, 262144
    s_mul_i32 s5, s4, 32768
    s_add_u32 s19, s19, s5
    s_add_u32 s19, s19, 67108864
    s_and_b32 s5, s16, 1
    s_mul_i32 s5, s5, 131072
    s_add_u32 s19, s19, s5
    s_mov_b32 s31, 0
wo_a_9:
    buffer_load_dword v6, v3, s[8:11], s21 offen sc1
    s_add_u32 s31, s31, 1
    s_cmp_gt_u32 s31, 0x8000
    s_cbranch_scc1 wo_a_9_fail
    s_waitcnt vmcnt(0)
    v_cmp_gt_u32 vcc, s20, v6
    s_cbranch_vccz wo_a_9_ok
    s_sleep 2
    s_branch wo_a_9
wo_a_9_fail:
    s_add_u32 s30, s30, 1
    s_waitcnt vmcnt(0)
wo_a_9_ok:
    buffer_load_dwordx4 v[32:35], v1, s[8:11], s19 offen offset:0 sc1
    buffer_load_dwordx4 v[36:39], v1, s[8:11], s19 offen offset:1024 sc1
    buffer_load_dwordx4 v[40:43], v1, s[8:11], s19 offen offset:2048 sc1
    buffer_load_dwordx4 v[44:47], v1, s[8:11], s19 offen offset:3072 sc1
    s_add_u32 s5, s19, 4096
    buffer_load_dwordx4 v[48:51], v1, s[8:11], s5 offen offset:0 sc1
    s_add_u32 s5, s19, 4096
    buffer_load_dwordx4 v[52:55], v1, s[8:11], s5 offen offset:1024 sc1
    s_add_u32 s5, s19, 4096
    buffer_load_dwordx4 v[56:59], v1, s[8:11], s5 offen offset:2048 sc1
    s_add_u32 s5, s19, 4096
    buffer_load_dwordx4 v[60:63], v1, s[8:11], s5 offen offset:3072 sc1
    s_add_u32 s5, s19, 8192
    buffer_load_dwordx4 v[64:67], v1, s[8:11], s5 offen offset:0 sc1
    s_add_u32 s5, s19, 8192
    buffer_load_dwordx4 v[68:71], v1, s[8:11], s5 offen offset:1024 sc1
    s_add_u32 s5, s19, 8192
    buffer_load_dwordx4 v[72:75], v1, s[8:11], s5 offen offset:2048 sc1
    s_add_u32 s5, s19, 8192
    buffer_load_dwordx4 v[76:79], v1, s[8:11], s5 offen offset:3072 sc1
    s_add_u32 s5, s19, 12288
    buffer_load_dwordx4 v[80:83], v1, s[8:11], s5 offen offset:0 sc1
    s_add_u32 s5, s19, 12288
    buffer_load_dwordx4 v[84:87], v1, s[8:11], s5 offen offset:1024 sc1
    s_add_u32 s5, s19, 12288
    buffer_load_dwordx4 v[88:91], v1, s[8:11], s5 offen offset:2048 sc1
    s_add_u32 s5, s19, 12288
    buffer_load_dwordx4 v[92:95], v1, s[8:11], s5 offen offset:3072 sc1
    s_waitcnt vmcnt(15)
    v_mfma_f32_16x16x32_bf16 v[8:11], a[0:3], v[32:35], 0
    v_mfma_f32_16x16x32_bf16 v[16:19], a[4:7], v[32:35], 0
    s_add_u32 s5, s19, 16384
    buffer_load_dwordx4 v[32:35], v1, s[8:11], s5 offen offset:0 sc1
    s_waitcnt vmcnt(15)
    v_mfma_f32_16x16x32_bf16 v[8:11], a[8:11], v[36:39], v[8:11]
    v_mfma_f32_16x16x32_bf16 v[16:19], a[12:15], v[36:39], v[16:19]
    s_add_u32 s5, s19, 16384
    buffer_load_dwordx4 v[36:39], v1, s[8:11], s5 offen offset:1024 sc1
    s_waitcnt vmcnt(15)
    v_mfma_f32_16x16x32_bf16 v[8:11], a[16:19], v[40:43], v[8:11]
    v_mfma_f32_16x16x32_bf16 v[16:19], a[20:23], v[40:43], v[16:19]
    s_add_u32 s5, s19, 16384
    buffer_load_dwordx4 v[40:43], v1, s[8:11], s5 offen offset:2048 sc1
    s_waitcnt vmcnt(15)
    v_mfma_f32_16x16x32_bf16 v[8:11], a[24:27], v[44:47], v[8:11]
    v_mfma_f32_16x16x32_bf16 v[16:19], a[28:31], v[44:47], v[16:19]
    s_add_u32 s5, s19, 16384
    buffer_load_dwordx4 v[44:47], v1, s[8:11], s5 offen offset:3072 sc1
    s_waitcnt vmcnt(15)
    v_mfma_f32_16x16x32_bf16 v[8:11], a[32:35], v[48:51], v[8:11]
    v_mfma_f32_16x16x32_bf16 v[16:19], a[36:39], v[48:51], v[16:19]
    s_add_u32 s5, s19, 20480
    buffer_load_dwordx4 v[48:51], v1, s[8:11], s5 offen offset:0 sc1
    s_waitcnt vmcnt(15)
    v_mfma_f32_16x16x32_bf16 v[8:11], a[40:43], v[52:55], v[8:11]
    v_mfma_f32_16x16x32_bf16 v[16:19], a[44:47], v[52:55], v[16:19]
    s_add_u32 s5, s19, 20480
    buffer_load_dwordx4 v[52:55], v1, s[8:11], s5 offen offset:1024 sc1
    s_waitcnt vmcnt(15)
    v_mfma_f32_16x16x32_bf16 v[8:11], a[48:51], v[56:59], v[8:11]
    v_mfma_f32_16x16x32_bf16 v[16:19], a[52:55], v[56:59], v[16:19]
    s_add_u32 s5, s19, 20480
    buffer_load_dwordx4 v[56:59], v1, s[8:11], s5 offen offset:2048 sc1
    s_waitcnt vmcnt(15)
    v_mfma_f32_16x16x32_bf16 v[8:11], a[56:59], v[60:63], v[8:11]
    v_mfma_f32_16x16x32_bf16 v[16:19], a[60:63], v[60:63], v[16:19]
    s_add_u32 s5, s19, 20480
    buffer_load_dwordx4 v[60:63], v1, s[8:11], s5 offen offset:3072 sc1
    s_waitcnt vmcnt(15)
    v_mfma_f32_16x16x32_bf16 v[8:11], a[64:67], v[64:67], v[8:11]
    v_mfma_f32_16x16x32_bf16 v[16:19], a[68:71], v[64:67], v[16:19]
    s_add_u32 s5, s19, 24576
    buffer_load_dwordx4 v[64:67], v1, s[8:11], s5 offen offset:0 sc1
    s_waitcnt vmcnt(15)
    v_mfma_f32_16x16x32_bf16 v[8:11], a[72:75], v[68:71], v[8:11]
    v_mfma_f32_16x16x32_bf16 v[16:19], a[76:79], v[68:71], v[16:19]
    s_add_u32 s5, s19, 24576
    buffer_load_dwordx4 v[68:71], v1, s[8:11], s5 offen offset:1024 sc1
    s_waitcnt vmcnt(15)
    v_mfma_f32_16x16x32_bf16 v[8:11], a[80:83], v[72:75], v[8:11]
    v_mfma_f32_16x16x32_bf16 v[16:19], a[84:87], v[72:75], v[16:19]
    s_add_u32 s5, s19, 24576
    buffer_load_dwordx4 v[72:75], v1, s[8:11], s5 offen offset:2048 sc1
    s_waitcnt vmcnt(15)
    v_mfma_f32_16x16x32_bf16 v[8:11], a[88:91], v[76:79], v[8:11]
    v_mfma_f32_16x16x32_bf16 v[16:19], a[92:95], v[76:79], v[16:19]
    s_add_u32 s5, s19, 24576
    buffer_load_dwordx4 v[76:79], v1, s[8:11], s5 offen offset:3072 sc1
    s_waitcnt vmcnt(15)
    v_mfma_f32_16x16x32_bf16 v[8:11], a[96:99], v[80:83], v[8:11]
    v_mfma_f32_16x16x32_bf16 v[16:19], a[100:103], v[80:83], v[16:19]
    s_add_u32 s5, s19, 28672
    buffer_load_dwordx4 v[80:83], v1, s[8:11], s5 offen offset:0 sc1
    s_waitcnt vmcnt(15)
    v_mfma_f32_16x16x32_bf16 v[8:11], a[104:107], v[84:87], v[8:11]
    v_mfma_f32_16x16x32_bf16 v[16:19], a[108:111], v[84:87], v[16:19]
    s_add_u32 s5, s19, 28672
    buffer_load_dwordx4 v[84:87], v1, s[8:11], s5 offen offset:1024 sc1
    s_waitcnt vmcnt(15)
    v_mfma_f32_16x16x32_bf16 v[8:11], a[112:115], v[88:91], v[8:11]
    v_mfma_f32_16x16x32_bf16 v[16:19], a[116:119], v[88:91], v[16:19]
    s_add_u32 s5, s19, 28672
    buffer_load_dwordx4 v[88:91], v1, s[8:11], s5 offen offset:2048 sc1
    s_waitcnt vmcnt(15)
    v_mfma_f32_16x16x32_bf16 v[8:11], a[120:123], v[92:95], v[8:11]
    v_mfma_f32_16x16x32_bf16 v[16:19], a[124:127], v[92:95], v[16:19]
    s_add_u32 s5, s19, 28672
    buffer_load_dwordx4 v[92:95], v1, s[8:11], s5 offen offset:3072 sc1
    s_waitcnt vmcnt(15)
    v_mfma_f32_16x16x32_bf16 v[8:11], a[128:131], v[32:35], v[8:11]
    v_mfma_f32_16x16x32_bf16 v[16:19], a[132:135], v[32:35], v[16:19]
    s_waitcnt vmcnt(14)
    v_mfma_f32_16x16x32_bf16 v[8:11], a[136:139], v[36:39], v[8:11]
    v_mfma_f32_16x16x32_bf16 v[16:19], a[140:143], v[36:39], v[16:19]
    s_waitcnt vmcnt(13)
    v_mfma_f32_16x16x32_bf16 v[8:11], a[144:147], v[40:43], v[8:11]
    v_mfma_f32_16x16x32_bf16 v[16:19], a[148:151], v[40:43], v[16:19]
    s_waitcnt vmcnt(12)
    v_mfma_f32_16x16x32_bf16 v[8:11], a[152:155], v[44:47], v[8:11]
    v_mfma_f32_16x16x32_bf16 v[16:19], a[156:159], v[44:47], v[16:19]
    s_waitcnt vmcnt(11)
    v_mfma_f32_16x16x32_bf16 v[8:11], a[160:163], v[48:51], v[8:11]
    v_mfma_f32_16x16x32_bf16 v[16:19], a[164:167], v[48:51], v[16:19]
    s_waitcnt vmcnt(10)
    v_mfma_f32_16x16x32_bf16 v[8:11], a[168:171], v[52:55], v[8:11]
    v_mfma_f32_16x16x32_bf16 v[16:19], a[172:175], v[52:55], v[16:19]
    s_waitcnt vmcnt(9)
    v_mfma_f32_16x16x32_bf16 v[8:11], a[176:179], v[56:59], v[8:11]
    v_mfma_f32_16x16x32_bf16 v[16:19], a[180:183], v[56:59], v[16:19]
    s_waitcnt vmcnt(8)
    v_mfma_f32_16x16x32_bf16 v[8:11], a[184:187], v[60:63], v[8:11]
    v_mfma_f32_16x16x32_bf16 v[16:19], a[188:191], v[60:63], v[16:19]
    s_waitcnt vmcnt(7)
    v_mfma_f32_16x16x32_bf16 v[8:11], a[192:195], v[64:67], v[8:11]
    v_mfma_f32_16x16x32_bf16 v[16:19], a[196:199], v[64:67], v[16:19]
    s_waitcnt vmcnt(6)
    v_mfma_f32_16x16x32_bf16 v[8:11], a[200:203], v[68:71], v[8:11]
    v_mfma_f32_16x16x32_bf16 v[16:19], a[204:207], v[68:71], v[16:19]
    s_waitcnt vmcnt(5)
    v_mfma_f32_16x16x32_bf16 v[8:11], a[208:211], v[72:75], v[8:11]
    v_mfma_f32_16x16x32_bf16 v[16:19], a[212:215], v[72:75], v[16:19]
    s_waitcnt vmcnt(4)
    v_mfma_f32_16x16x32_bf16 v[8:11], a[216:219], v[76:79], v[8:11]
    v_mfma_f32_16x16x32_bf16 v[16:19], a[220:223], v[76:79], v[16:19]
    s_waitcnt vmcnt(3)
    v_mfma_f32_16x16x32_bf16 v[8:11], a[224:227], v[80:83], v[8:11]
    v_mfma_f32_16x16x32_bf16 v[16:19], a[228:231], v[80:83], v[16:19]
    s_waitcnt vmcnt(2)
    v_mfma_f32_16x16x32_bf16 v[8:11], a[232:235], v[84:87], v[8:11]
    v_mfma_f32_16x16x32_bf16 v[16:19], a[236:239], v[84:87], v[16:19]
    s_waitcnt vmcnt(1)
    v_mfma_f32_16x16x32_bf16 v[8:11], a[240:243], v[88:91], v[8:11]
    v_mfma_f32_16x16x32_bf16 v[16:19], a[244:247], v[88:91], v[16:19]
    s_waitcnt vmcnt(0)
    v_mfma_f32_16x16x32_bf16 v[8:11], a[248:251], v[92:95], v[8:11]
    v_mfma_f32_16x16x32_bf16 v[16:19], a[252:255], v[92:95], v[16:19]
    s_lshl_b32 s5, s4, 12
    s_add_u32 s5, s5, 0
    v_add_u32 v4, s5, v1
    s_nop 0
    ds_write_b128 v4, v[8:11] offset:0
    s_nop 2
    ds_write_b128 v4, v[16:19] offset:1024
    s_waitcnt lgkmcnt(0)
    s_barrier
    s_lshl_b32 s5, s4, 10
    s_add_u32 s5, s5, 0
    v_add_u32 v4, s5, v1
    ds_read_b128 v[40:43], v4 offset:0
    ds_read_b128 v[44:47], v4 offset:4096
    ds_read_b128 v[48:51], v4 offset:8192
    ds_read_b128 v[52:55], v4 offset:12288
    s_waitcnt lgkmcnt(0)
    s_barrier
    s_cmp_ge_u32 s4, 2
    s_cbranch_scc1 wo_skip
    v_add_f32 v40, v40, v44
    v_add_f32 v48, v48, v52
    v_add_f32 v40, v40, v48
    v_add_f32 v41, v41, v45
    v_add_f32 v49, v49, v53
    v_add_f32 v41, v41, v49
    v_add_f32 v42, v42, v46
    v_add_f32 v50, v50, v54
    v_add_f32 v42, v42, v50
    v_add_f32 v43, v43, v47
    v_add_f32 v51, v51, v55
    v_add_f32 v43, v43, v51
    v_cvt_pk_bf16_f32 v44, v40, v41
    v_cvt_pk_bf16_f32 v45, v42, v43
    v_lshlrev_b32 v40, 16, v44
    v_and_b32 v41, 0xffff0000, v44
    v_lshlrev_b32 v42, 16, v45
    v_and_b32 v43, 0xffff0000, v45
    v_lshlrev_b32 v44, 16, v24
    v_and_b32 v45, 0xffff0000, v24
    v_lshlrev_b32 v46, 16, v25
    v_and_b32 v47, 0xffff0000, v25
    v_mul_f32 v40, v40, v44
    v_mul_f32 v41, v41, v45
    v_mul_f32 v42, v42, v46
    v_mul_f32 v43, v43, v47
    v_cvt_pk_bf16_f32 v44, v40, v41
    v_cvt_pk_bf16_f32 v45, v42, v43
    v_lshlrev_b32 v40, 16, v44
    v_and_b32 v41, 0xffff0000, v44
    v_lshlrev_b32 v42, 16, v45
    v_and_b32 v43, 0xffff0000, v45
    v_lshlrev_b32 v44, 16, v26
    v_and_b32 v45, 0xffff0000, v26
    v_lshlrev_b32 v46, 16, v27
    v_and_b32 v47, 0xffff0000, v27
    v_add_f32 v40, v40, v44
    v_add_f32 v41, v41, v45
    v_add_f32 v42, v42, v46
    v_add_f32 v43, v43, v47
    v_cvt_pk_bf16_f32 v44, v40, v41
    v_cvt_pk_bf16_f32 v45, v42, v43
    buffer_store_dwordx2 v[44:45], v2, s[32:35], s22 offen
wo_skip:
    s_add_u32 s17, s17, 2
    s_cmp_lt_u32 s17, 64
    s_cbranch_scc1 wo_loop
    s_waitcnt vmcnt(0)
    s_endpgm
mg_f2:
    s_and_b32 s3, s6, 15
    s_lshr_b32 s16, s6, 4
    s_load_dwordx2 s[68:69], s[0:1], 96
    s_waitcnt lgkmcnt(0)
    s_mov_b32 s64, s68
    s_and_b32 s65, s69, 0xffff
    s_mov_b32 s66, 256
    s_mov_b32 s67, 0x20000
    s_load_dwordx2 s[36:37], s[0:1], 80
    s_load_dwordx2 s[38:39], s[0:1], 104
    s_load_dwordx2 s[40:41], s[0:1], 0
    s_load_dwordx2 s[42:43], s[0:1], 88
    v_lshrrev_b32 v24, 6, v0
    v_and_b32 v0, 63, v0
    v_readfirstlane_b32 s4, v24
    v_lshlrev_b32 v1, 4, v0
    v_and_b32 v24, 15, v0
    v_lshrrev_b32 v25, 4, v0
    v_lshlrev_b32 v26, 10, v24
    v_lshl_add_u32 v26, v25, 3, v26
    s_and_b32 s5, s4, 1
    s_lshl_b32 s5, s5, 5
    s_lshl_b32 s6, s3, 6
    s_add_u32 s5, s5, s6
    s_lshr_b32 s6, s4, 1
    s_lshl_b32 s6, s6, 14
    s_add_u32 s5, s5, s6
    v_add_u32 v2, s5, v26
    s_waitcnt lgkmcnt(0)
    s_mov_b32 s8, s38
    s_and_b32 s9, s39, 0xffff
    s_mov_b32 s10, 268435456
    s_mov_b32 s11, 0x20000
    s_mov_b32 s12, s36
    s_and_b32 s13, s37, 0xffff
    s_mov_b32 s14, 1835008
    s_mov_b32 s15, 0x20000
    s_mov_b32 s24, s40
    s_and_b32 s25, s41, 0xffff
    s_mov_b32 s26, 2097152
    s_mov_b32 s27, 0x20000
    s_mov_b32 s32, s42
    s_and_b32 s33, s43, 0xffff
    s_mov_b32 s34, 2097152
    s_mov_b32 s35, 0x20000
    v_and_b32 v26, 7, v0
    v_min_u32 v26, 6, v26
    v_lshlrev_b32 v26, 2, v26
    v_add_u32 v3, 3072, v26
    v_lshrrev_b32 v26, 2, v0
    v_lshlrev_b32 v26, 10, v26
    v_bfe_u32 v27, v0, 4, 1
    v_lshlrev_b32 v27, 1, v27
    v_and_b32 v28, 3, v0
    v_xor_b32 v27, v27, v28
    v_lshl_add_u32 v24, v27, 4, v26
    v_bfe_u32 v28, v0, 2, 2
    v_lshl_add_u32 v28, v25, 2, v28
    v_lshlrev_b32 v28, 6, v28
    v_and_b32 v29, 1, v25
    v_lshlrev_b32 v29, 1, v29
    v_bfe_u32 v30, v0, 1, 1
    v_xor_b32 v29, v29, v30
    v_lshl_add_u32 v28, v29, 4, v28
    v_and_b32 v29, 1, v0
    v_lshl_add_u32 v28, v29, 3, v28
    s_lshl_b32 s5, s4, 15
    v_add_u32 v26, s5, v28
    v_xor_b32 v27, 32, v26
    s_mul_i32 s5, s4, 458752
    s_lshl_b32 s6, s3, 6
    s_add_u32 s5, s5, s6
    s_lshl_b32 s6, s4, 15
    s_mov_b32 m0, s6
    s_nop 0
    buffer_load_dwordx4 v24, s[12:15], s5 offen lds
    s_add_u32 s5, s5, 16384
    s_add_u32 s6, s6, 1024
    s_mov_b32 m0, s6
    s_nop 0
    buffer_load_dwordx4 v24, s[12:15], s5 offen lds
    s_add_u32 s5, s5, 16384
    s_add_u32 s6, s6, 1024
    s_mov_b32 m0, s6
    s_nop 0
    buffer_load_dwordx4 v24, s[12:15], s5 offen lds
    s_add_u32 s5, s5, 16384
    s_add_u32 s6, s6, 1024
    s_mov_b32 m0, s6
    s_nop 0
    buffer_load_dwordx4 v24, s[12:15], s5 offen lds
    s_add_u32 s5, s5, 16384
    s_add_u32 s6, s6, 1024
    s_mov_b32 m0, s6
    s_nop 0
    buffer_load_dwordx4 v24, s[12:15], s5 offen lds
    s_add_u32 s5, s5, 16384
    s_add_u32 s6, s6, 1024
    s_mov_b32 m0, s6
    s_nop 0
    buffer_load_dwordx4 v24, s[12:15], s5 offen lds
    s_add_u32 s5, s5, 16384
    s_add_u32 s6, s6, 1024
    s_mov_b32 m0, s6
    s_nop 0
    buffer_load_dwordx4 v24, s[12:15], s5 offen lds
    s_add_u32 s5, s5, 16384
    s_add_u32 s6, s6, 1024
    s_mov_b32 m0, s6
    s_nop 0
    buffer_load_dwordx4 v24, s[12:15], s5 offen lds
    s_add_u32 s5, s5, 16384
    s_add_u32 s6, s6, 1024
    s_mov_b32 m0, s6
    s_nop 0
    buffer_load_dwordx4 v24, s[12:15], s5 offen lds
    s_add_u32 s5, s5, 16384
    s_add_u32 s6, s6, 1024
    s_mov_b32 m0, s6
    s_nop 0
    buffer_load_dwordx4 v24, s[12:15], s5 offen lds
    s_add_u32 s5, s5, 16384
    s_add_u32 s6, s6, 1024
    s_mov_b32 m0, s6
    s_nop 0
    buffer_load_dwordx4 v24, s[12:15], s5 offen lds
    s_add_u32 s5, s5, 16384
    s_add_u32 s6, s6, 1024
    s_mov_b32 m0, s6
    s_nop 0
    buffer_load_dwordx4 v24, s[12:15], s5 offen lds
    s_add_u32 s5, s5, 16384
    s_add_u32 s6, s6, 1024
    s_mov_b32 m0, s6
    s_nop 0
    buffer_load_dwordx4 v24, s[12:15], s5 offen lds
    s_add_u32 s5, s5, 16384
    s_add_u32 s6, s6, 1024
    s_mov_b32 m0, s6
    s_nop 0
    buffer_load_dwordx4 v24, s[12:15], s5 offen lds
    s_add_u32 s5, s5, 16384
    s_add_u32 s6, s6, 1024
    s_mov_b32 m0, s6
    s_nop 0
    buffer_load_dwordx4 v24, s[12:15], s5 offen lds
    s_add_u32 s5, s5, 16384
    s_add_u32 s6, s6, 1024
    s_mov_b32 m0, s6
    s_nop 0
    buffer_load_dwordx4 v24, s[12:15], s5 offen lds
    s_add_u32 s5, s5, 16384
    s_add_u32 s6, s6, 1024
    s_mov_b32 m0, s6
    s_nop 0
    buffer_load_dwordx4 v24, s[12:15], s5 offen lds
    s_add_u32 s5, s5, 16384
    s_add_u32 s6, s6, 1024
    s_mov_b32 m0, s6
    s_nop 0
    buffer_load_dwordx4 v24, s[12:15], s5 offen lds
    s_add_u32 s5, s5, 16384
    s_add_u32 s6, s6, 1024
    s_mov_b32 m0, s6
    s_nop 0
    buffer_load_dwordx4 v24, s[12:15], s5 offen lds
    s_add_u32 s5, s5, 16384
    s_add_u32 s6, s6, 1024
    s_mov_b32 m0, s6
    s_nop 0
    buffer_load_dwordx4 v24, s[12:15], s5 offen lds
    s_add_u32 s5, s5, 16384
    s_add_u32 s6, s6, 1024
    s_mov_b32 m0, s6
    s_nop 0
    buffer_load_dwordx4 v24, s[12:15], s5 offen lds
    s_add_u32 s5, s5, 16384
    s_add_u32 s6, s6, 1024
    s_mov_b32 m0, s6
    s_nop 0
    buffer_load_dwordx4 v24, s[12:15], s5 offen lds
    s_add_u32 s5, s5, 16384
    s_add_u32 s6, s6, 1024
    s_mov_b32 m0, s6
    s_nop 0
    buffer_load_dwordx4 v24, s[12:15], s5 offen lds
    s_add_u32 s5, s5, 16384
    s_add_u32 s6, s6, 1024
    s_mov_b32 m0, s6
    s_nop 0
    buffer_load_dwordx4 v24, s[12:15], s5 offen lds
    s_add_u32 s5, s5, 16384
    s_add_u32 s6, s6, 1024
    s_mov_b32 m0, s6
    s_nop 0
    buffer_load_dwordx4 v24, s[12:15], s5 offen lds
    s_add_u32 s5, s5, 16384
    s_add_u32 s6, s6, 1024
    s_mov_b32 m0, s6
    s_nop 0
    buffer_load_dwordx4 v24, s[12:15], s5 offen lds
    s_add_u32 s5, s5, 16384
    s_add_u32 s6, s6, 1024
    s_mov_b32 m0, s6
    s_nop 0
    buffer_load_dwordx4 v24, s[12:15], s5 offen lds
    s_add_u32 s5, s5, 16384
    s_add_u32 s6, s6, 1024
    s_mov_b32 m0, s6
    s_nop 0
    buffer_load_dwordx4 v24, s[12:15], s5 offen lds
    s_lshl_b32 s7, s3, 2
    s_lshl_b32 s20, s16, 6
    s_add_u32 s7, s7, s20
    s_add_u32 s7, s7, 3328
    v_mov_b32 v40, 0
    buffer_store_dword v40, off, s[8:11], s7 sc1
    s_waitcnt vmcnt(0)
    s_barrier
    s_cmp_lg_u32 s4, 0
    s_cbranch_scc1 dba_10
    v_mov_b32 v40, 1
    s_mov_b64 exec, 1
    buffer_atomic_add v40, off, s[64:67], 0 offset:128 sc1
    s_mov_b64 exec, -1
dba_10:
    ds_read_b64_tr_b16 a[0:1], v26 offset:0
    ds_read_b64_tr_b16 a[2:3], v26 offset:1024
    ds_read_b64_tr_b16 a[4:5], v27 offset:0
    ds_read_b64_tr_b16 a[6:7], v27 offset:1024
    ds_read_b64_tr_b16 a[8:9], v26 offset:2048
    ds_read_b64_tr_b16 a[10:11], v26 offset:3072
    ds_read_b64_tr_b16 a[12:13], v27 offset:2048
    ds_read_b64_tr_b16 a[14:15], v27 offset:3072
    s_waitcnt lgkmcnt(4)
    ds_read_b64_tr_b16 a[16:17], v26 offset:4096
    ds_read_b64_tr_b16 a[18:19], v26 offset:5120
    ds_read_b64_tr_b16 a[20:21], v27 offset:4096
    ds_read_b64_tr_b16 a[22:23], v27 offset:5120
    ds_read_b64_tr_b16 a[24:25], v26 offset:6144
    ds_read_b64_tr_b16 a[26:27], v26 offset:7168
    ds_read_b64_tr_b16 a[28:29], v27 offset:6144
    ds_read_b64_tr_b16 a[30:31], v27 offset:7168
    s_waitcnt lgkmcnt(4)
    ds_read_b64_tr_b16 a[32:33], v26 offset:8192
    ds_read_b64_tr_b16 a[34:35], v26 offset:9216
    ds_read_b64_tr_b16 a[36:37], v27 offset:8192
    ds_read_b64_tr_b16 a[38:39], v27 offset:9216
    ds_read_b64_tr_b16 a[40:41], v26 offset:10240
    ds_read_b64_tr_b16 a[42:43], v26 offset:11264
    ds_read_b64_tr_b16 a[44:45], v27 offset:10240
    ds_read_b64_tr_b16 a[46:47], v27 offset:11264
    s_waitcnt lgkmcnt(4)
    ds_read_b64_tr_b16 a[48:49], v26 offset:12288
    ds_read_b64_tr_b16 a[50:51], v26 offset:13312
    ds_read_b64_tr_b16 a[52:53], v27 offset:12288
    ds_read_b64_tr_b16 a[54:55], v27 offset:13312
    ds_read_b64_tr_b16 a[56:57], v26 offset:14336
    ds_read_b64_tr_b16 a[58:59], v26 offset:15360
    ds_read_b64_tr_b16 a[60:61], v27 offset:14336
    ds_read_b64_tr_b16 a[62:63], v27 offset:15360
    s_waitcnt lgkmcnt(4)
    ds_read_b64_tr_b16 a[64:65], v26 offset:16384
    ds_read_b64_tr_b16 a[66:67], v26 offset:17408
    ds_read_b64_tr_b16 a[68:69], v27 offset:16384
    ds_read_b64_tr_b16 a[70:71], v27 offset:17408
    ds_read_b64_tr_b16 a[72:73], v26 offset:18432
    ds_read_b64_tr_b16 a[74:75], v26 offset:19456
    ds_read_b64_tr_b16 a[76:77], v27 offset:18432
    ds_read_b64_tr_b16 a[78:79], v27 offset:19456
    s_waitcnt lgkmcnt(4)
    ds_read_b64_tr_b16 a[80:81], v26 offset:20480
    ds_read_b64_tr_b16 a[82:83], v26 offset:21504
    ds_read_b64_tr_b16 a[84:85], v27 offset:20480
    ds_read_b64_tr_b16 a[86:87], v27 offset:21504
    ds_read_b64_tr_b16 a[88:89], v26 offset:22528
    ds_read_b64_tr_b16 a[90:91], v26 offset:23552
    ds_read_b64_tr_b16 a[92:93], v27 offset:22528
    ds_read_b64_tr_b16 a[94:95], v27 offset:23552
    s_waitcnt lgkmcnt(4)
    ds_read_b64_tr_b16 a[96:97], v26 offset:24576
    ds_read_b64_tr_b16 a[98:99], v26 offset:25600
    ds_read_b64_tr_b16 a[100:101], v27 offset:24576
    ds_read_b64_tr_b16 a[102:103], v27 offset:25600
    ds_read_b64_tr_b16 a[104:105], v26 offset:26624
    ds_read_b64_tr_b16 a[106:107], v26 offset:27648
    ds_read_b64_tr_b16 a[108:109], v27 offset:26624
    ds_read_b64_tr_b16 a[110:111], v27 offset:27648
    s_waitcnt lgkmcnt(4)
    s_waitcnt lgkmcnt(0)
    s_barrier
    s_cmp_lg_u32 s4, 0
    s_cbranch_scc1 dbw_11_x
    s_mov_b32 s70, 0
dbw_11:
    buffer_load_dword v40, off, s[64:67], 0 offset:128 sc1
    s_add_u32 s70, s70, 1
    s_cmp_gt_u32 s70, 0x10000
    s_cbranch_scc1 dbw_11_y
    s_waitcnt vmcnt(0)
    v_readfirstlane_b32 s71, v40
    s_nop 0
    s_cmp_ge_u32 s71, 174
    s_cbranch_scc1 dbw_11_x
    s_sleep 8
    s_branch dbw_11
dbw_11_y:
    s_waitcnt vmcnt(0)
dbw_11_x:
    s_barrier
    s_mov_b32 s17, s16
    s_mov_b32 s30, 0
    s_mov_b32 s18, 0
f2_loop:
    s_lshl_b32 s22, s17, 15
    s_mul_hi_u32 s20, s17, 2147483648
    s_mul_i32 s5, s20, 2
    s_sub_u32 s5, s17, s5
    s_mul_i32 s21, s5, 32
    s_add_u32 s20, s20, 1
    s_mul_i32 s19, s17, 114688
    s_mul_i32 s5, s4, 14336
    s_add_u32 s19, s19, s5
    s_add_u32 s19, s19, 16777216
    s_add_u32 s18, s18, 0
    s_mov_b32 s31, 0
f2_a_12:
    buffer_load_dword v6, v3, s[8:11], s21 offen sc1
    s_add_u32 s31, s31, 1
    s_cmp_gt_u32 s31, 0x8000
    s_cbranch_scc1 f2_a_12_fail
    s_waitcnt vmcnt(0)
    v_cmp_gt_u32 vcc, s20, v6
    s_cbranch_vccz f2_a_12_ok
    s_sleep 2
    s_branch f2_a_12
f2_a_12_fail:
    s_add_u32 s30, s30, 1
    s_waitcnt vmcnt(0)
f2_a_12_ok:
    s_add_u32 s23, s19, 57344
    buffer_load_dwordx4 v[32:35], v1, s[8:11], s19 offen offset:0 sc1
    buffer_load_dwordx4 v[36:39], v1, s[8:11], s23 offen offset:0 sc1
    buffer_load_dwordx4 v[40:43], v1, s[8:11], s19 offen offset:1024 sc1
    buffer_load_dwordx4 v[44:47], v1, s[8:11], s23 offen offset:1024 sc1
    buffer_load_dwordx4 v[48:51], v1, s[8:11], s19 offen offset:2048 sc1
    buffer_load_dwordx4 v[52:55], v1, s[8:11], s23 offen offset:2048 sc1
    buffer_load_dwordx4 v[56:59], v1, s[8:11], s19 offen offset:3072 sc1
    buffer_load_dwordx4 v[60:63], v1, s[8:11], s23 offen offset:3072 sc1
    s_add_u32 s5, s19, 4096
    buffer_load_dwordx4 v[64:67], v1, s[8:11], s5 offen offset:0 sc1
    s_add_u32 s5, s23, 4096
    buffer_load_dwordx4 v[68:71], v1, s[8:11], s5 offen offset:0 sc1
    s_add_u32 s5, s19, 4096
    buffer_load_dwordx4 v[72:75], v1, s[8:11], s5 offen offset:1024 sc1
    s_add_u32 s5, s23, 4096
    buffer_load_dwordx4 v[76:79], v1, s[8:11], s5 offen offset:1024 sc1
    s_add_u32 s5, s19, 4096
    buffer_load_dwordx4 v[80:83], v1, s[8:11], s5 offen offset:2048 sc1
    s_add_u32 s5, s23, 4096
    buffer_load_dwordx4 v[84:87], v1, s[8:11], s5 offen offset:2048 sc1
    s_add_u32 s5, s19, 4096
    buffer_load_dwordx4 v[88:91], v1, s[8:11], s5 offen offset:3072 sc1
    s_add_u32 s5, s23, 4096
    buffer_load_dwordx4 v[92:95], v1, s[8:11], s5 offen offset:3072 sc1
    s_waitcnt vmcnt(14)
    v_mfma_f32_16x16x32_bf16 v[8:11], a[0:3], v[32:35], 0
    v_mfma_f32_16x16x32_bf16 v[16:19], a[4:7], v[32:35], 0
    v_mfma_f32_16x16x32_bf16 v[12:15], a[0:3], v[36:39], 0
    v_mfma_f32_16x16x32_bf16 v[20:23], a[4:7], v[36:39], 0
    s_add_u32 s5, s19, 8192
    buffer_load_dwordx4 v[32:35], v1, s[8:11], s5 offen offset:0 sc1
    s_add_u32 s5, s23, 8192
    buffer_load_dwordx4 v[36:39], v1, s[8:11], s5 offen offset:0 sc1
    s_waitcnt vmcnt(14)
    v_mfma_f32_16x16x32_bf16 v[8:11], a[8:11], v[40:43], v[8:11]
    v_mfma_f32_16x16x32_bf16 v[16:19], a[12:15], v[40:43], v[16:19]
    v_mfma_f32_16x16x32_bf16 v[12:15], a[8:11], v[44:47], v[12:15]
    v_mfma_f32_16x16x32_bf16 v[20:23], a[12:15], v[44:47], v[20:23]
    s_add_u32 s5, s19, 8192
    buffer_load_dwordx4 v[40:43], v1, s[8:11], s5 offen offset:1024 sc1
    s_add_u32 s5, s23, 8192
    buffer_load_dwordx4 v[44:47], v1, s[8:11], s5 offen offset:1024 sc1
    s_waitcnt vmcnt(14)
    v_mfma_f32_16x16x32_bf16 v[8:11], a[16:19], v[48:51], v[8:11]
    v_mfma_f32_16x16x32_bf16 v[16:19], a[20:23], v[48:51], v[16:19]
    v_mfma_f32_16x16x32_bf16 v[12:15], a[16:19], v[52:55], v[12:15]
    v_mfma_f32_16x16x32_bf16 v[20:23], a[20:23], v[52:55], v[20:23]
    s_add_u32 s5, s19, 8192
    buffer_load_dwordx4 v[48:51], v1, s[8:11], s5 offen offset:2048 sc1
    s_add_u32 s5, s23, 8192
    buffer_load_dwordx4 v[52:55], v1, s[8:11], s5 offen offset:2048 sc1
    s_waitcnt vmcnt(14)
    v_mfma_f32_16x16x32_bf16 v[8:11], a[24:27], v[56:59], v[8:11]
    v_mfma_f32_16x16x32_bf16 v[16:19], a[28:31], v[56:59], v[16:19]
    v_mfma_f32_16x16x32_bf16 v[12:15], a[24:27], v[60:63], v[12:15]
    v_mfma_f32_16x16x32_bf16 v[20:23], a[28:31], v[60:63], v[20:23]
    s_add_u32 s5, s19, 8192
    buffer_load_dwordx4 v[56:59], v1, s[8:11], s5 offen offset:3072 sc1
    s_add_u32 s5, s23, 8192
    buffer_load_dwordx4 v[60:63], v1, s[8:11], s5 offen offset:3072 sc1
    s_waitcnt vmcnt(14)
    v_mfma_f32_16x16x32_bf16 v[8:11], a[32:35], v[64:67], v[8:11]
    v_mfma_f32_16x16x32_bf16 v[16:19], a[36:39], v[64:67], v[16:19]
    v_mfma_f32_16x16x32_bf16 v[12:15], a[32:35], v[68:71], v[12:15]
    v_mfma_f32_16x16x32_bf16 v[20:23], a[36:39], v[68:71], v[20:23]
    s_add_u32 s5, s19, 12288
    buffer_load_dwordx4 v[64:67], v1, s[8:11], s5 offen offset:0 sc1
    s_add_u32 s5, s23, 12288
    buffer_load_dwordx4 v[68:71], v1, s[8:11], s5 offen offset:0 sc1
    s_waitcnt vmcnt(14)
    v_mfma_f32_16x16x32_bf16 v[8:11], a[40:43], v[72:75], v[8:11]
    v_mfma_f32_16x16x32_bf16 v[16:19], a[44:47], v[72:75], v[16:19]
    v_mfma_f32_16x16x32_bf16 v[12:15], a[40:43], v[76:79], v[12:15]
    v_mfma_f32_16x16x32_bf16 v[20:23], a[44:47], v[76:79], v[20:23]
    s_add_u32 s5, s19, 12288
    buffer_load_dwordx4 v[72:75], v1, s[8:11], s5 offen offset:1024 sc1
    s_add_u32 s5, s23, 12288
    buffer_load_dwordx4 v[76:79], v1, s[8:11], s5 offen offset:1024 sc1
    s_waitcnt vmcnt(14)
    v_mfma_f32_16x16x32_bf16 v[8:11], a[48:51], v[80:83], v[8:11]
    v_mfma_f32_16x16x32_bf16 v[16:19], a[52:55], v[80:83], v[16:19]
    v_mfma_f32_16x16x32_bf16 v[12:15], a[48:51], v[84:87], v[12:15]
    v_mfma_f32_16x16x32_bf16 v[20:23], a[52:55], v[84:87], v[20:23]
    s_waitcnt vmcnt(12)
    v_mfma_f32_16x16x32_bf16 v[8:11], a[56:59], v[88:91], v[8:11]
    v_mfma_f32_16x16x32_bf16 v[16:19], a[60:63], v[88:91], v[16:19]
    v_mfma_f32_16x16x32_bf16 v[12:15], a[56:59], v[92:95], v[12:15]
    v_mfma_f32_16x16x32_bf16 v[20:23], a[60:63], v[92:95], v[20:23]
    s_waitcnt vmcnt(10)
    v_mfma_f32_16x16x32_bf16 v[8:11], a[64:67], v[32:35], v[8:11]
    v_mfma_f32_16x16x32_bf16 v[16:19], a[68:71], v[32:35], v[16:19]
    v_mfma_f32_16x16x32_bf16 v[12:15], a[64:67], v[36:39], v[12:15]
    v_mfma_f32_16x16x32_bf16 v[20:23], a[68:71], v[36:39], v[20:23]
    s_waitcnt vmcnt(8)
    v_mfma_f32_16x16x32_bf16 v[8:11], a[72:75], v[40:43], v[8:11]
    v_mfma_f32_16x16x32_bf16 v[16:19], a[76:79], v[40:43], v[16:19]
    v_mfma_f32_16x16x32_bf16 v[12:15], a[72:75], v[44:47], v[12:15]
    v_mfma_f32_16x16x32_bf16 v[20:23], a[76:79], v[44:47], v[20:23]
    s_waitcnt vmcnt(6)
    v_mfma_f32_16x16x32_bf16 v[8:11], a[80:83], v[48:51], v[8:11]
    v_mfma_f32_16x16x32_bf16 v[16:19], a[84:87], v[48:51], v[16:19]
    v_mfma_f32_16x16x32_bf16 v[12:15], a[80:83], v[52:55], v[12:15]
    v_mfma_f32_16x16x32_bf16 v[20:23], a[84:87], v[52:55], v[20:23]
    s_waitcnt vmcnt(4)
    v_mfma_f32_16x16x32_bf16 v[8:11], a[88:91], v[56:59], v[8:11]
    v_mfma_f32_16x16x32_bf16 v[16:19], a[92:95], v[56:59], v[16:19]
    v_mfma_f32_16x16x32_bf16 v[12:15], a[88:91], v[60:63], v[12:15]
    v_mfma_f32_16x16x32_bf16 v[20:23], a[92:95], v[60:63], v[20:23]
    s_waitcnt vmcnt(2)
    v_mfma_f32_16x16x32_bf16 v[8:11], a[96:99], v[64:67], v[8:11]
    v_mfma_f32_16x16x32_bf16 v[16:19], a[100:103], v[64:67], v[16:19]
    v_mfma_f32_16x16x32_bf16 v[12:15], a[96:99], v[68:71], v[12:15]
    v_mfma_f32_16x16x32_bf16 v[20:23], a[100:103], v[68:71], v[20:23]
    s_waitcnt vmcnt(0)
    v_mfma_f32_16x16x32_bf16 v[8:11], a[104:107], v[72:75], v[8:11]
    v_mfma_f32_16x16x32_bf16 v[16:19], a[108:111], v[72:75], v[16:19]
    v_mfma_f32_16x16x32_bf16 v[12:15], a[104:107], v[76:79], v[12:15]
    v_mfma_f32_16x16x32_bf16 v[20:23], a[108:111], v[76:79], v[20:23]
    s_lshl_b32 s5, s4, 12
    s_add_u32 s5, s5, 0
    v_add_u32 v4, s5, v1
    ds_write_b128 v4, v[8:11] offset:0
    ds_write_b128 v4, v[12:15] offset:2048
    ds_write_b128 v4, v[16:19] offset:1024
    s_nop 1
    ds_write_b128 v4, v[20:23] offset:3072
    s_waitcnt lgkmcnt(0)
    s_barrier
    s_lshl_b32 s5, s4, 10
    s_add_u32 s5, s5, 0
    v_add_u32 v4, s5, v1
    ds_read_b128 v[40:43], v4 offset:0
    ds_read_b128 v[44:47], v4 offset:4096
    ds_read_b128 v[48:51], v4 offset:8192
    ds_read_b128 v[52:55], v4 offset:12288
    s_waitcnt lgkmcnt(0)
    s_barrier
    v_add_f32 v40, v40, v44
    v_add_f32 v48, v48, v52
    v_add_f32 v40, v40, v48
    v_add_f32 v41, v41, v45
    v_add_f32 v49, v49, v53
    v_add_f32 v41, v41, v49
    v_add_f32 v42, v42, v46
    v_add_f32 v50, v50, v54
    v_add_f32 v42, v42, v50
    v_add_f32 v43, v43, v47
    v_add_f32 v51, v51, v55
    v_add_f32 v43, v43, v51
    v_cvt_pk_bf16_f32 v44, v40, v41
    v_cvt_pk_bf16_f32 v45, v42, v43
    v_lshlrev_b32 v40, 16, v44
    v_and_b32 v41, 0xffff0000, v44
    v_lshlrev_b32 v42, 16, v45
    v_and_b32 v43, 0xffff0000, v45
    v_mul_f32 v44, 0xbfb8aa3b, v40
    v_mul_f32 v45, 0xbfb8aa3b, v41
    v_mul_f32 v46, 0xbfb8aa3b, v42
    v_mul_f32 v47, 0xbfb8aa3b, v43
    v_exp_f32 v44, v44
    v_exp_f32 v45, v45
    v_exp_f32 v46, v46
    v_exp_f32 v47, v47
    v_add_f32 v44, 1.0, v44
    v_add_f32 v45, 1.0, v45
    v_add_f32 v46, 1.0, v46
    v_add_f32 v47, 1.0, v47
    v_rcp_f32 v44, v44
    v_rcp_f32 v45, v45
    v_rcp_f32 v46, v46
    v_rcp_f32 v47, v47
    v_mul_f32 v40, v40, v44
    v_mul_f32 v41, v41, v45
    v_mul_f32 v42, v42, v46
    v_mul_f32 v43, v43, v47
    v_cvt_pk_bf16_f32 v44, v40, v41
    v_cvt_pk_bf16_f32 v45, v42, v43
    s_add_u32 s5, s22, 3145728
    buffer_store_dwordx2 v[44:45], v2, s[8:11], s5 offen sc1
    s_add_u32 s18, s18, 1
    s_waitcnt vmcnt(0)
    s_barrier
    s_lshl_b32 s5, s3, 2
    s_lshl_b32 s6, s16, 6
    s_add_u32 s5, s5, s6
    s_add_u32 s21, s5, 3328
    s_cmp_lg_u32 s4, 0
    s_cbranch_scc1 f2_pf_13
    v_mov_b32 v6, s18
    v_mov_b32 v7, 0
    s_mov_b64 exec, 1
    buffer_store_dword v6, v7, s[8:11], s21 offen sc1
    s_mov_b64 exec, -1
f2_pf_13:
    s_add_u32 s17, s17, 2
    s_cmp_lt_u32 s17, 64
    s_cbranch_scc1 f2_loop
    s_waitcnt vmcnt(0)
    s_endpgm
mg_qkv:
    s_mul_hi_u32 s3, s5, 1431655766
    s_mul_i32 s6, s3, 3
    s_sub_u32 s16, s5, s6
    s_load_dwordx2 s[68:69], s[0:1], 96
    s_waitcnt lgkmcnt(0)
    s_mov_b32 s64, s68
    s_and_b32 s65, s69, 0xffff
    s_mov_b32 s66, 256
    s_mov_b32 s67, 0x20000
    s_load_dwordx4 s[36:39], s[0:1], 16
    s_load_dwordx2 s[40:41], s[0:1], 32
    s_load_dwordx2 s[42:43], s[0:1], 104
    v_lshrrev_b32 v24, 6, v0
    v_and_b32 v0, 63, v0
    v_readfirstlane_b32 s4, v24
    v_lshlrev_b32 v1, 4, v0
    v_and_b32 v24, 15, v0
    v_lshrrev_b32 v25, 4, v0
    s_and_b32 s32, s4, 1
    s_lshr_b32 s33, s4, 1
    v_lshrrev_b32 v26, 2, v24
    v_lshlrev_b32 v26, 1, v26
    v_and_b32 v27, 1, v24
    v_add_u32 v26, v26, v27
    v_lshlrev_b32 v26, 8, v26
    v_lshl_add_u32 v2, v25, 4, v26
    v_lshlrev_b32 v26, 3, v0
    s_lshl_b32 s5, s33, 10
    v_add_u32 v3, s5, v26
    s_lshl_b32 s5, s3, 4
    s_add_u32 s5, s5, 1024
    v_mov_b32 v5, s5
    s_lshl_b32 s5, s32, 4
    v_add_u32 v26, s5, v24
    v_lshlrev_b32 v27, 2, v25
    v_mov_b32 v29, 0xf149f2ca
    v_add_u32 v28, 0, v27
    v_cmp_gt_u32 vcc, v28, v26
    s_nop 1
    v_cndmask_b32 v8, 0, v29, vcc
    v_add_u32 v28, 1, v27
    v_cmp_gt_u32 vcc, v28, v26
    s_nop 1
    v_cndmask_b32 v9, 0, v29, vcc
    v_add_u32 v28, 2, v27
    v_cmp_gt_u32 vcc, v28, v26
    s_nop 1
    v_cndmask_b32 v10, 0, v29, vcc
    v_add_u32 v28, 3, v27
    v_cmp_gt_u32 vcc, v28, v26
    s_nop 1
    v_cndmask_b32 v11, 0, v29, vcc
    v_add_u32 v28, 16, v27
    v_cmp_gt_u32 vcc, v28, v26
    s_nop 1
    v_cndmask_b32 v12, 0, v29, vcc
    v_add_u32 v28, 17, v27
    v_cmp_gt_u32 vcc, v28, v26
    s_nop 1
    v_cndmask_b32 v13, 0, v29, vcc
    v_add_u32 v28, 18, v27
    v_cmp_gt_u32 vcc, v28, v26
    s_nop 1
    v_cndmask_b32 v14, 0, v29, vcc
    v_add_u32 v28, 19, v27
    v_cmp_gt_u32 vcc, v28, v26
    s_nop 1
    v_cndmask_b32 v15, 0, v29, vcc
    v_mov_b32 v16, 0
    v_mov_b32 v17, 0
    v_mov_b32 v18, v29
    v_mov_b32 v19, v29
    s_waitcnt lgkmcnt(0)
    s_mov_b32 s8, s42
    s_and_b32 s9, s43, 0xffff
    s_mov_b32 s10, 268435456
    s_mov_b32 s11, 0x20000
    v_lshrrev_b32 v26, 4, v0
    v_lshlrev_b32 v27, 1, v26
    v_and_b32 v28, 15, v0
    v_xor_b32 v27, v27, v28
    v_lshlrev_b32 v27, 4, v27
    v_lshlrev_b32 v26, 13, v26
    v_add_u32 v26, v26, v27
    s_lshl_b32 s5, s3, 8
    v_add_u32 v24, s5, v26
    v_xor_b32 v25, 128, v24
    v_bfe_u32 v28, v0, 2, 2
    v_and_b32 v29, 3, v0
    v_lshrrev_b32 v30, 4, v0
    v_lshl_add_u32 v31, v30, 3, v28
    v_lshlrev_b32 v31, 8, v31
    v_and_b32 v32, 1, v30
    v_lshl_add_u32 v32, v32, 2, v28
    v_lshlrev_b32 v32, 1, v32
    v_lshrrev_b32 v33, 1, v29
    s_lshl_b32 s5, s4, 2
    v_add_u32 v33, s5, v33
    v_xor_b32 v33, v33, v32
    v_lshlrev_b32 v33, 4, v33
    v_and_b32 v34, 1, v29
    v_lshl_add_u32 v33, v34, 3, v33
    v_add_u32 v26, v31, v33
    v_xor_b32 v27, 32, v26
    v_add_u32 v28, 0x10000, v26
    v_add_u32 v29, 0x10000, v27
    s_mov_b32 s12, s36
    s_and_b32 s13, s37, 0xffff
    s_mov_b32 s14, 4194304
    s_mov_b32 s15, 0x20000
    s_lshl_b32 s5, s4, 20
    s_lshl_b32 s6, s4, 15
    s_mov_b32 m0, s6
    s_nop 0
    buffer_load_dwordx4 v24, s[12:15], s5 offen lds
    s_add_u32 s5, s5, 32768
    s_add_u32 s6, s6, 1024
    s_mov_b32 m0, s6
    s_nop 0
    buffer_load_dwordx4 v24, s[12:15], s5 offen lds
    s_add_u32 s5, s5, 32768
    s_add_u32 s6, s6, 1024
    s_mov_b32 m0, s6
    s_nop 0
    buffer_load_dwordx4 v25, s[12:15], s5 offen lds
    s_add_u32 s5, s5, 32768
    s_add_u32 s6, s6, 1024
    s_mov_b32 m0, s6
    s_nop 0
    buffer_load_dwordx4 v25, s[12:15], s5 offen lds
    s_add_u32 s5, s5, 32768
    s_add_u32 s6, s6, 1024
    s_mov_b32 m0, s6
    s_nop 0
    buffer_load_dwordx4 v24, s[12:15], s5 offen lds
    s_add_u32 s5, s5, 32768
    s_add_u32 s6, s6, 1024
    s_mov_b32 m0, s6
    s_nop 0
    buffer_load_dwordx4 v24, s[12:15], s5 offen lds
    s_add_u32 s5, s5, 32768
    s_add_u32 s6, s6, 1024
    s_mov_b32 m0, s6
    s_nop 0
    buffer_load_dwordx4 v25, s[12:15], s5 offen lds
    s_add_u32 s5, s5, 32768
    s_add_u32 s6, s6, 1024
    s_mov_b32 m0, s6
    s_nop 0
    buffer_load_dwordx4 v25, s[12:15], s5 offen lds
    s_add_u32 s5, s5, 32768
    s_add_u32 s6, s6, 1024
    s_mov_b32 m0, s6
    s_nop 0
    buffer_load_dwordx4 v24, s[12:15], s5 offen lds
    s_add_u32 s5, s5, 32768
    s_add_u32 s6, s6, 1024
    s_mov_b32 m0, s6
    s_nop 0
    buffer_load_dwordx4 v24, s[12:15], s5 offen lds
    s_add_u32 s5, s5, 32768
    s_add_u32 s6, s6, 1024
    s_mov_b32 m0, s6
    s_nop 0
    buffer_load_dwordx4 v25, s[12:15], s5 offen lds
    s_add_u32 s5, s5, 32768
    s_add_u32 s6, s6, 1024
    s_mov_b32 m0, s6
    s_nop 0
    buffer_load_dwordx4 v25, s[12:15], s5 offen lds
    s_add_u32 s5, s5, 32768
    s_add_u32 s6, s6, 1024
    s_mov_b32 m0, s6
    s_nop 0
    buffer_load_dwordx4 v24, s[12:15], s5 offen lds
    s_add_u32 s5, s5, 32768
    s_add_u32 s6, s6, 1024
    s_mov_b32 m0, s6
    s_nop 0
    buffer_load_dwordx4 v24, s[12:15], s5 offen lds
    s_add_u32 s5, s5, 32768
    s_add_u32 s6, s6, 1024
    s_mov_b32 m0, s6
    s_nop 0
    buffer_load_dwordx4 v25, s[12:15], s5 offen lds
    s_add_u32 s5, s5, 32768
    s_add_u32 s6, s6, 1024
    s_mov_b32 m0, s6
    s_nop 0
    buffer_load_dwordx4 v25, s[12:15], s5 offen lds
    s_add_u32 s5, s5, 32768
    s_add_u32 s6, s6, 1024
    s_mov_b32 m0, s6
    s_nop 0
    buffer_load_dwordx4 v24, s[12:15], s5 offen lds
    s_add_u32 s5, s5, 32768
    s_add_u32 s6, s6, 1024
    s_mov_b32 m0, s6
    s_nop 0
    buffer_load_dwordx4 v24, s[12:15], s5 offen lds
    s_add_u32 s5, s5, 32768
    s_add_u32 s6, s6, 1024
    s_mov_b32 m0, s6
    s_nop 0
    buffer_load_dwordx4 v25, s[12:15], s5 offen lds
    s_add_u32 s5, s5, 32768
    s_add_u32 s6, s6, 1024
    s_mov_b32 m0, s6
    s_nop 0
    buffer_load_dwordx4 v25, s[12:15], s5 offen lds
    s_add_u32 s5, s5, 32768
    s_add_u32 s6, s6, 1024
    s_mov_b32 m0, s6
    s_nop 0
    buffer_load_dwordx4 v24, s[12:15], s5 offen lds
    s_add_u32 s5, s5, 32768
    s_add_u32 s6, s6, 1024
    s_mov_b32 m0, s6
    s_nop 0
    buffer_load_dwordx4 v24, s[12:15], s5 offen lds
    s_add_u32 s5, s5, 32768
    s_add_u32 s6, s6, 1024
    s_mov_b32 m0, s6
    s_nop 0
    buffer_load_dwordx4 v25, s[12:15], s5 offen lds
    s_add_u32 s5, s5, 32768
    s_add_u32 s6, s6, 1024
    s_mov_b32 m0, s6
    s_nop 0
    buffer_load_dwordx4 v25, s[12:15], s5 offen lds
    s_add_u32 s5, s5, 32768
    s_add_u32 s6, s6, 1024
    s_mov_b32 m0, s6
    s_nop 0
    buffer_load_dwordx4 v24, s[12:15], s5 offen lds
    s_add_u32 s5, s5, 32768
    s_add_u32 s6, s6, 1024
    s_mov_b32 m0, s6
    s_nop 0
    buffer_load_dwordx4 v24, s[12:15], s5 offen lds
    s_add_u32 s5, s5, 32768
    s_add_u32 s6, s6, 1024
    s_mov_b32 m0, s6
    s_nop 0
    buffer_load_dwordx4 v25, s[12:15], s5 offen lds
    s_add_u32 s5, s5, 32768
    s_add_u32 s6, s6, 1024
    s_mov_b32 m0, s6
    s_nop 0
    buffer_load_dwordx4 v25, s[12:15], s5 offen lds
    s_add_u32 s5, s5, 32768
    s_add_u32 s6, s6, 1024
    s_mov_b32 m0, s6
    s_nop 0
    buffer_load_dwordx4 v24, s[12:15], s5 offen lds
    s_add_u32 s5, s5, 32768
    s_add_u32 s6, s6, 1024
    s_mov_b32 m0, s6
    s_nop 0
    buffer_load_dwordx4 v24, s[12:15], s5 offen lds
    s_add_u32 s5, s5, 32768
    s_add_u32 s6, s6, 1024
    s_mov_b32 m0, s6
    s_nop 0
    buffer_load_dwordx4 v25, s[12:15], s5 offen lds
    s_add_u32 s5, s5, 32768
    s_add_u32 s6, s6, 1024
    s_mov_b32 m0, s6
    s_nop 0
    buffer_load_dwordx4 v25, s[12:15], s5 offen lds
    s_lshl_b32 s7, s3, 4
    s_lshl_b32 s22, s16, 2
    s_add_u32 s7, s7, s22
    s_add_u32 s7, s7, 0
    v_mov_b32 v40, 0
    buffer_store_dword v40, off, s[8:11], s7 sc1
    s_lshl_b32 s7, s16, 7
    s_lshl_b32 s22, s3, 2
    s_add_u32 s7, s7, s22
    s_add_u32 s7, s7, 2048
    v_mov_b32 v41, 0
    buffer_store_dword v41, off, s[8:11], s7 sc1
    s_waitcnt vmcnt(0)
    s_barrier
    s_cmp_lg_u32 s4, 0
    s_cbranch_scc1 dba_14
    v_mov_b32 v40, 1
    s_mov_b64 exec, 1
    buffer_atomic_add v40, off, s[64:67], 0 offset:128 sc1
    s_mov_b64 exec, -1
dba_14:
    ds_read_b64_tr_b16 a[0:1], v26 offset:0
    ds_read_b64_tr_b16 a[2:3], v26 offset:1024
    ds_read_b64_tr_b16 a[4:5], v26 offset:8192
    ds_read_b64_tr_b16 a[6:7], v26 offset:9216
    ds_read_b64_tr_b16 a[8:9], v26 offset:16384
    ds_read_b64_tr_b16 a[10:11], v26 offset:17408
    ds_read_b64_tr_b16 a[12:13], v26 offset:24576
    ds_read_b64_tr_b16 a[14:15], v26 offset:25600
    s_waitcnt lgkmcnt(4)
    ds_read_b64_tr_b16 a[16:17], v26 offset:32768
    ds_read_b64_tr_b16 a[18:19], v26 offset:33792
    ds_read_b64_tr_b16 a[20:21], v26 offset:40960
    ds_read_b64_tr_b16 a[22:23], v26 offset:41984
    ds_read_b64_tr_b16 a[24:25], v26 offset:49152
    ds_read_b64_tr_b16 a[26:27], v26 offset:50176
    ds_read_b64_tr_b16 a[28:29], v26 offset:57344
    ds_read_b64_tr_b16 a[30:31], v26 offset:58368
    s_waitcnt lgkmcnt(4)
    ds_read_b64_tr_b16 a[32:33], v28 offset:0
    ds_read_b64_tr_b16 a[34:35], v28 offset:1024
    ds_read_b64_tr_b16 a[36:37], v28 offset:8192
    ds_read_b64_tr_b16 a[38:39], v28 offset:9216
    ds_read_b64_tr_b16 a[40:41], v28 offset:16384
    ds_read_b64_tr_b16 a[42:43], v28 offset:17408
    ds_read_b64_tr_b16 a[44:45], v28 offset:24576
    ds_read_b64_tr_b16 a[46:47], v28 offset:25600
    s_waitcnt lgkmcnt(4)
    ds_read_b64_tr_b16 a[48:49], v28 offset:32768
    ds_read_b64_tr_b16 a[50:51], v28 offset:33792
    ds_read_b64_tr_b16 a[52:53], v28 offset:40960
    ds_read_b64_tr_b16 a[54:55], v28 offset:41984
    ds_read_b64_tr_b16 a[56:57], v28 offset:49152
    ds_read_b64_tr_b16 a[58:59], v28 offset:50176
    ds_read_b64_tr_b16 a[60:61], v28 offset:57344
    ds_read_b64_tr_b16 a[62:63], v28 offset:58368
    s_waitcnt lgkmcnt(4)
    ds_read_b64_tr_b16 a[64:65], v27 offset:0
    ds_read_b64_tr_b16 a[66:67], v27 offset:1024
    ds_read_b64_tr_b16 a[68:69], v27 offset:8192
    ds_read_b64_tr_b16 a[70:71], v27 offset:9216
    ds_read_b64_tr_b16 a[72:73], v27 offset:16384
    ds_read_b64_tr_b16 a[74:75], v27 offset:17408
    ds_read_b64_tr_b16 a[76:77], v27 offset:24576
    ds_read_b64_tr_b16 a[78:79], v27 offset:25600
    s_waitcnt lgkmcnt(4)
    ds_read_b64_tr_b16 a[80:81], v27 offset:32768
    ds_read_b64_tr_b16 a[82:83], v27 offset:33792
    ds_read_b64_tr_b16 a[84:85], v27 offset:40960
    ds_read_b64_tr_b16 a[86:87], v27 offset:41984
    ds_read_b64_tr_b16 a[88:89], v27 offset:49152
    ds_read_b64_tr_b16 a[90:91], v27 offset:50176
    ds_read_b64_tr_b16 a[92:93], v27 offset:57344
    ds_read_b64_tr_b16 a[94:95], v27 offset:58368
    s_waitcnt lgkmcnt(4)
    ds_read_b64_tr_b16 a[96:97], v29 offset:0
    ds_read_b64_tr_b16 a[98:99], v29 offset:1024
    ds_read_b64_tr_b16 a[100:101], v29 offset:8192
    ds_read_b64_tr_b16 a[102:103], v29 offset:9216
    ds_read_b64_tr_b16 a[104:105], v29 offset:16384
    ds_read_b64_tr_b16 a[106:107], v29 offset:17408
    ds_read_b64_tr_b16 a[108:109], v29 offset:24576
    ds_read_b64_tr_b16 a[110:111], v29 offset:25600
    s_waitcnt lgkmcnt(4)
    ds_read_b64_tr_b16 a[112:113], v29 offset:32768
    ds_read_b64_tr_b16 a[114:115], v29 offset:33792
    ds_read_b64_tr_b16 a[116:117], v29 offset:40960
    ds_read_b64_tr_b16 a[118:119], v29 offset:41984
    ds_read_b64_tr_b16 a[120:121], v29 offset:49152
    ds_read_b64_tr_b16 a[122:123], v29 offset:50176
    ds_read_b64_tr_b16 a[124:125], v29 offset:57344
    ds_read_b64_tr_b16 a[126:127], v29 offset:58368
    s_waitcnt lgkmcnt(4)
    s_waitcnt lgkmcnt(0)
    s_barrier
    s_mov_b32 s12, s38
    s_and_b32 s13, s39, 0xffff
    s_mov_b32 s14, 4194304
    s_mov_b32 s15, 0x20000
    s_lshl_b32 s5, s4, 20
    s_lshl_b32 s6, s4, 15
    s_mov_b32 m0, s6
    s_nop 0
    buffer_load_dwordx4 v24, s[12:15], s5 offen lds
    s_add_u32 s5, s5, 32768
    s_add_u32 s6, s6, 1024
    s_mov_b32 m0, s6
    s_nop 0
    buffer_load_dwordx4 v24, s[12:15], s5 offen lds
    s_add_u32 s5, s5, 32768
    s_add_u32 s6, s6, 1024
    s_mov_b32 m0, s6
    s_nop 0
    buffer_load_dwordx4 v25, s[12:15], s5 offen lds
    s_add_u32 s5, s5, 32768
    s_add_u32 s6, s6, 1024
    s_mov_b32 m0, s6
    s_nop 0
    buffer_load_dwordx4 v25, s[12:15], s5 offen lds
    s_add_u32 s5, s5, 32768
    s_add_u32 s6, s6, 1024
    s_mov_b32 m0, s6
    s_nop 0
    buffer_load_dwordx4 v24, s[12:15], s5 offen lds
    s_add_u32 s5, s5, 32768
    s_add_u32 s6, s6, 1024
    s_mov_b32 m0, s6
    s_nop 0
    buffer_load_dwordx4 v24, s[12:15], s5 offen lds
    s_add_u32 s5, s5, 32768
    s_add_u32 s6, s6, 1024
    s_mov_b32 m0, s6
    s_nop 0
    buffer_load_dwordx4 v25, s[12:15], s5 offen lds
    s_add_u32 s5, s5, 32768
    s_add_u32 s6, s6, 1024
    s_mov_b32 m0, s6
    s_nop 0
    buffer_load_dwordx4 v25, s[12:15], s5 offen lds
    s_add_u32 s5, s5, 32768
    s_add_u32 s6, s6, 1024
    s_mov_b32 m0, s6
    s_nop 0
    buffer_load_dwordx4 v24, s[12:15], s5 offen lds
    s_add_u32 s5, s5, 32768
    s_add_u32 s6, s6, 1024
    s_mov_b32 m0, s6
    s_nop 0
    buffer_load_dwordx4 v24, s[12:15], s5 offen lds
    s_add_u32 s5, s5, 32768
    s_add_u32 s6, s6, 1024
    s_mov_b32 m0, s6
    s_nop 0
    buffer_load_dwordx4 v25, s[12:15], s5 offen lds
    s_add_u32 s5, s5, 32768
    s_add_u32 s6, s6, 1024
    s_mov_b32 m0, s6
    s_nop 0
    buffer_load_dwordx4 v25, s[12:15], s5 offen lds
    s_add_u32 s5, s5, 32768
    s_add_u32 s6, s6, 1024
    s_mov_b32 m0, s6
    s_nop 0
    buffer_load_dwordx4 v24, s[12:15], s5 offen lds
    s_add_u32 s5, s5, 32768
    s_add_u32 s6, s6, 1024
    s_mov_b32 m0, s6
    s_nop 0
    buffer_load_dwordx4 v24, s[12:15], s5 offen lds
    s_add_u32 s5, s5, 32768
    s_add_u32 s6, s6, 1024
    s_mov_b32 m0, s6
    s_nop 0
    buffer_load_dwordx4 v25, s[12:15], s5 offen lds
    s_add_u32 s5, s5, 32768
    s_add_u32 s6, s6, 1024
    s_mov_b32 m0, s6
    s_nop 0
    buffer_load_dwordx4 v25, s[12:15], s5 offen lds
    s_add_u32 s5, s5, 32768
    s_add_u32 s6, s6, 1024
    s_mov_b32 m0, s6
    s_nop 0
    buffer_load_dwordx4 v24, s[12:15], s5 offen lds
    s_add_u32 s5, s5, 32768
    s_add_u32 s6, s6, 1024
    s_mov_b32 m0, s6
    s_nop 0
    buffer_load_dwordx4 v24, s[12:15], s5 offen lds
    s_add_u32 s5, s5, 32768
    s_add_u32 s6, s6, 1024
    s_mov_b32 m0, s6
    s_nop 0
    buffer_load_dwordx4 v25, s[12:15], s5 offen lds
    s_add_u32 s5, s5, 32768
    s_add_u32 s6, s6, 1024
    s_mov_b32 m0, s6
    s_nop 0
    buffer_load_dwordx4 v25, s[12:15], s5 offen lds
    s_add_u32 s5, s5, 32768
    s_add_u32 s6, s6, 1024
    s_mov_b32 m0, s6
    s_nop 0
    buffer_load_dwordx4 v24, s[12:15], s5 offen lds
    s_add_u32 s5, s5, 32768
    s_add_u32 s6, s6, 1024
    s_mov_b32 m0, s6
    s_nop 0
    buffer_load_dwordx4 v24, s[12:15], s5 offen lds
    s_add_u32 s5, s5, 32768
    s_add_u32 s6, s6, 1024
    s_mov_b32 m0, s6
    s_nop 0
    buffer_load_dwordx4 v25, s[12:15], s5 offen lds
    s_add_u32 s5, s5, 32768
    s_add_u32 s6, s6, 1024
    s_mov_b32 m0, s6
    s_nop 0
    buffer_load_dwordx4 v25, s[12:15], s5 offen lds
    s_add_u32 s5, s5, 32768
    s_add_u32 s6, s6, 1024
    s_mov_b32 m0, s6
    s_nop 0
    buffer_load_dwordx4 v24, s[12:15], s5 offen lds
    s_add_u32 s5, s5, 32768
    s_add_u32 s6, s6, 1024
    s_mov_b32 m0, s6
    s_nop 0
    buffer_load_dwordx4 v24, s[12:15], s5 offen lds
    s_add_u32 s5, s5, 32768
    s_add_u32 s6, s6, 1024
    s_mov_b32 m0, s6
    s_nop 0
    buffer_load_dwordx4 v25, s[12:15], s5 offen lds
    s_add_u32 s5, s5, 32768
    s_add_u32 s6, s6, 1024
    s_mov_b32 m0, s6
    s_nop 0
    buffer_load_dwordx4 v25, s[12:15], s5 offen lds
    s_add_u32 s5, s5, 32768
    s_add_u32 s6, s6, 1024
    s_mov_b32 m0, s6
    s_nop 0
    buffer_load_dwordx4 v24, s[12:15], s5 offen lds
    s_add_u32 s5, s5, 32768
    s_add_u32 s6, s6, 1024
    s_mov_b32 m0, s6
    s_nop 0
    buffer_load_dwordx4 v24, s[12:15], s5 offen lds
    s_add_u32 s5, s5, 32768
    s_add_u32 s6, s6, 1024
    s_mov_b32 m0, s6
    s_nop 0
    buffer_load_dwordx4 v25, s[12:15], s5 offen lds
    s_add_u32 s5, s5, 32768
    s_add_u32 s6, s6, 1024
    s_mov_b32 m0, s6
    s_nop 0
    buffer_load_dwordx4 v25, s[12:15], s5 offen lds
    s_waitcnt vmcnt(0)
    s_barrier
    ds_read_b64_tr_b16 a[128:129], v26 offset:0
    ds_read_b64_tr_b16 a[130:131], v26 offset:1024
    ds_read_b64_tr_b16 a[132:133], v26 offset:8192
    ds_read_b64_tr_b16 a[134:135], v26 offset:9216
    ds_read_b64_tr_b16 a[136:137], v26 offset:16384
    ds_read_b64_tr_b16 a[138:139], v26 offset:17408
    ds_read_b64_tr_b16 a[140:141], v26 offset:24576
    ds_read_b64_tr_b16 a[142:143], v26 offset:25600
    s_waitcnt lgkmcnt(4)
    ds_read_b64_tr_b16 a[144:145], v26 offset:32768
    ds_read_b64_tr_b16 a[146:147], v26 offset:33792
    ds_read_b64_tr_b16 a[148:149], v26 offset:40960
    ds_read_b64_tr_b16 a[150:151], v26 offset:41984
    ds_read_b64_tr_b16 a[152:153], v26 offset:49152
    ds_read_b64_tr_b16 a[154:155], v26 offset:50176
    ds_read_b64_tr_b16 a[156:157], v26 offset:57344
    ds_read_b64_tr_b16 a[158:159], v26 offset:58368
    s_waitcnt lgkmcnt(4)
    ds_read_b64_tr_b16 a[160:161], v28 offset:0
    ds_read_b64_tr_b16 a[162:163], v28 offset:1024
    ds_read_b64_tr_b16 a[164:165], v28 offset:8192
    ds_read_b64_tr_b16 a[166:167], v28 offset:9216
    ds_read_b64_tr_b16 a[168:169], v28 offset:16384
    ds_read_b64_tr_b16 a[170:171], v28 offset:17408
    ds_read_b64_tr_b16 a[172:173], v28 offset:24576
    ds_read_b64_tr_b16 a[174:175], v28 offset:25600
    s_waitcnt lgkmcnt(4)
    ds_read_b64_tr_b16 a[176:177], v28 offset:32768
    ds_read_b64_tr_b16 a[178:179], v28 offset:33792
    ds_read_b64_tr_b16 a[180:181], v28 offset:40960
    ds_read_b64_tr_b16 a[182:183], v28 offset:41984
    ds_read_b64_tr_b16 a[184:185], v28 offset:49152
    ds_read_b64_tr_b16 a[186:187], v28 offset:50176
    ds_read_b64_tr_b16 a[188:189], v28 offset:57344
    ds_read_b64_tr_b16 a[190:191], v28 offset:58368
    s_waitcnt lgkmcnt(4)
    ds_read_b64_tr_b16 a[192:193], v27 offset:0
    ds_read_b64_tr_b16 a[194:195], v27 offset:1024
    ds_read_b64_tr_b16 a[196:197], v27 offset:8192
    ds_read_b64_tr_b16 a[198:199], v27 offset:9216
    ds_read_b64_tr_b16 a[200:201], v27 offset:16384
    ds_read_b64_tr_b16 a[202:203], v27 offset:17408
    ds_read_b64_tr_b16 a[204:205], v27 offset:24576
    ds_read_b64_tr_b16 a[206:207], v27 offset:25600
    s_waitcnt lgkmcnt(4)
    ds_read_b64_tr_b16 a[208:209], v27 offset:32768
    ds_read_b64_tr_b16 a[210:211], v27 offset:33792
    ds_read_b64_tr_b16 a[212:213], v27 offset:40960
    ds_read_b64_tr_b16 a[214:215], v27 offset:41984
    ds_read_b64_tr_b16 a[216:217], v27 offset:49152
    ds_read_b64_tr_b16 a[218:219], v27 offset:50176
    ds_read_b64_tr_b16 a[220:221], v27 offset:57344
    ds_read_b64_tr_b16 a[222:223], v27 offset:58368
    s_waitcnt lgkmcnt(4)
    ds_read_b64_tr_b16 a[224:225], v29 offset:0
    ds_read_b64_tr_b16 a[226:227], v29 offset:1024
    ds_read_b64_tr_b16 a[228:229], v29 offset:8192
    ds_read_b64_tr_b16 a[230:231], v29 offset:9216
    ds_read_b64_tr_b16 a[232:233], v29 offset:16384
    ds_read_b64_tr_b16 a[234:235], v29 offset:17408
    ds_read_b64_tr_b16 a[236:237], v29 offset:24576
    ds_read_b64_tr_b16 a[238:239], v29 offset:25600
    s_waitcnt lgkmcnt(4)
    ds_read_b64_tr_b16 a[240:241], v29 offset:32768
    ds_read_b64_tr_b16 a[242:243], v29 offset:33792
    ds_read_b64_tr_b16 a[244:245], v29 offset:40960
    ds_read_b64_tr_b16 a[246:247], v29 offset:41984
    ds_read_b64_tr_b16 a[248:249], v29 offset:49152
    ds_read_b64_tr_b16 a[250:251], v29 offset:50176
    ds_read_b64_tr_b16 a[252:253], v29 offset:57344
    ds_read_b64_tr_b16 a[254:255], v29 offset:58368
    s_waitcnt lgkmcnt(4)
    s_waitcnt lgkmcnt(0)
    s_barrier
    s_cmp_lg_u32 s4, 0
    s_cbranch_scc1 dbw_15_x
    s_mov_b32 s70, 0
dbw_15:
    buffer_load_dword v40, off, s[64:67], 0 offset:64 sc1
    s_add_u32 s70, s70, 1
    s_cmp_gt_u32 s70, 0x10000
    s_cbranch_scc1 dbw_15_y
    s_waitcnt vmcnt(0)
    v_readfirstlane_b32 s71, v40
    s_nop 0
    s_cmp_ge_u32 s71, 128
    s_cbranch_scc1 dbw_15_x
    s_sleep 8
    s_branch dbw_15
dbw_15_y:
    s_waitcnt vmcnt(0)
dbw_15_x:
    s_barrier
    s_mov_b32 s20, 131072
    s_lshl_b32 s5, s16, 15
    s_lshl_b32 s6, s4, 13
    s_add_u32 s5, s5, s6
    s_add_u32 s5, s5, 1048576
    s_add_u32 s6, s6, s20
    s_mov_b32 m0, s6
    s_nop 0
    buffer_load_dwordx4 v1, s[8:11], s5 offen offset:0 sc1 lds
    buffer_load_dwordx4 v1, s[8:11], s5 offen offset:1024 sc1 lds
    buffer_load_dwordx4 v1, s[8:11], s5 offen offset:2048 sc1 lds
    buffer_load_dwordx4 v1, s[8:11], s5 offen offset:3072 sc1 lds
    s_add_u32 s5, s5, 4096
    s_add_u32 s6, s6, 4096
    s_mov_b32 m0, s6
    s_nop 0
    buffer_load_dwordx4 v1, s[8:11], s5 offen offset:0 sc1 lds
    buffer_load_dwordx4 v1, s[8:11], s5 offen offset:1024 sc1 lds
    buffer_load_dwordx4 v1, s[8:11], s5 offen offset:2048 sc1 lds
    buffer_load_dwordx4 v1, s[8:11], s5 offen offset:3072 sc1 lds
    s_mov_b32 s12, s40
    s_and_b32 s13, s41, 0xffff
    s_mov_b32 s14, 4194304
    s_mov_b32 s15, 0x20000
    s_lshl_b32 s5, s4, 20
    s_lshl_b32 s6, s4, 15
    s_mov_b32 m0, s6
    s_nop 0
    buffer_load_dwordx4 v24, s[12:15], s5 offen lds
    s_add_u32 s5, s5, 32768
    s_add_u32 s6, s6, 1024
    s_mov_b32 m0, s6
    s_nop 0
    buffer_load_dwordx4 v24, s[12:15], s5 offen lds
    s_add_u32 s5, s5, 32768
    s_add_u32 s6, s6, 1024
    s_mov_b32 m0, s6
    s_nop 0
    buffer_load_dwordx4 v25, s[12:15], s5 offen lds
    s_add_u32 s5, s5, 32768
    s_add_u32 s6, s6, 1024
    s_mov_b32 m0, s6
    s_nop 0
    buffer_load_dwordx4 v25, s[12:15], s5 offen lds
    s_add_u32 s5, s5, 32768
    s_add_u32 s6, s6, 1024
    s_mov_b32 m0, s6
    s_nop 0
    buffer_load_dwordx4 v24, s[12:15], s5 offen lds
    s_add_u32 s5, s5, 32768
    s_add_u32 s6, s6, 1024
    s_mov_b32 m0, s6
    s_nop 0
    buffer_load_dwordx4 v24, s[12:15], s5 offen lds
    s_add_u32 s5, s5, 32768
    s_add_u32 s6, s6, 1024
    s_mov_b32 m0, s6
    s_nop 0
    buffer_load_dwordx4 v25, s[12:15], s5 offen lds
    s_add_u32 s5, s5, 32768
    s_add_u32 s6, s6, 1024
    s_mov_b32 m0, s6
    s_nop 0
    buffer_load_dwordx4 v25, s[12:15], s5 offen lds
    s_add_u32 s5, s5, 32768
    s_add_u32 s6, s6, 1024
    s_mov_b32 m0, s6
    s_nop 0
    buffer_load_dwordx4 v24, s[12:15], s5 offen lds
    s_add_u32 s5, s5, 32768
    s_add_u32 s6, s6, 1024
    s_mov_b32 m0, s6
    s_nop 0
    buffer_load_dwordx4 v24, s[12:15], s5 offen lds
    s_add_u32 s5, s5, 32768
    s_add_u32 s6, s6, 1024
    s_mov_b32 m0, s6
    s_nop 0
    buffer_load_dwordx4 v25, s[12:15], s5 offen lds
    s_add_u32 s5, s5, 32768
    s_add_u32 s6, s6, 1024
    s_mov_b32 m0, s6
    s_nop 0
    buffer_load_dwordx4 v25, s[12:15], s5 offen lds
    s_add_u32 s5, s5, 32768
    s_add_u32 s6, s6, 1024
    s_mov_b32 m0, s6
    s_nop 0
    buffer_load_dwordx4 v24, s[12:15], s5 offen lds
    s_add_u32 s5, s5, 32768
    s_add_u32 s6, s6, 1024
    s_mov_b32 m0, s6
    s_nop 0
    buffer_load_dwordx4 v24, s[12:15], s5 offen lds
    s_add_u32 s5, s5, 32768
    s_add_u32 s6, s6, 1024
    s_mov_b32 m0, s6
    s_nop 0
    buffer_load_dwordx4 v25, s[12:15], s5 offen lds
    s_add_u32 s5, s5, 32768
    s_add_u32 s6, s6, 1024
    s_mov_b32 m0, s6
    s_nop 0
    buffer_load_dwordx4 v25, s[12:15], s5 offen lds
    s_add_u32 s5, s5, 32768
    s_add_u32 s6, s6, 1024
    s_mov_b32 m0, s6
    s_nop 0
    buffer_load_dwordx4 v24, s[12:15], s5 offen lds
    s_add_u32 s5, s5, 32768
    s_add_u32 s6, s6, 1024
    s_mov_b32 m0, s6
    s_nop 0
    buffer_load_dwordx4 v24, s[12:15], s5 offen lds
    s_add_u32 s5, s5, 32768
    s_add_u32 s6, s6, 1024
    s_mov_b32 m0, s6
    s_nop 0
    buffer_load_dwordx4 v25, s[12:15], s5 offen lds
    s_add_u32 s5, s5, 32768
    s_add_u32 s6, s6, 1024
    s_mov_b32 m0, s6
    s_nop 0
    buffer_load_dwordx4 v25, s[12:15], s5 offen lds
    s_add_u32 s5, s5, 32768
    s_add_u32 s6, s6, 1024
    s_mov_b32 m0, s6
    s_nop 0
    buffer_load_dwordx4 v24, s[12:15], s5 offen lds
    s_add_u32 s5, s5, 32768
    s_add_u32 s6, s6, 1024
    s_mov_b32 m0, s6
    s_nop 0
    buffer_load_dwordx4 v24, s[12:15], s5 offen lds
    s_add_u32 s5, s5, 32768
    s_add_u32 s6, s6, 1024
    s_mov_b32 m0, s6
    s_nop 0
    buffer_load_dwordx4 v25, s[12:15], s5 offen lds
    s_add_u32 s5, s5, 32768
    s_add_u32 s6, s6, 1024
    s_mov_b32 m0, s6
    s_nop 0
    buffer_load_dwordx4 v25, s[12:15], s5 offen lds
    s_add_u32 s5, s5, 32768
    s_add_u32 s6, s6, 1024
    s_mov_b32 m0, s6
    s_nop 0
    buffer_load_dwordx4 v24, s[12:15], s5 offen lds
    s_add_u32 s5, s5, 32768
    s_add_u32 s6, s6, 1024
    s_mov_b32 m0, s6
    s_nop 0
    buffer_load_dwordx4 v24, s[12:15], s5 offen lds
    s_add_u32 s5, s5, 32768
    s_add_u32 s6, s6, 1024
    s_mov_b32 m0, s6
    s_nop 0
    buffer_load_dwordx4 v25, s[12:15], s5 offen lds
    s_add_u32 s5, s5, 32768
    s_add_u32 s6, s6, 1024
    s_mov_b32 m0, s6
    s_nop 0
    buffer_load_dwordx4 v25, s[12:15], s5 offen lds
    s_add_u32 s5, s5, 32768
    s_add_u32 s6, s6, 1024
    s_mov_b32 m0, s6
    s_nop 0
    buffer_load_dwordx4 v24, s[12:15], s5 offen lds
    s_add_u32 s5, s5, 32768
    s_add_u32 s6, s6, 1024
    s_mov_b32 m0, s6
    s_nop 0
    buffer_load_dwordx4 v24, s[12:15], s5 offen lds
    s_add_u32 s5, s5, 32768
    s_add_u32 s6, s6, 1024
    s_mov_b32 m0, s6
    s_nop 0
    buffer_load_dwordx4 v25, s[12:15], s5 offen lds
    s_add_u32 s5, s5, 32768
    s_add_u32 s6, s6, 1024
    s_mov_b32 m0, s6
    s_nop 0
    buffer_load_dwordx4 v25, s[12:15], s5 offen lds
    s_waitcnt vmcnt(0)
    s_barrier
    ds_read_b64_tr_b16 v[128:129], v26 offset:0
    ds_read_b64_tr_b16 v[130:131], v26 offset:1024
    ds_read_b64_tr_b16 v[132:133], v26 offset:8192
    ds_read_b64_tr_b16 v[134:135], v26 offset:9216
    ds_read_b64_tr_b16 v[136:137], v26 offset:16384
    ds_read_b64_tr_b16 v[138:139], v26 offset:17408
    ds_read_b64_tr_b16 v[140:141], v26 offset:24576
    ds_read_b64_tr_b16 v[142:143], v26 offset:25600
    s_waitcnt lgkmcnt(4)
    ds_read_b64_tr_b16 v[144:145], v26 offset:32768
    ds_read_b64_tr_b16 v[146:147], v26 offset:33792
    ds_read_b64_tr_b16 v[148:149], v26 offset:40960
    ds_read_b64_tr_b16 v[150:151], v26 offset:41984
    ds_read_b64_tr_b16 v[152:153], v26 offset:49152
    ds_read_b64_tr_b16 v[154:155], v26 offset:50176
    ds_read_b64_tr_b16 v[156:157], v26 offset:57344
    ds_read_b64_tr_b16 v[158:159], v26 offset:58368
    s_waitcnt lgkmcnt(4)
    ds_read_b64_tr_b16 v[160:161], v28 offset:0
    ds_read_b64_tr_b16 v[162:163], v28 offset:1024
    ds_read_b64_tr_b16 v[164:165], v28 offset:8192
    ds_read_b64_tr_b16 v[166:167], v28 offset:9216
    ds_read_b64_tr_b16 v[168:169], v28 offset:16384
    ds_read_b64_tr_b16 v[170:171], v28 offset:17408
    ds_read_b64_tr_b16 v[172:173], v28 offset:24576
    ds_read_b64_tr_b16 v[174:175], v28 offset:25600
    s_waitcnt lgkmcnt(4)
    ds_read_b64_tr_b16 v[176:177], v28 offset:32768
    ds_read_b64_tr_b16 v[178:179], v28 offset:33792
    ds_read_b64_tr_b16 v[180:181], v28 offset:40960
    ds_read_b64_tr_b16 v[182:183], v28 offset:41984
    ds_read_b64_tr_b16 v[184:185], v28 offset:49152
    ds_read_b64_tr_b16 v[186:187], v28 offset:50176
    ds_read_b64_tr_b16 v[188:189], v28 offset:57344
    ds_read_b64_tr_b16 v[190:191], v28 offset:58368
    s_waitcnt lgkmcnt(4)
    ds_read_b64_tr_b16 v[192:193], v27 offset:0
    ds_read_b64_tr_b16 v[194:195], v27 offset:1024
    ds_read_b64_tr_b16 v[196:197], v27 offset:8192
    ds_read_b64_tr_b16 v[198:199], v27 offset:9216
    ds_read_b64_tr_b16 v[200:201], v27 offset:16384
    ds_read_b64_tr_b16 v[202:203], v27 offset:17408
    ds_read_b64_tr_b16 v[204:205], v27 offset:24576
    ds_read_b64_tr_b16 v[206:207], v27 offset:25600
    s_waitcnt lgkmcnt(4)
    ds_read_b64_tr_b16 v[208:209], v27 offset:32768
    ds_read_b64_tr_b16 v[210:211], v27 offset:33792
    ds_read_b64_tr_b16 v[212:213], v27 offset:40960
    ds_read_b64_tr_b16 v[214:215], v27 offset:41984
    ds_read_b64_tr_b16 v[216:217], v27 offset:49152
    ds_read_b64_tr_b16 v[218:219], v27 offset:50176
    ds_read_b64_tr_b16 v[220:221], v27 offset:57344
    ds_read_b64_tr_b16 v[222:223], v27 offset:58368
    s_waitcnt lgkmcnt(4)
    ds_read_b64_tr_b16 v[224:225], v29 offset:0
    ds_read_b64_tr_b16 v[226:227], v29 offset:1024
    ds_read_b64_tr_b16 v[228:229], v29 offset:8192
    ds_read_b64_tr_b16 v[230:231], v29 offset:9216
    ds_read_b64_tr_b16 v[232:233], v29 offset:16384
    ds_read_b64_tr_b16 v[234:235], v29 offset:17408
    ds_read_b64_tr_b16 v[236:237], v29 offset:24576
    ds_read_b64_tr_b16 v[238:239], v29 offset:25600
    s_waitcnt lgkmcnt(4)
    ds_read_b64_tr_b16 v[240:241], v29 offset:32768
    ds_read_b64_tr_b16 v[242:243], v29 offset:33792
    ds_read_b64_tr_b16 v[244:245], v29 offset:40960
    ds_read_b64_tr_b16 v[246:247], v29 offset:41984
    ds_read_b64_tr_b16 v[248:249], v29 offset:49152
    ds_read_b64_tr_b16 v[250:251], v29 offset:50176
    ds_read_b64_tr_b16 v[252:253], v29 offset:57344
    ds_read_b64_tr_b16 v[254:255], v29 offset:58368
    s_waitcnt lgkmcnt(4)
    s_waitcnt lgkmcnt(0)
    s_barrier
    s_mov_b32 s28, 0x3e0293ee
    s_mov_b32 s29, 0x3f803f80
    s_mov_b32 s30, 0
    s_sub_u32 s5, 66, s16
    s_mul_hi_u32 s19, s5, 1431655766
    s_mov_b32 s17, 0
    s_mov_b32 s18, s16
    s_mov_b32 s20, 131072
    s_mov_b32 s21, 32768
    s_mov_b32 s25, 0
    s_mov_b32 s26, s16
    s_mov_b32 s27, 32768
qk_loop:
    s_add_u32 s22, s18, 3
    s_xor_b32 s23, s20, 131072
    s_cmp_lt_u32 s22, 64
    s_cbranch_scc0 qk_nopf
    s_lshl_b32 s5, s22, 15
    s_lshl_b32 s6, s4, 13
    s_add_u32 s5, s5, s6
    s_add_u32 s5, s5, 1048576
    s_add_u32 s6, s6, s23
    s_mov_b32 m0, s6
    s_nop 0
    buffer_load_dwordx4 v1, s[8:11], s5 offen offset:0 sc1 lds
    buffer_load_dwordx4 v1, s[8:11], s5 offen offset:1024 sc1 lds
    buffer_load_dwordx4 v1, s[8:11], s5 offen offset:2048 sc1 lds
    buffer_load_dwordx4 v1, s[8:11], s5 offen offset:3072 sc1 lds
    s_add_u32 s5, s5, 4096
    s_add_u32 s6, s6, 4096
    s_mov_b32 m0, s6
    s_nop 0
    buffer_load_dwordx4 v1, s[8:11], s5 offen offset:0 sc1 lds
    buffer_load_dwordx4 v1, s[8:11], s5 offen offset:1024 sc1 lds
    buffer_load_dwordx4 v1, s[8:11], s5 offen offset:2048 sc1 lds
    buffer_load_dwordx4 v1, s[8:11], s5 offen offset:3072 sc1 lds
    s_waitcnt vmcnt(8)
    s_branch qk_pf_done
qk_nopf:
    s_waitcnt vmcnt(0)
qk_pf_done:
    s_barrier
    v_add_u32 v4, s20, v1
    ds_read_b128 v[72:75], v4 offset:0
    ds_read_b128 v[76:79], v4 offset:16384
    ds_read_b128 v[80:83], v4 offset:1024
    ds_read_b128 v[84:87], v4 offset:17408
    s_waitcnt lgkmcnt(2)
    v_mfma_f32_16x16x32_bf16 v[24:27], a[0:3], v[72:75], 0
    v_mfma_f32_16x16x32_bf16 v[28:31], a[0:3], v[76:79], 0
    v_mfma_f32_16x16x32_bf16 v[32:35], a[64:67], v[72:75], 0
    v_mfma_f32_16x16x32_bf16 v[36:39], a[64:67], v[76:79], 0
    v_mfma_f32_16x16x32_bf16 v[40:43], a[128:131], v[72:75], 0
    v_mfma_f32_16x16x32_bf16 v[44:47], a[128:131], v[76:79], 0
    v_mfma_f32_16x16x32_bf16 v[48:51], a[192:195], v[72:75], 0
    v_mfma_f32_16x16x32_bf16 v[52:55], a[192:195], v[76:79], 0
    v_mfma_f32_16x16x32_bf16 v[56:59], v[72:75], v[128:131], 0
    v_mfma_f32_16x16x32_bf16 v[60:63], v[76:79], v[128:131], 0
    v_mfma_f32_16x16x32_bf16 v[64:67], v[72:75], v[192:195], 0
    v_mfma_f32_16x16x32_bf16 v[68:71], v[76:79], v[192:195], 0
    ds_read_b128 v[72:75], v4 offset:2048
    ds_read_b128 v[76:79], v4 offset:18432
    s_waitcnt lgkmcnt(2)
    v_mfma_f32_16x16x32_bf16 v[24:27], a[4:7], v[80:83], v[24:27]
    v_mfma_f32_16x16x32_bf16 v[28:31], a[4:7], v[84:87], v[28:31]
    v_mfma_f32_16x16x32_bf16 v[32:35], a[68:71], v[80:83], v[32:35]
    v_mfma_f32_16x16x32_bf16 v[36:39], a[68:71], v[84:87], v[36:39]
    v_mfma_f32_16x16x32_bf16 v[40:43], a[132:135], v[80:83], v[40:43]
    v_mfma_f32_16x16x32_bf16 v[44:47], a[132:135], v[84:87], v[44:47]
    v_mfma_f32_16x16x32_bf16 v[48:51], a[196:199], v[80:83], v[48:51]
    v_mfma_f32_16x16x32_bf16 v[52:55], a[196:199], v[84:87], v[52:55]
    v_mfma_f32_16x16x32_bf16 v[56:59], v[80:83], v[132:135], v[56:59]
    v_mfma_f32_16x16x32_bf16 v[60:63], v[84:87], v[132:135], v[60:63]
    v_mfma_f32_16x16x32_bf16 v[64:67], v[80:83], v[196:199], v[64:67]
    v_mfma_f32_16x16x32_bf16 v[68:71], v[84:87], v[196:199], v[68:71]
    ds_read_b128 v[80:83], v4 offset:3072
    ds_read_b128 v[84:87], v4 offset:19456
    s_waitcnt lgkmcnt(2)
    v_mfma_f32_16x16x32_bf16 v[24:27], a[8:11], v[72:75], v[24:27]
    v_mfma_f32_16x16x32_bf16 v[28:31], a[8:11], v[76:79], v[28:31]
    v_mfma_f32_16x16x32_bf16 v[32:35], a[72:75], v[72:75], v[32:35]
    v_mfma_f32_16x16x32_bf16 v[36:39], a[72:75], v[76:79], v[36:39]
    v_mfma_f32_16x16x32_bf16 v[40:43], a[136:139], v[72:75], v[40:43]
    v_mfma_f32_16x16x32_bf16 v[44:47], a[136:139], v[76:79], v[44:47]
    v_mfma_f32_16x16x32_bf16 v[48:51], a[200:203], v[72:75], v[48:51]
    v_mfma_f32_16x16x32_bf16 v[52:55], a[200:203], v[76:79], v[52:55]
    v_mfma_f32_16x16x32_bf16 v[56:59], v[72:75], v[136:139], v[56:59]
    v_mfma_f32_16x16x32_bf16 v[60:63], v[76:79], v[136:139], v[60:63]
    v_mfma_f32_16x16x32_bf16 v[64:67], v[72:75], v[200:203], v[64:67]
    v_mfma_f32_16x16x32_bf16 v[68:71], v[76:79], v[200:203], v[68:71]
    ds_read_b128 v[72:75], v4 offset:4096
    ds_read_b128 v[76:79], v4 offset:20480
    s_waitcnt lgkmcnt(2)
    v_mfma_f32_16x16x32_bf16 v[24:27], a[12:15], v[80:83], v[24:27]
    v_mfma_f32_16x16x32_bf16 v[28:31], a[12:15], v[84:87], v[28:31]
    v_mfma_f32_16x16x32_bf16 v[32:35], a[76:79], v[80:83], v[32:35]
    v_mfma_f32_16x16x32_bf16 v[36:39], a[76:79], v[84:87], v[36:39]
    v_mfma_f32_16x16x32_bf16 v[40:43], a[140:143], v[80:83], v[40:43]
    v_mfma_f32_16x16x32_bf16 v[44:47], a[140:143], v[84:87], v[44:47]
    v_mfma_f32_16x16x32_bf16 v[48:51], a[204:207], v[80:83], v[48:51]
    v_mfma_f32_16x16x32_bf16 v[52:55], a[204:207], v[84:87], v[52:55]
    v_mfma_f32_16x16x32_bf16 v[56:59], v[80:83], v[140:143], v[56:59]
    v_mfma_f32_16x16x32_bf16 v[60:63], v[84:87], v[140:143], v[60:63]
    v_mfma_f32_16x16x32_bf16 v[64:67], v[80:83], v[204:207], v[64:67]
    v_mfma_f32_16x16x32_bf16 v[68:71], v[84:87], v[204:207], v[68:71]
    ds_read_b128 v[80:83], v4 offset:5120
    ds_read_b128 v[84:87], v4 offset:21504
    s_waitcnt lgkmcnt(2)
    v_mfma_f32_16x16x32_bf16 v[24:27], a[16:19], v[72:75], v[24:27]
    v_mfma_f32_16x16x32_bf16 v[28:31], a[16:19], v[76:79], v[28:31]
    v_mfma_f32_16x16x32_bf16 v[32:35], a[80:83], v[72:75], v[32:35]
    v_mfma_f32_16x16x32_bf16 v[36:39], a[80:83], v[76:79], v[36:39]
    v_mfma_f32_16x16x32_bf16 v[40:43], a[144:147], v[72:75], v[40:43]
    v_mfma_f32_16x16x32_bf16 v[44:47], a[144:147], v[76:79], v[44:47]
    v_mfma_f32_16x16x32_bf16 v[48:51], a[208:211], v[72:75], v[48:51]
    v_mfma_f32_16x16x32_bf16 v[52:55], a[208:211], v[76:79], v[52:55]
    v_mfma_f32_16x16x32_bf16 v[56:59], v[72:75], v[144:147], v[56:59]
    v_mfma_f32_16x16x32_bf16 v[60:63], v[76:79], v[144:147], v[60:63]
    v_mfma_f32_16x16x32_bf16 v[64:67], v[72:75], v[208:211], v[64:67]
    v_mfma_f32_16x16x32_bf16 v[68:71], v[76:79], v[208:211], v[68:71]
    ds_read_b128 v[72:75], v4 offset:6144
    ds_read_b128 v[76:79], v4 offset:22528
    s_waitcnt lgkmcnt(2)
    v_mfma_f32_16x16x32_bf16 v[24:27], a[20:23], v[80:83], v[24:27]
    v_mfma_f32_16x16x32_bf16 v[28:31], a[20:23], v[84:87], v[28:31]
    v_mfma_f32_16x16x32_bf16 v[32:35], a[84:87], v[80:83], v[32:35]
    v_mfma_f32_16x16x32_bf16 v[36:39], a[84:87], v[84:87], v[36:39]
    v_mfma_f32_16x16x32_bf16 v[40:43], a[148:151], v[80:83], v[40:43]
    v_mfma_f32_16x16x32_bf16 v[44:47], a[148:151], v[84:87], v[44:47]
    v_mfma_f32_16x16x32_bf16 v[48:51], a[212:215], v[80:83], v[48:51]
    v_mfma_f32_16x16x32_bf16 v[52:55], a[212:215], v[84:87], v[52:55]
    v_mfma_f32_16x16x32_bf16 v[56:59], v[80:83], v[148:151], v[56:59]
    v_mfma_f32_16x16x32_bf16 v[60:63], v[84:87], v[148:151], v[60:63]
    v_mfma_f32_16x16x32_bf16 v[64:67], v[80:83], v[212:215], v[64:67]
    v_mfma_f32_16x16x32_bf16 v[68:71], v[84:87], v[212:215], v[68:71]
    ds_read_b128 v[80:83], v4 offset:7168
    ds_read_b128 v[84:87], v4 offset:23552
    s_waitcnt lgkmcnt(2)
    v_mfma_f32_16x16x32_bf16 v[24:27], a[24:27], v[72:75], v[24:27]
    v_mfma_f32_16x16x32_bf16 v[28:31], a[24:27], v[76:79], v[28:31]
    v_mfma_f32_16x16x32_bf16 v[32:35], a[88:91], v[72:75], v[32:35]
    v_mfma_f32_16x16x32_bf16 v[36:39], a[88:91], v[76:79], v[36:39]
    v_mfma_f32_16x16x32_bf16 v[40:43], a[152:155], v[72:75], v[40:43]
    v_mfma_f32_16x16x32_bf16 v[44:47], a[152:155], v[76:79], v[44:47]
    v_mfma_f32_16x16x32_bf16 v[48:51], a[216:219], v[72:75], v[48:51]
    v_mfma_f32_16x16x32_bf16 v[52:55], a[216:219], v[76:79], v[52:55]
    v_mfma_f32_16x16x32_bf16 v[56:59], v[72:75], v[152:155], v[56:59]
    v_mfma_f32_16x16x32_bf16 v[60:63], v[76:79], v[152:155], v[60:63]
    v_mfma_f32_16x16x32_bf16 v[64:67], v[72:75], v[216:219], v[64:67]
    v_mfma_f32_16x16x32_bf16 v[68:71], v[76:79], v[216:219], v[68:71]
    ds_read_b128 v[72:75], v4 offset:8192
    ds_read_b128 v[76:79], v4 offset:24576
    s_waitcnt lgkmcnt(2)
    v_mfma_f32_16x16x32_bf16 v[24:27], a[28:31], v[80:83], v[24:27]
    v_mfma_f32_16x16x32_bf16 v[28:31], a[28:31], v[84:87], v[28:31]
    v_mfma_f32_16x16x32_bf16 v[32:35], a[92:95], v[80:83], v[32:35]
    v_mfma_f32_16x16x32_bf16 v[36:39], a[92:95], v[84:87], v[36:39]
    v_mfma_f32_16x16x32_bf16 v[40:43], a[156:159], v[80:83], v[40:43]
    v_mfma_f32_16x16x32_bf16 v[44:47], a[156:159], v[84:87], v[44:47]
    v_mfma_f32_16x16x32_bf16 v[48:51], a[220:223], v[80:83], v[48:51]
    v_mfma_f32_16x16x32_bf16 v[52:55], a[220:223], v[84:87], v[52:55]
    v_mfma_f32_16x16x32_bf16 v[56:59], v[80:83], v[156:159], v[56:59]
    v_mfma_f32_16x16x32_bf16 v[60:63], v[84:87], v[156:159], v[60:63]
    v_mfma_f32_16x16x32_bf16 v[64:67], v[80:83], v[220:223], v[64:67]
    v_mfma_f32_16x16x32_bf16 v[68:71], v[84:87], v[220:223], v[68:71]
    ds_read_b128 v[80:83], v4 offset:9216
    ds_read_b128 v[84:87], v4 offset:25600
    s_waitcnt lgkmcnt(2)
    v_mfma_f32_16x16x32_bf16 v[24:27], a[32:35], v[72:75], v[24:27]
    v_mfma_f32_16x16x32_bf16 v[28:31], a[32:35], v[76:79], v[28:31]
    v_mfma_f32_16x16x32_bf16 v[32:35], a[96:99], v[72:75], v[32:35]
    v_mfma_f32_16x16x32_bf16 v[36:39], a[96:99], v[76:79], v[36:39]
    v_mfma_f32_16x16x32_bf16 v[40:43], a[160:163], v[72:75], v[40:43]
    v_mfma_f32_16x16x32_bf16 v[44:47], a[160:163], v[76:79], v[44:47]
    v_mfma_f32_16x16x32_bf16 v[48:51], a[224:227], v[72:75], v[48:51]
    v_mfma_f32_16x16x32_bf16 v[52:55], a[224:227], v[76:79], v[52:55]
    v_mfma_f32_16x16x32_bf16 v[56:59], v[72:75], v[160:163], v[56:59]
    v_mfma_f32_16x16x32_bf16 v[60:63], v[76:79], v[160:163], v[60:63]
    v_mfma_f32_16x16x32_bf16 v[64:67], v[72:75], v[224:227], v[64:67]
    v_mfma_f32_16x16x32_bf16 v[68:71], v[76:79], v[224:227], v[68:71]
    ds_read_b128 v[72:75], v4 offset:10240
    ds_read_b128 v[76:79], v4 offset:26624
    s_waitcnt lgkmcnt(2)
    v_mfma_f32_16x16x32_bf16 v[24:27], a[36:39], v[80:83], v[24:27]
    v_mfma_f32_16x16x32_bf16 v[28:31], a[36:39], v[84:87], v[28:31]
    v_mfma_f32_16x16x32_bf16 v[32:35], a[100:103], v[80:83], v[32:35]
    v_mfma_f32_16x16x32_bf16 v[36:39], a[100:103], v[84:87], v[36:39]
    v_mfma_f32_16x16x32_bf16 v[40:43], a[164:167], v[80:83], v[40:43]
    v_mfma_f32_16x16x32_bf16 v[44:47], a[164:167], v[84:87], v[44:47]
    v_mfma_f32_16x16x32_bf16 v[48:51], a[228:231], v[80:83], v[48:51]
    v_mfma_f32_16x16x32_bf16 v[52:55], a[228:231], v[84:87], v[52:55]
    v_mfma_f32_16x16x32_bf16 v[56:59], v[80:83], v[164:167], v[56:59]
    v_mfma_f32_16x16x32_bf16 v[60:63], v[84:87], v[164:167], v[60:63]
    v_mfma_f32_16x16x32_bf16 v[64:67], v[80:83], v[228:231], v[64:67]
    v_mfma_f32_16x16x32_bf16 v[68:71], v[84:87], v[228:231], v[68:71]
    ds_read_b128 v[80:83], v4 offset:11264
    ds_read_b128 v[84:87], v4 offset:27648
    s_waitcnt lgkmcnt(2)
    v_mfma_f32_16x16x32_bf16 v[24:27], a[40:43], v[72:75], v[24:27]
    v_mfma_f32_16x16x32_bf16 v[28:31], a[40:43], v[76:79], v[28:31]
    v_mfma_f32_16x16x32_bf16 v[32:35], a[104:107], v[72:75], v[32:35]
    v_mfma_f32_16x16x32_bf16 v[36:39], a[104:107], v[76:79], v[36:39]
    v_mfma_f32_16x16x32_bf16 v[40:43], a[168:171], v[72:75], v[40:43]
    v_mfma_f32_16x16x32_bf16 v[44:47], a[168:171], v[76:79], v[44:47]
    v_mfma_f32_16x16x32_bf16 v[48:51], a[232:235], v[72:75], v[48:51]
    v_mfma_f32_16x16x32_bf16 v[52:55], a[232:235], v[76:79], v[52:55]
    v_mfma_f32_16x16x32_bf16 v[56:59], v[72:75], v[168:171], v[56:59]
    v_mfma_f32_16x16x32_bf16 v[60:63], v[76:79], v[168:171], v[60:63]
    v_mfma_f32_16x16x32_bf16 v[64:67], v[72:75], v[232:235], v[64:67]
    v_mfma_f32_16x16x32_bf16 v[68:71], v[76:79], v[232:235], v[68:71]
    ds_read_b128 v[72:75], v4 offset:12288
    ds_read_b128 v[76:79], v4 offset:28672
    s_waitcnt lgkmcnt(2)
    v_mfma_f32_16x16x32_bf16 v[24:27], a[44:47], v[80:83], v[24:27]
    v_mfma_f32_16x16x32_bf16 v[28:31], a[44:47], v[84:87], v[28:31]
    v_mfma_f32_16x16x32_bf16 v[32:35], a[108:111], v[80:83], v[32:35]
    v_mfma_f32_16x16x32_bf16 v[36:39], a[108:111], v[84:87], v[36:39]
    v_mfma_f32_16x16x32_bf16 v[40:43], a[172:175], v[80:83], v[40:43]
    v_mfma_f32_16x16x32_bf16 v[44:47], a[172:175], v[84:87], v[44:47]
    v_mfma_f32_16x16x32_bf16 v[48:51], a[236:239], v[80:83], v[48:51]
    v_mfma_f32_16x16x32_bf16 v[52:55], a[236:239], v[84:87], v[52:55]
    v_mfma_f32_16x16x32_bf16 v[56:59], v[80:83], v[172:175], v[56:59]
    v_mfma_f32_16x16x32_bf16 v[60:63], v[84:87], v[172:175], v[60:63]
    v_mfma_f32_16x16x32_bf16 v[64:67], v[80:83], v[236:239], v[64:67]
    v_mfma_f32_16x16x32_bf16 v[68:71], v[84:87], v[236:239], v[68:71]
    ds_read_b128 v[80:83], v4 offset:13312
    ds_read_b128 v[84:87], v4 offset:29696
    s_waitcnt lgkmcnt(2)
    v_mfma_f32_16x16x32_bf16 v[24:27], a[48:51], v[72:75], v[24:27]
    v_mfma_f32_16x16x32_bf16 v[28:31], a[48:51], v[76:79], v[28:31]
    v_mfma_f32_16x16x32_bf16 v[32:35], a[112:115], v[72:75], v[32:35]
    v_mfma_f32_16x16x32_bf16 v[36:39], a[112:115], v[76:79], v[36:39]
    v_mfma_f32_16x16x32_bf16 v[40:43], a[176:179], v[72:75], v[40:43]
    v_mfma_f32_16x16x32_bf16 v[44:47], a[176:179], v[76:79], v[44:47]
    v_mfma_f32_16x16x32_bf16 v[48:51], a[240:243], v[72:75], v[48:51]
    v_mfma_f32_16x16x32_bf16 v[52:55], a[240:243], v[76:79], v[52:55]
    v_mfma_f32_16x16x32_bf16 v[56:59], v[72:75], v[176:179], v[56:59]
    v_mfma_f32_16x16x32_bf16 v[60:63], v[76:79], v[176:179], v[60:63]
    v_mfma_f32_16x16x32_bf16 v[64:67], v[72:75], v[240:243], v[64:67]
    v_mfma_f32_16x16x32_bf16 v[68:71], v[76:79], v[240:243], v[68:71]
    ds_read_b128 v[72:75], v4 offset:14336
    ds_read_b128 v[76:79], v4 offset:30720
    s_waitcnt lgkmcnt(2)
    v_mfma_f32_16x16x32_bf16 v[24:27], a[52:55], v[80:83], v[24:27]
    v_mfma_f32_16x16x32_bf16 v[28:31], a[52:55], v[84:87], v[28:31]
    v_mfma_f32_16x16x32_bf16 v[32:35], a[116:119], v[80:83], v[32:35]
    v_mfma_f32_16x16x32_bf16 v[36:39], a[116:119], v[84:87], v[36:39]
    v_mfma_f32_16x16x32_bf16 v[40:43], a[180:183], v[80:83], v[40:43]
    v_mfma_f32_16x16x32_bf16 v[44:47], a[180:183], v[84:87], v[44:47]
    v_mfma_f32_16x16x32_bf16 v[48:51], a[244:247], v[80:83], v[48:51]
    v_mfma_f32_16x16x32_bf16 v[52:55], a[244:247], v[84:87], v[52:55]
    v_mfma_f32_16x16x32_bf16 v[56:59], v[80:83], v[180:183], v[56:59]
    v_mfma_f32_16x16x32_bf16 v[60:63], v[84:87], v[180:183], v[60:63]
    v_mfma_f32_16x16x32_bf16 v[64:67], v[80:83], v[244:247], v[64:67]
    v_mfma_f32_16x16x32_bf16 v[68:71], v[84:87], v[244:247], v[68:71]
    ds_read_b128 v[80:83], v4 offset:15360
    ds_read_b128 v[84:87], v4 offset:31744
    s_waitcnt lgkmcnt(2)
    v_mfma_f32_16x16x32_bf16 v[24:27], a[56:59], v[72:75], v[24:27]
    v_mfma_f32_16x16x32_bf16 v[28:31], a[56:59], v[76:79], v[28:31]
    v_mfma_f32_16x16x32_bf16 v[32:35], a[120:123], v[72:75], v[32:35]
    v_mfma_f32_16x16x32_bf16 v[36:39], a[120:123], v[76:79], v[36:39]
    v_mfma_f32_16x16x32_bf16 v[40:43], a[184:187], v[72:75], v[40:43]
    v_mfma_f32_16x16x32_bf16 v[44:47], a[184:187], v[76:79], v[44:47]
    v_mfma_f32_16x16x32_bf16 v[48:51], a[248:251], v[72:75], v[48:51]
    v_mfma_f32_16x16x32_bf16 v[52:55], a[248:251], v[76:79], v[52:55]
    v_mfma_f32_16x16x32_bf16 v[56:59], v[72:75], v[184:187], v[56:59]
    v_mfma_f32_16x16x32_bf16 v[60:63], v[76:79], v[184:187], v[60:63]
    v_mfma_f32_16x16x32_bf16 v[64:67], v[72:75], v[248:251], v[64:67]
    v_mfma_f32_16x16x32_bf16 v[68:71], v[76:79], v[248:251], v[68:71]
    s_waitcnt lgkmcnt(0)
    v_mfma_f32_16x16x32_bf16 v[24:27], a[60:63], v[80:83], v[24:27]
    v_mfma_f32_16x16x32_bf16 v[28:31], a[60:63], v[84:87], v[28:31]
    v_mfma_f32_16x16x32_bf16 v[32:35], a[124:127], v[80:83], v[32:35]
    v_mfma_f32_16x16x32_bf16 v[36:39], a[124:127], v[84:87], v[36:39]
    v_mfma_f32_16x16x32_bf16 v[40:43], a[188:191], v[80:83], v[40:43]
    v_mfma_f32_16x16x32_bf16 v[44:47], a[188:191], v[84:87], v[44:47]
    v_mfma_f32_16x16x32_bf16 v[48:51], a[252:255], v[80:83], v[48:51]
    v_mfma_f32_16x16x32_bf16 v[52:55], a[252:255], v[84:87], v[52:55]
    v_mfma_f32_16x16x32_bf16 v[56:59], v[80:83], v[188:191], v[56:59]
    v_mfma_f32_16x16x32_bf16 v[60:63], v[84:87], v[188:191], v[60:63]
    v_mfma_f32_16x16x32_bf16 v[64:67], v[80:83], v[252:255], v[64:67]
    v_mfma_f32_16x16x32_bf16 v[68:71], v[84:87], v[252:255], v[68:71]
    v_cvt_pk_bf16_f32 v72, v40, v41
    v_cvt_pk_bf16_f32 v73, v42, v43
    v_cvt_pk_bf16_f32 v74, v48, v49
    v_cvt_pk_bf16_f32 v75, v50, v51
    v_cvt_pk_bf16_f32 v80, v24, v25
    v_cvt_pk_bf16_f32 v81, v26, v27
    v_cvt_pk_bf16_f32 v82, v32, v33
    v_cvt_pk_bf16_f32 v83, v34, v35
    v_cvt_pk_bf16_f32 v76, v44, v45
    v_cvt_pk_bf16_f32 v77, v46, v47
    v_cvt_pk_bf16_f32 v78, v52, v53
    v_cvt_pk_bf16_f32 v79, v54, v55
    v_cvt_pk_bf16_f32 v84, v28, v29
    v_cvt_pk_bf16_f32 v85, v30, v31
    v_cvt_pk_bf16_f32 v86, v36, v37
    v_cvt_pk_bf16_f32 v87, v38, v39
    v_cvt_pk_bf16_f32 v88, v56, v57
    v_cvt_pk_bf16_f32 v89, v58, v59
    v_cvt_pk_bf16_f32 v90, v60, v61
    v_cvt_pk_bf16_f32 v91, v62, v63
    v_cvt_pk_bf16_f32 v92, v64, v65
    v_cvt_pk_bf16_f32 v93, v66, v67
    v_cvt_pk_bf16_f32 v94, v68, v69
    v_cvt_pk_bf16_f32 v95, v70, v71
    s_lshl_b32 s5, s3, 6
    s_add_u32 s5, s5, s18
    s_lshl_b32 s5, s5, 13
    s_lshl_b32 s6, s4, 10
    s_add_u32 s7, s5, s6
    s_add_u32 s7, s7, 33554432
    buffer_store_dwordx4 v[72:75], v1, s[8:11], s7 offen sc1
    s_add_u32 s7, s7, 4096
    buffer_store_dwordx4 v[76:79], v1, s[8:11], s7 offen sc1
    s_lshl_b32 s6, s4, 11
    s_add_u32 s7, s5, s6
    s_add_u32 s7, s7, 50331648
    buffer_store_dwordx4 v[88:91], v1, s[8:11], s7 offen sc1
    buffer_store_dwordx4 v[92:95], v1, s[8:11], s7 offen offset:1024 sc1
    s_lshl_b32 s6, s4, 10
    s_add_u32 s5, s6, s21
    v_add_u32 v4, s5, v1
    ds_write_b128 v4, v[80:83]
    ds_write_b128 v4, v[84:87] offset:4096
    ds_write_b128 v4, v[72:75] offset:8192
    ds_write_b128 v4, v[76:79] offset:12288
    v_add_u32 v4, s6, v4
    ds_write_b128 v4, v[88:91] offset:16384
    ds_write_b128 v4, v[92:95] offset:17408
    s_add_u32 s17, s17, 1
    s_waitcnt vmcnt(0) lgkmcnt(0)
    s_barrier
    s_lshl_b32 s5, s3, 4
    s_lshl_b32 s6, s16, 2
    s_add_u32 s5, s5, s6
    s_add_u32 s24, s5, 0
    s_cmp_lg_u32 s4, 0
    s_cbranch_scc1 qk_pf_16
    v_mov_b32 v6, s17
    v_mov_b32 v7, 0
    s_mov_b64 exec, 1
    buffer_store_dword v6, v7, s[8:11], s24 offen sc1
    s_mov_b64 exec, -1
qk_pf_16:
    s_add_u32 s18, s18, 3
    s_xor_b32 s20, s20, 131072
    s_add_u32 s21, s21, 24576
    s_cmp_lt_u32 s21, 106496
    s_cselect_b32 s21, s21, 32768
    s_cmp_gt_u32 s17, 2
    s_cbranch_scc1 qk_att
    s_cmp_lt_u32 s17, s19
    s_cbranch_scc1 qk_loop
qk_att:
    s_cmp_lg_u32 s25, 0
    s_cbranch_scc1 qk_att2
    s_cmp_lg_u32 s4, 0
    s_cbranch_scc1 dbw_17_x
    s_mov_b32 s70, 0
dbw_17:
    buffer_load_dword v6, off, s[64:67], 0 offset:128 sc1
    s_add_u32 s70, s70, 1
    s_cmp_gt_u32 s70, 0x10000
    s_cbranch_scc1 dbw_17_y
    s_waitcnt vmcnt(0)
    v_readfirstlane_b32 s71, v6
    s_nop 0
    s_cmp_ge_u32 s71, 174
    s_cbranch_scc1 dbw_17_x
    s_sleep 8
    s_branch dbw_17
dbw_17_y:
    s_waitcnt vmcnt(0)
dbw_17_x:
    s_barrier
qk_att2:
    s_lshl_b32 s5, s32, 12
    s_add_u32 s5, s5, s27
    v_add_u32 v4, s5, v1
    ds_read_b128 v[24:27], v4 offset:0
    ds_read_b128 v[28:31], v4 offset:1024
    ds_read_b128 v[32:35], v4 offset:2048
    ds_read_b128 v[36:39], v4 offset:3072
    v_add_u32 v4, s27, v1
    ds_read_b128 v[40:43], v4 offset:8192
    ds_read_b128 v[44:47], v4 offset:9216
    ds_read_b128 v[48:51], v4 offset:10240
    ds_read_b128 v[52:55], v4 offset:11264
    ds_read_b128 v[56:59], v4 offset:12288
    ds_read_b128 v[60:63], v4 offset:13312
    ds_read_b128 v[64:67], v4 offset:14336
    ds_read_b128 v[68:71], v4 offset:15360
    s_waitcnt lgkmcnt(0)
    v_mfma_f32_16x16x32_bf16 v[112:115], v[40:43], v[24:27], v[8:11]
    v_mfma_f32_16x16x32_bf16 v[116:119], v[56:59], v[24:27], v[12:15]
    v_mfma_f32_16x16x32_bf16 v[112:115], v[44:47], v[28:31], v[112:115]
    v_mfma_f32_16x16x32_bf16 v[116:119], v[60:63], v[28:31], v[116:119]
    v_mfma_f32_16x16x32_bf16 v[112:115], v[48:51], v[32:35], v[112:115]
    v_mfma_f32_16x16x32_bf16 v[116:119], v[64:67], v[32:35], v[116:119]
    v_mfma_f32_16x16x32_bf16 v[112:115], v[52:55], v[36:39], v[112:115]
    v_mfma_f32_16x16x32_bf16 v[116:119], v[68:71], v[36:39], v[116:119]
    s_lshl_b32 s5, s33, 12
    s_add_u32 s5, s5, s27
    v_add_u32 v4, s5, v1
    ds_read_b128 v[88:91], v4 offset:16384
    ds_read_b128 v[92:95], v4 offset:17408
    ds_read_b128 v[96:99], v4 offset:18432
    ds_read_b128 v[100:103], v4 offset:19456
    s_add_u32 s22, s26, 1
    s_mov_b32 s31, 0
qk_kvm_18:
    buffer_load_dword v6, v5, s[8:11], 0 offen sc1
    s_add_u32 s31, s31, 1
    s_cmp_gt_u32 s31, 0x8000
    s_cbranch_scc1 qk_kvm_18_fail
    s_waitcnt vmcnt(0)
    v_cmp_gt_u32 vcc, s22, v6
    s_cbranch_vccz qk_kvm_18_ok
    s_sleep 2
    s_branch qk_kvm_18
qk_kvm_18_fail:
    s_add_u32 s30, s30, 1
    s_waitcnt vmcnt(0)
qk_kvm_18_ok:
    s_lshl_b32 s5, s26, 5
    s_add_u32 s5, s5, s3
    s_lshl_b32 s5, s5, 11
    s_add_u32 s6, s5, 5242880
    s_add_u32 s7, s5, 9437184
    buffer_load_dwordx4 v[72:75], v2, s[8:11], s6 offen offset:0 sc1
    buffer_load_dwordx4 v[76:79], v2, s[8:11], s6 offen offset:64 sc1
    buffer_load_dwordx4 v[80:83], v2, s[8:11], s6 offen offset:128 sc1
    buffer_load_dwordx4 v[84:87], v2, s[8:11], s6 offen offset:192 sc1
    buffer_load_dwordx2 v[104:105], v3, s[8:11], s7 offen sc1
    buffer_load_dwordx2 v[106:107], v3, s[8:11], s7 offen offset:512 sc1
    s_waitcnt vmcnt(2)
    v_mfma_f32_16x16x32_bf16 v[120:123], v[72:75], v[24:27], v[16:19]
    v_mfma_f32_16x16x32_bf16 v[120:123], v[76:79], v[28:31], v[120:123]
    v_mfma_f32_16x16x32_bf16 v[120:123], v[80:83], v[32:35], v[120:123]
    v_mfma_f32_16x16x32_bf16 v[120:123], v[84:87], v[36:39], v[120:123]
    v_max3_f32 v6, v112, v113, v114
    v_max3_f32 v7, v115, v116, v117
    v_max3_f32 v6, v6, v118, v119
    s_nop 4
    v_max3_f32 v7, v7, v120, v121
    v_max_f32 v6, v6, v7
    v_mov_b32 v7, v6
    s_nop 1
    v_permlane32_swap_b32 v6, v7
    v_max_f32 v6, v6, v7
    v_mov_b32 v7, v6
    s_nop 1
    v_permlane16_swap_b32 v6, v7
    v_max_f32 v6, v6, v7
    v_mul_f32 v6, 0xbe0293ee, v6
    v_fma_f32 v112, v112, s28, v6
    v_fma_f32 v113, v113, s28, v6
    v_fma_f32 v114, v114, s28, v6
    v_fma_f32 v115, v115, s28, v6
    v_fma_f32 v116, v116, s28, v6
    v_fma_f32 v117, v117, s28, v6
    v_fma_f32 v118, v118, s28, v6
    v_fma_f32 v119, v119, s28, v6
    v_fma_f32 v120, v120, s28, v6
    v_fma_f32 v121, v121, s28, v6
    v_exp_f32 v112, v112
    v_exp_f32 v113, v113
    v_exp_f32 v114, v114
    v_exp_f32 v115, v115
    v_exp_f32 v116, v116
    v_exp_f32 v117, v117
    v_exp_f32 v118, v118
    v_exp_f32 v119, v119
    v_exp_f32 v120, v120
    v_exp_f32 v121, v121
    v_cvt_pk_bf16_f32 v40, v112, v113
    v_cvt_pk_bf16_f32 v41, v114, v115
    v_cvt_pk_bf16_f32 v42, v116, v117
    v_cvt_pk_bf16_f32 v43, v118, v119
    v_cvt_pk_bf16_f32 v44, v120, v121
    v_mov_b32 v45, 0
    s_waitcnt vmcnt(0) lgkmcnt(0)
    v_mov_b32 v48, v104
    v_mov_b32 v49, 0
    v_mov_b32 v50, v105
    v_mov_b32 v51, 0
    v_mov_b32 v52, v106
    v_mov_b32 v53, 0
    v_mov_b32 v54, v107
    v_mov_b32 v55, 0
    v_mfma_f32_16x16x32_bf16 v[56:59], v[88:91], v[40:43], 0
    v_mfma_f32_16x16x32_bf16 v[60:63], v[92:95], v[40:43], 0
    v_mfma_f32_16x16x32_bf16 v[64:67], v[96:99], v[40:43], 0
    v_mfma_f32_16x16x32_bf16 v[68:71], v[100:103], v[40:43], 0
    v_mfma_f32_16x16x16_bf16 v[56:59], v[48:49], v[44:45], v[56:59]
    v_mfma_f32_16x16x16_bf16 v[60:63], v[50:51], v[44:45], v[60:63]
    v_mfma_f32_16x16x16_bf16 v[64:67], v[52:53], v[44:45], v[64:67]
    v_mfma_f32_16x16x16_bf16 v[68:71], v[54:55], v[44:45], v[68:71]
    v_dot2_f32_bf16 v6, v40, s29, 0
    v_dot2_f32_bf16 v7, v41, s29, 0
    v_dot2_f32_bf16 v6, v42, s29, v6
    v_dot2_f32_bf16 v7, v43, s29, v7
    v_dot2_f32_bf16 v6, v44, s29, v6
    s_nop 2
    v_add_f32 v6, v6, v7
    v_mov_b32 v7, v6
    s_nop 1
    v_permlane32_swap_b32 v6, v7
    v_add_f32 v6, v6, v7
    v_mov_b32 v7, v6
    s_nop 1
    v_permlane16_swap_b32 v6, v7
    v_add_f32 v6, v6, v7
    v_rcp_f32 v6, v6
    s_nop 0
    v_mul_f32 v56, v56, v6
    v_mul_f32 v57, v57, v6
    v_mul_f32 v58, v58, v6
    v_mul_f32 v59, v59, v6
    v_mul_f32 v60, v60, v6
    v_mul_f32 v61, v61, v6
    v_mul_f32 v62, v62, v6
    v_mul_f32 v63, v63, v6
    v_mul_f32 v64, v64, v6
    v_mul_f32 v65, v65, v6
    v_mul_f32 v66, v66, v6
    v_mul_f32 v67, v67, v6
    v_mul_f32 v68, v68, v6
    v_mul_f32 v69, v69, v6
    v_mul_f32 v70, v70, v6
    v_mul_f32 v71, v71, v6
    v_cvt_pk_bf16_f32 v72, v56, v57
    v_cvt_pk_bf16_f32 v73, v58, v59
    v_cvt_pk_bf16_f32 v74, v60, v61
    v_cvt_pk_bf16_f32 v75, v62, v63
    v_cvt_pk_bf16_f32 v76, v64, v65
    v_cvt_pk_bf16_f32 v77, v66, v67
    v_cvt_pk_bf16_f32 v78, v68, v69
    v_cvt_pk_bf16_f32 v79, v70, v71
    s_lshl_b32 s5, s26, 18
    s_lshl_b32 s6, s32, 17
    s_add_u32 s5, s5, s6
    s_lshl_b32 s6, s3, 12
    s_add_u32 s5, s5, s6
    s_lshl_b32 s6, s33, 11
    s_add_u32 s5, s5, s6
    s_add_u32 s5, s5, 67108864
    buffer_store_dwordx4 v[72:75], v1, s[8:11], s5 offen sc1
    buffer_store_dwordx4 v[76:79], v1, s[8:11], s5 offen offset:1024 sc1
    s_add_u32 s25, s25, 1
    s_waitcnt vmcnt(0)
    s_barrier
    s_lshl_b32 s5, s16, 7
    s_lshl_b32 s6, s3, 2
    s_add_u32 s5, s5, s6
    s_add_u32 s24, s5, 2048
    s_cmp_lg_u32 s4, 0
    s_cbranch_scc1 qk_pf_19
    v_mov_b32 v6, s25
    v_mov_b32 v7, 0
    s_mov_b64 exec, 1
    buffer_store_dword v6, v7, s[8:11], s24 offen sc1
    s_mov_b64 exec, -1
qk_pf_19:
    s_add_u32 s26, s26, 3
    s_add_u32 s27, s27, 24576
    s_cmp_lt_u32 s27, 106496
    s_cselect_b32 s27, s27, 32768
    s_cmp_lt_u32 s17, s19
    s_cbranch_scc1 qk_loop
    s_cmp_lt_u32 s25, s19
    s_cbranch_scc1 qk_att
    s_endpgm
mg_f1:
    s_lshr_b32 s3, s5, 1
    s_and_b32 s16, s5, 1
    s_load_dwordx2 s[68:69], s[0:1], 96
    s_waitcnt lgkmcnt(0)
    s_mov_b32 s64, s68
    s_and_b32 s65, s69, 0xffff
    s_mov_b32 s66, 256
    s_mov_b32 s67, 0x20000
    s_load_dwordx4 s[36:39], s[0:1], 64
    s_load_dwordx2 s[42:43], s[0:1], 104
    v_lshrrev_b32 v24, 6, v0
    v_and_b32 v0, 63, v0
    v_readfirstlane_b32 s4, v24
    v_lshlrev_b32 v1, 4, v0
    v_lshrrev_b32 v25, 4, v0
    s_waitcnt lgkmcnt(0)
    s_mov_b32 s8, s42
    s_and_b32 s9, s43, 0xffff
    s_mov_b32 s10, 268435456
    s_mov_b32 s11, 0x20000
    s_mov_b32 s12, s38
    s_and_b32 s13, s39, 0xffff
    s_mov_b32 s14, 3584
    s_mov_b32 s15, 0x20000
    s_lshl_b32 s5, s3, 9
    s_lshl_b32 s6, s4, 7
    s_add_u32 s5, s5, s6
    v_lshlrev_b32 v26, 3, v25
    buffer_load_dwordx2 v[40:41], v26, s[12:15], s5 offen offset:0
    buffer_load_dwordx2 v[42:43], v26, s[12:15], s5 offen offset:32
    buffer_load_dwordx2 v[44:45], v26, s[12:15], s5 offen offset:64
    buffer_load_dwordx2 v[46:47], v26, s[12:15], s5 offen offset:96
    s_waitcnt vmcnt(0)
    v_lshlrev_b32 v8, 16, v40
    v_and_b32 v9, 0xffff0000, v40
    v_lshlrev_b32 v10, 16, v41
    v_and_b32 v11, 0xffff0000, v41
    v_lshlrev_b32 v12, 16, v42
    v_and_b32 v13, 0xffff0000, v42
    v_lshlrev_b32 v14, 16, v43
    v_and_b32 v15, 0xffff0000, v43
    v_lshlrev_b32 v16, 16, v44
    v_and_b32 v17, 0xffff0000, v44
    v_lshlrev_b32 v18, 16, v45
    v_and_b32 v19, 0xffff0000, v45
    v_lshlrev_b32 v20, 16, v46
    v_and_b32 v21, 0xffff0000, v46
    v_lshlrev_b32 v22, 16, v47
    v_and_b32 v23, 0xffff0000, v47
    s_mov_b32 s12, s36
    s_and_b32 s13, s37, 0xffff
    s_mov_b32 s14, 1835008
    s_mov_b32 s15, 0x20000
    v_lshrrev_b32 v26, 3, v0
    v_mul_u32_u24 v26, 3584, v26
    v_bfe_u32 v27, v0, 4, 1
    v_lshlrev_b32 v27, 1, v27
    v_and_b32 v28, 7, v0
    v_xor_b32 v27, v27, v28
    v_lshlrev_b32 v27, 4, v27
    v_add_u32 v24, v26, v27
    v_xor_b32 v28, 64, v27
    v_add_u32 v25, v26, v28
    v_bfe_u32 v28, v0, 2, 2
    v_lshrrev_b32 v29, 4, v0
    v_lshl_add_u32 v30, v29, 3, v28
    v_lshlrev_b32 v30, 7, v30
    v_lshrrev_b32 v31, 1, v28
    v_and_b32 v32, 1, v29
    v_lshl_add_u32 v31, v32, 1, v31
    v_lshlrev_b32 v31, 1, v31
    v_bfe_u32 v32, v0, 1, 1
    v_xor_b32 v31, v31, v32
    v_lshl_add_u32 v30, v31, 4, v30
    v_and_b32 v32, 1, v0
    v_lshl_add_u32 v30, v32, 3, v30
    s_lshl_b32 s5, s4, 15
    v_add_u32 v26, s5, v30
    s_lshl_b32 s5, s3, 9
    s_lshl_b32 s6, s4, 7
    s_add_u32 s5, s5, s6
    s_lshl_b32 s6, s4, 15
    s_mov_b32 m0, s6
    s_nop 0
    buffer_load_dwordx4 v24, s[12:15], s5 offen lds
    s_add_u32 s5, s5, 28672
    s_add_u32 s6, s6, 1024
    s_mov_b32 m0, s6
    s_nop 0
    buffer_load_dwordx4 v25, s[12:15], s5 offen lds
    s_add_u32 s5, s5, 28672
    s_add_u32 s6, s6, 1024
    s_mov_b32 m0, s6
    s_nop 0
    buffer_load_dwordx4 v24, s[12:15], s5 offen lds
    s_add_u32 s5, s5, 28672
    s_add_u32 s6, s6, 1024
    s_mov_b32 m0, s6
    s_nop 0
    buffer_load_dwordx4 v25, s[12:15], s5 offen lds
    s_add_u32 s5, s5, 28672
    s_add_u32 s6, s6, 1024
    s_mov_b32 m0, s6
    s_nop 0
    buffer_load_dwordx4 v24, s[12:15], s5 offen lds
    s_add_u32 s5, s5, 28672
    s_add_u32 s6, s6, 1024
    s_mov_b32 m0, s6
    s_nop 0
    buffer_load_dwordx4 v25, s[12:15], s5 offen lds
    s_add_u32 s5, s5, 28672
    s_add_u32 s6, s6, 1024
    s_mov_b32 m0, s6
    s_nop 0
    buffer_load_dwordx4 v24, s[12:15], s5 offen lds
    s_add_u32 s5, s5, 28672
    s_add_u32 s6, s6, 1024
    s_mov_b32 m0, s6
    s_nop 0
    buffer_load_dwordx4 v25, s[12:15], s5 offen lds
    s_add_u32 s5, s5, 28672
    s_add_u32 s6, s6, 1024
    s_mov_b32 m0, s6
    s_nop 0
    buffer_load_dwordx4 v24, s[12:15], s5 offen lds
    s_add_u32 s5, s5, 28672
    s_add_u32 s6, s6, 1024
    s_mov_b32 m0, s6
    s_nop 0
    buffer_load_dwordx4 v25, s[12:15], s5 offen lds
    s_add_u32 s5, s5, 28672
    s_add_u32 s6, s6, 1024
    s_mov_b32 m0, s6
    s_nop 0
    buffer_load_dwordx4 v24, s[12:15], s5 offen lds
    s_add_u32 s5, s5, 28672
    s_add_u32 s6, s6, 1024
    s_mov_b32 m0, s6
    s_nop 0
    buffer_load_dwordx4 v25, s[12:15], s5 offen lds
    s_add_u32 s5, s5, 28672
    s_add_u32 s6, s6, 1024
    s_mov_b32 m0, s6
    s_nop 0
    buffer_load_dwordx4 v24, s[12:15], s5 offen lds
    s_add_u32 s5, s5, 28672
    s_add_u32 s6, s6, 1024
    s_mov_b32 m0, s6
    s_nop 0
    buffer_load_dwordx4 v25, s[12:15], s5 offen lds
    s_add_u32 s5, s5, 28672
    s_add_u32 s6, s6, 1024
    s_mov_b32 m0, s6
    s_nop 0
    buffer_load_dwordx4 v24, s[12:15], s5 offen lds
    s_add_u32 s5, s5, 28672
    s_add_u32 s6, s6, 1024
    s_mov_b32 m0, s6
    s_nop 0
    buffer_load_dwordx4 v25, s[12:15], s5 offen lds
    s_add_u32 s5, s5, 28672
    s_add_u32 s6, s6, 1024
    s_mov_b32 m0, s6
    s_nop 0
    buffer_load_dwordx4 v24, s[12:15], s5 offen lds
    s_add_u32 s5, s5, 28672
    s_add_u32 s6, s6, 1024
    s_mov_b32 m0, s6
    s_nop 0
    buffer_load_dwordx4 v25, s[12:15], s5 offen lds
    s_add_u32 s5, s5, 28672
    s_add_u32 s6, s6, 1024
    s_mov_b32 m0, s6
    s_nop 0
    buffer_load_dwordx4 v24, s[12:15], s5 offen lds
    s_add_u32 s5, s5, 28672
    s_add_u32 s6, s6, 1024
    s_mov_b32 m0, s6
    s_nop 0
    buffer_load_dwordx4 v25, s[12:15], s5 offen lds
    s_add_u32 s5, s5, 28672
    s_add_u32 s6, s6, 1024
    s_mov_b32 m0, s6
    s_nop 0
    buffer_load_dwordx4 v24, s[12:15], s5 offen lds
    s_add_u32 s5, s5, 28672
    s_add_u32 s6, s6, 1024
    s_mov_b32 m0, s6
    s_nop 0
    buffer_load_dwordx4 v25, s[12:15], s5 offen lds
    s_add_u32 s5, s5, 28672
    s_add_u32 s6, s6, 1024
    s_mov_b32 m0, s6
    s_nop 0
    buffer_load_dwordx4 v24, s[12:15], s5 offen lds
    s_add_u32 s5, s5, 28672
    s_add_u32 s6, s6, 1024
    s_mov_b32 m0, s6
    s_nop 0
    buffer_load_dwordx4 v25, s[12:15], s5 offen lds
    s_add_u32 s5, s5, 28672
    s_add_u32 s6, s6, 1024
    s_mov_b32 m0, s6
    s_nop 0
    buffer_load_dwordx4 v24, s[12:15], s5 offen lds
    s_add_u32 s5, s5, 28672
    s_add_u32 s6, s6, 1024
    s_mov_b32 m0, s6
    s_nop 0
    buffer_load_dwordx4 v25, s[12:15], s5 offen lds
    s_add_u32 s5, s5, 28672
    s_add_u32 s6, s6, 1024
    s_mov_b32 m0, s6
    s_nop 0
    buffer_load_dwordx4 v24, s[12:15], s5 offen lds
    s_add_u32 s5, s5, 28672
    s_add_u32 s6, s6, 1024
    s_mov_b32 m0, s6
    s_nop 0
    buffer_load_dwordx4 v25, s[12:15], s5 offen lds
    s_add_u32 s5, s5, 28672
    s_add_u32 s6, s6, 1024
    s_mov_b32 m0, s6
    s_nop 0
    buffer_load_dwordx4 v24, s[12:15], s5 offen lds
    s_add_u32 s5, s5, 28672
    s_add_u32 s6, s6, 1024
    s_mov_b32 m0, s6
    s_nop 0
    buffer_load_dwordx4 v25, s[12:15], s5 offen lds
    s_add_u32 s5, s5, 28672
    s_add_u32 s6, s6, 1024
    s_mov_b32 m0, s6
    s_nop 0
    buffer_load_dwordx4 v24, s[12:15], s5 offen lds
    s_add_u32 s5, s5, 28672
    s_add_u32 s6, s6, 1024
    s_mov_b32 m0, s6
    s_nop 0
    buffer_load_dwordx4 v25, s[12:15], s5 offen lds
    s_lshl_b32 s7, s16, 5
    s_lshl_b32 s22, s3, 2
    s_add_u32 s7, s7, s22
    s_add_u32 s7, s7, 3072
    v_mov_b32 v40, 0
    buffer_store_dword v40, off, s[8:11], s7 sc1
    s_waitcnt vmcnt(0)
    s_barrier
    s_cmp_lg_u32 s4, 0
    s_cbranch_scc1 dba_20
    v_mov_b32 v40, 1
    s_mov_b64 exec, 1
    buffer_atomic_add v40, off, s[64:67], 0 offset:128 sc1
    s_mov_b64 exec, -1
dba_20:
    v_xor_b32 v27, 0, v26
    ds_read_b64_tr_b16 a[0:1], v27 offset:0
    ds_read_b64_tr_b16 a[2:3], v27 offset:512
    ds_read_b64_tr_b16 a[4:5], v27 offset:4096
    ds_read_b64_tr_b16 a[6:7], v27 offset:4608
    ds_read_b64_tr_b16 a[8:9], v27 offset:8192
    ds_read_b64_tr_b16 a[10:11], v27 offset:8704
    ds_read_b64_tr_b16 a[12:13], v27 offset:12288
    ds_read_b64_tr_b16 a[14:15], v27 offset:12800
    s_waitcnt lgkmcnt(4)
    ds_read_b64_tr_b16 a[16:17], v27 offset:16384
    ds_read_b64_tr_b16 a[18:19], v27 offset:16896
    ds_read_b64_tr_b16 a[20:21], v27 offset:20480
    ds_read_b64_tr_b16 a[22:23], v27 offset:20992
    ds_read_b64_tr_b16 a[24:25], v27 offset:24576
    ds_read_b64_tr_b16 a[26:27], v27 offset:25088
    ds_read_b64_tr_b16 a[28:29], v27 offset:28672
    ds_read_b64_tr_b16 a[30:31], v27 offset:29184
    s_waitcnt lgkmcnt(4)
    v_xor_b32 v27, 32, v26
    ds_read_b64_tr_b16 a[64:65], v27 offset:0
    ds_read_b64_tr_b16 a[66:67], v27 offset:512
    ds_read_b64_tr_b16 a[68:69], v27 offset:4096
    ds_read_b64_tr_b16 a[70:71], v27 offset:4608
    ds_read_b64_tr_b16 a[72:73], v27 offset:8192
    ds_read_b64_tr_b16 a[74:75], v27 offset:8704
    ds_read_b64_tr_b16 a[76:77], v27 offset:12288
    ds_read_b64_tr_b16 a[78:79], v27 offset:12800
    s_waitcnt lgkmcnt(4)
    ds_read_b64_tr_b16 a[80:81], v27 offset:16384
    ds_read_b64_tr_b16 a[82:83], v27 offset:16896
    ds_read_b64_tr_b16 a[84:85], v27 offset:20480
    ds_read_b64_tr_b16 a[86:87], v27 offset:20992
    ds_read_b64_tr_b16 a[88:89], v27 offset:24576
    ds_read_b64_tr_b16 a[90:91], v27 offset:25088
    ds_read_b64_tr_b16 a[92:93], v27 offset:28672
    ds_read_b64_tr_b16 a[94:95], v27 offset:29184
    s_waitcnt lgkmcnt(4)
    v_xor_b32 v27, 64, v26
    ds_read_b64_tr_b16 a[128:129], v27 offset:0
    ds_read_b64_tr_b16 a[130:131], v27 offset:512
    ds_read_b64_tr_b16 a[132:133], v27 offset:4096
    ds_read_b64_tr_b16 a[134:135], v27 offset:4608
    ds_read_b64_tr_b16 a[136:137], v27 offset:8192
    ds_read_b64_tr_b16 a[138:139], v27 offset:8704
    ds_read_b64_tr_b16 a[140:141], v27 offset:12288
    ds_read_b64_tr_b16 a[142:143], v27 offset:12800
    s_waitcnt lgkmcnt(4)
    ds_read_b64_tr_b16 a[144:145], v27 offset:16384
    ds_read_b64_tr_b16 a[146:147], v27 offset:16896
    ds_read_b64_tr_b16 a[148:149], v27 offset:20480
    ds_read_b64_tr_b16 a[150:151], v27 offset:20992
    ds_read_b64_tr_b16 a[152:153], v27 offset:24576
    ds_read_b64_tr_b16 a[154:155], v27 offset:25088
    ds_read_b64_tr_b16 a[156:157], v27 offset:28672
    ds_read_b64_tr_b16 a[158:159], v27 offset:29184
    s_waitcnt lgkmcnt(4)
    v_xor_b32 v27, 96, v26
    ds_read_b64_tr_b16 a[192:193], v27 offset:0
    ds_read_b64_tr_b16 a[194:195], v27 offset:512
    ds_read_b64_tr_b16 a[196:197], v27 offset:4096
    ds_read_b64_tr_b16 a[198:199], v27 offset:4608
    ds_read_b64_tr_b16 a[200:201], v27 offset:8192
    ds_read_b64_tr_b16 a[202:203], v27 offset:8704
    ds_read_b64_tr_b16 a[204:205], v27 offset:12288
    ds_read_b64_tr_b16 a[206:207], v27 offset:12800
    s_waitcnt lgkmcnt(4)
    ds_read_b64_tr_b16 a[208:209], v27 offset:16384
    ds_read_b64_tr_b16 a[210:211], v27 offset:16896
    ds_read_b64_tr_b16 a[212:213], v27 offset:20480
    ds_read_b64_tr_b16 a[214:215], v27 offset:20992
    ds_read_b64_tr_b16 a[216:217], v27 offset:24576
    ds_read_b64_tr_b16 a[218:219], v27 offset:25088
    ds_read_b64_tr_b16 a[220:221], v27 offset:28672
    ds_read_b64_tr_b16 a[222:223], v27 offset:29184
    s_waitcnt lgkmcnt(4)
    s_waitcnt lgkmcnt(0)
    s_lshl_b32 s5, s3, 9
    s_lshl_b32 s6, s4, 7
    s_add_u32 s5, s5, s6
    s_add_u32 s5, s5, 917504
    s_lshl_b32 s6, s4, 15
    s_mov_b32 m0, s6
    s_nop 0
    buffer_load_dwordx4 v24, s[12:15], s5 offen lds
    s_add_u32 s5, s5, 28672
    s_add_u32 s6, s6, 1024
    s_mov_b32 m0, s6
    s_nop 0
    buffer_load_dwordx4 v25, s[12:15], s5 offen lds
    s_add_u32 s5, s5, 28672
    s_add_u32 s6, s6, 1024
    s_mov_b32 m0, s6
    s_nop 0
    buffer_load_dwordx4 v24, s[12:15], s5 offen lds
    s_add_u32 s5, s5, 28672
    s_add_u32 s6, s6, 1024
    s_mov_b32 m0, s6
    s_nop 0
    buffer_load_dwordx4 v25, s[12:15], s5 offen lds
    s_add_u32 s5, s5, 28672
    s_add_u32 s6, s6, 1024
    s_mov_b32 m0, s6
    s_nop 0
    buffer_load_dwordx4 v24, s[12:15], s5 offen lds
    s_add_u32 s5, s5, 28672
    s_add_u32 s6, s6, 1024
    s_mov_b32 m0, s6
    s_nop 0
    buffer_load_dwordx4 v25, s[12:15], s5 offen lds
    s_add_u32 s5, s5, 28672
    s_add_u32 s6, s6, 1024
    s_mov_b32 m0, s6
    s_nop 0
    buffer_load_dwordx4 v24, s[12:15], s5 offen lds
    s_add_u32 s5, s5, 28672
    s_add_u32 s6, s6, 1024
    s_mov_b32 m0, s6
    s_nop 0
    buffer_load_dwordx4 v25, s[12:15], s5 offen lds
    s_add_u32 s5, s5, 28672
    s_add_u32 s6, s6, 1024
    s_mov_b32 m0, s6
    s_nop 0
    buffer_load_dwordx4 v24, s[12:15], s5 offen lds
    s_add_u32 s5, s5, 28672
    s_add_u32 s6, s6, 1024
    s_mov_b32 m0, s6
    s_nop 0
    buffer_load_dwordx4 v25, s[12:15], s5 offen lds
    s_add_u32 s5, s5, 28672
    s_add_u32 s6, s6, 1024
    s_mov_b32 m0, s6
    s_nop 0
    buffer_load_dwordx4 v24, s[12:15], s5 offen lds
    s_add_u32 s5, s5, 28672
    s_add_u32 s6, s6, 1024
    s_mov_b32 m0, s6
    s_nop 0
    buffer_load_dwordx4 v25, s[12:15], s5 offen lds
    s_add_u32 s5, s5, 28672
    s_add_u32 s6, s6, 1024
    s_mov_b32 m0, s6
    s_nop 0
    buffer_load_dwordx4 v24, s[12:15], s5 offen lds
    s_add_u32 s5, s5, 28672
    s_add_u32 s6, s6, 1024
    s_mov_b32 m0, s6
    s_nop 0
    buffer_load_dwordx4 v25, s[12:15], s5 offen lds
    s_add_u32 s5, s5, 28672
    s_add_u32 s6, s6, 1024
    s_mov_b32 m0, s6
    s_nop 0
    buffer_load_dwordx4 v24, s[12:15], s5 offen lds
    s_add_u32 s5, s5, 28672
    s_add_u32 s6, s6, 1024
    s_mov_b32 m0, s6
    s_nop 0
    buffer_load_dwordx4 v25, s[12:15], s5 offen lds
    s_add_u32 s5, s5, 28672
    s_add_u32 s6, s6, 1024
    s_mov_b32 m0, s6
    s_nop 0
    buffer_load_dwordx4 v24, s[12:15], s5 offen lds
    s_add_u32 s5, s5, 28672
    s_add_u32 s6, s6, 1024
    s_mov_b32 m0, s6
    s_nop 0
    buffer_load_dwordx4 v25, s[12:15], s5 offen lds
    s_add_u32 s5, s5, 28672
    s_add_u32 s6, s6, 1024
    s_mov_b32 m0, s6
    s_nop 0
    buffer_load_dwordx4 v24, s[12:15], s5 offen lds
    s_add_u32 s5, s5, 28672
    s_add_u32 s6, s6, 1024
    s_mov_b32 m0, s6
    s_nop 0
    buffer_load_dwordx4 v25, s[12:15], s5 offen lds
    s_add_u32 s5, s5, 28672
    s_add_u32 s6, s6, 1024
    s_mov_b32 m0, s6
    s_nop 0
    buffer_load_dwordx4 v24, s[12:15], s5 offen lds
    s_add_u32 s5, s5, 28672
    s_add_u32 s6, s6, 1024
    s_mov_b32 m0, s6
    s_nop 0
    buffer_load_dwordx4 v25, s[12:15], s5 offen lds
    s_add_u32 s5, s5, 28672
    s_add_u32 s6, s6, 1024
    s_mov_b32 m0, s6
    s_nop 0
    buffer_load_dwordx4 v24, s[12:15], s5 offen lds
    s_add_u32 s5, s5, 28672
    s_add_u32 s6, s6, 1024
    s_mov_b32 m0, s6
    s_nop 0
    buffer_load_dwordx4 v25, s[12:15], s5 offen lds
    s_add_u32 s5, s5, 28672
    s_add_u32 s6, s6, 1024
    s_mov_b32 m0, s6
    s_nop 0
    buffer_load_dwordx4 v24, s[12:15], s5 offen lds
    s_add_u32 s5, s5, 28672
    s_add_u32 s6, s6, 1024
    s_mov_b32 m0, s6
    s_nop 0
    buffer_load_dwordx4 v25, s[12:15], s5 offen lds
    s_add_u32 s5, s5, 28672
    s_add_u32 s6, s6, 1024
    s_mov_b32 m0, s6
    s_nop 0
    buffer_load_dwordx4 v24, s[12:15], s5 offen lds
    s_add_u32 s5, s5, 28672
    s_add_u32 s6, s6, 1024
    s_mov_b32 m0, s6
    s_nop 0
    buffer_load_dwordx4 v25, s[12:15], s5 offen lds
    s_add_u32 s5, s5, 28672
    s_add_u32 s6, s6, 1024
    s_mov_b32 m0, s6
    s_nop 0
    buffer_load_dwordx4 v24, s[12:15], s5 offen lds
    s_add_u32 s5, s5, 28672
    s_add_u32 s6, s6, 1024
    s_mov_b32 m0, s6
    s_nop 0
    buffer_load_dwordx4 v25, s[12:15], s5 offen lds
    s_add_u32 s5, s5, 28672
    s_add_u32 s6, s6, 1024
    s_mov_b32 m0, s6
    s_nop 0
    buffer_load_dwordx4 v24, s[12:15], s5 offen lds
    s_add_u32 s5, s5, 28672
    s_add_u32 s6, s6, 1024
    s_mov_b32 m0, s6
    s_nop 0
    buffer_load_dwordx4 v25, s[12:15], s5 offen lds
    s_waitcnt vmcnt(0)
    v_xor_b32 v27, 0, v26
    ds_read_b64_tr_b16 a[32:33], v27 offset:0
    ds_read_b64_tr_b16 a[34:35], v27 offset:512
    ds_read_b64_tr_b16 a[36:37], v27 offset:4096
    ds_read_b64_tr_b16 a[38:39], v27 offset:4608
    ds_read_b64_tr_b16 a[40:41], v27 offset:8192
    ds_read_b64_tr_b16 a[42:43], v27 offset:8704
    ds_read_b64_tr_b16 a[44:45], v27 offset:12288
    ds_read_b64_tr_b16 a[46:47], v27 offset:12800
    s_waitcnt lgkmcnt(4)
    ds_read_b64_tr_b16 a[48:49], v27 offset:16384
    ds_read_b64_tr_b16 a[50:51], v27 offset:16896
    ds_read_b64_tr_b16 a[52:53], v27 offset:20480
    ds_read_b64_tr_b16 a[54:55], v27 offset:20992
    ds_read_b64_tr_b16 a[56:57], v27 offset:24576
    ds_read_b64_tr_b16 a[58:59], v27 offset:25088
    ds_read_b64_tr_b16 a[60:61], v27 offset:28672
    ds_read_b64_tr_b16 a[62:63], v27 offset:29184
    s_waitcnt lgkmcnt(4)
    v_xor_b32 v27, 32, v26
    ds_read_b64_tr_b16 a[96:97], v27 offset:0
    ds_read_b64_tr_b16 a[98:99], v27 offset:512
    ds_read_b64_tr_b16 a[100:101], v27 offset:4096
    ds_read_b64_tr_b16 a[102:103], v27 offset:4608
    ds_read_b64_tr_b16 a[104:105], v27 offset:8192
    ds_read_b64_tr_b16 a[106:107], v27 offset:8704
    ds_read_b64_tr_b16 a[108:109], v27 offset:12288
    ds_read_b64_tr_b16 a[110:111], v27 offset:12800
    s_waitcnt lgkmcnt(4)
    ds_read_b64_tr_b16 a[112:113], v27 offset:16384
    ds_read_b64_tr_b16 a[114:115], v27 offset:16896
    ds_read_b64_tr_b16 a[116:117], v27 offset:20480
    ds_read_b64_tr_b16 a[118:119], v27 offset:20992
    ds_read_b64_tr_b16 a[120:121], v27 offset:24576
    ds_read_b64_tr_b16 a[122:123], v27 offset:25088
    ds_read_b64_tr_b16 a[124:125], v27 offset:28672
    ds_read_b64_tr_b16 a[126:127], v27 offset:29184
    s_waitcnt lgkmcnt(4)
    v_xor_b32 v27, 64, v26
    ds_read_b64_tr_b16 a[160:161], v27 offset:0
    ds_read_b64_tr_b16 a[162:163], v27 offset:512
    ds_read_b64_tr_b16 a[164:165], v27 offset:4096
    ds_read_b64_tr_b16 a[166:167], v27 offset:4608
    ds_read_b64_tr_b16 a[168:169], v27 offset:8192
    ds_read_b64_tr_b16 a[170:171], v27 offset:8704
    ds_read_b64_tr_b16 a[172:173], v27 offset:12288
    ds_read_b64_tr_b16 a[174:175], v27 offset:12800
    s_waitcnt lgkmcnt(4)
    ds_read_b64_tr_b16 a[176:177], v27 offset:16384
    ds_read_b64_tr_b16 a[178:179], v27 offset:16896
    ds_read_b64_tr_b16 a[180:181], v27 offset:20480
    ds_read_b64_tr_b16 a[182:183], v27 offset:20992
    ds_read_b64_tr_b16 a[184:185], v27 offset:24576
    ds_read_b64_tr_b16 a[186:187], v27 offset:25088
    ds_read_b64_tr_b16 a[188:189], v27 offset:28672
    ds_read_b64_tr_b16 a[190:191], v27 offset:29184
    s_waitcnt lgkmcnt(4)
    v_xor_b32 v27, 96, v26
    ds_read_b64_tr_b16 a[224:225], v27 offset:0
    ds_read_b64_tr_b16 a[226:227], v27 offset:512
    ds_read_b64_tr_b16 a[228:229], v27 offset:4096
    ds_read_b64_tr_b16 a[230:231], v27 offset:4608
    ds_read_b64_tr_b16 a[232:233], v27 offset:8192
    ds_read_b64_tr_b16 a[234:235], v27 offset:8704
    ds_read_b64_tr_b16 a[236:237], v27 offset:12288
    ds_read_b64_tr_b16 a[238:239], v27 offset:12800
    s_waitcnt lgkmcnt(4)
    ds_read_b64_tr_b16 a[240:241], v27 offset:16384
    ds_read_b64_tr_b16 a[242:243], v27 offset:16896
    ds_read_b64_tr_b16 a[244:245], v27 offset:20480
    ds_read_b64_tr_b16 a[246:247], v27 offset:20992
    ds_read_b64_tr_b16 a[248:249], v27 offset:24576
    ds_read_b64_tr_b16 a[250:251], v27 offset:25088
    ds_read_b64_tr_b16 a[252:253], v27 offset:28672
    ds_read_b64_tr_b16 a[254:255], v27 offset:29184
    s_waitcnt lgkmcnt(4)
    s_waitcnt lgkmcnt(0)
    s_barrier
    s_cmp_lg_u32 s4, 0
    s_cbranch_scc1 dbw_21_x
    s_mov_b32 s70, 0
dbw_21:
    buffer_load_dword v40, off, s[64:67], 0 offset:64 sc1
    s_add_u32 s70, s70, 1
    s_cmp_gt_u32 s70, 0x10000
    s_cbranch_scc1 dbw_21_y
    s_waitcnt vmcnt(0)
    v_readfirstlane_b32 s71, v40
    s_nop 0
    s_cmp_ge_u32 s71, 128
    s_cbranch_scc1 dbw_21_x
    s_sleep 8
    s_branch dbw_21
dbw_21_y:
    s_waitcnt vmcnt(0)
dbw_21_x:
    s_barrier
    s_mov_b32 s30, 0
    s_mov_b32 s17, 0
    s_mov_b32 s18, s16
    s_mov_b32 s20, 0
    s_lshl_b32 s5, s18, 15
    s_lshl_b32 s6, s4, 13
    s_add_u32 s5, s5, s6
    s_add_u32 s5, s5, 1048576
    s_add_u32 s6, s6, s20
    s_mov_b32 m0, s6
    s_nop 0
    buffer_load_dwordx4 v1, s[8:11], s5 offen offset:0 sc1 lds
    buffer_load_dwordx4 v1, s[8:11], s5 offen offset:1024 sc1 lds
    buffer_load_dwordx4 v1, s[8:11], s5 offen offset:2048 sc1 lds
    buffer_load_dwordx4 v1, s[8:11], s5 offen offset:3072 sc1 lds
    s_add_u32 s5, s5, 4096
    s_add_u32 s6, s6, 4096
    s_mov_b32 m0, s6
    s_nop 0
    buffer_load_dwordx4 v1, s[8:11], s5 offen offset:0 sc1 lds
    buffer_load_dwordx4 v1, s[8:11], s5 offen offset:1024 sc1 lds
    buffer_load_dwordx4 v1, s[8:11], s5 offen offset:2048 sc1 lds
    buffer_load_dwordx4 v1, s[8:11], s5 offen offset:3072 sc1 lds
f1_loop:
    s_add_u32 s22, s18, 2
    s_xor_b32 s23, s20, 32768
    s_cmp_lt_u32 s22, 64
    s_cbranch_scc0 f1_nopf
    s_lshl_b32 s5, s22, 15
    s_lshl_b32 s6, s4, 13
    s_add_u32 s5, s5, s6
    s_add_u32 s5, s5, 1048576
    s_add_u32 s6, s6, s23
    s_mov_b32 m0, s6
    s_nop 0
    buffer_load_dwordx4 v1, s[8:11], s5 offen offset:0 sc1 lds
    buffer_load_dwordx4 v1, s[8:11], s5 offen offset:1024 sc1 lds
    buffer_load_dwordx4 v1, s[8:11], s5 offen offset:2048 sc1 lds
    buffer_load_dwordx4 v1, s[8:11], s5 offen offset:3072 sc1 lds
    s_add_u32 s5, s5, 4096
    s_add_u32 s6, s6, 4096
    s_mov_b32 m0, s6
    s_nop 0
    buffer_load_dwordx4 v1, s[8:11], s5 offen offset:0 sc1 lds
    buffer_load_dwordx4 v1, s[8:11], s5 offen offset:1024 sc1 lds
    buffer_load_dwordx4 v1, s[8:11], s5 offen offset:2048 sc1 lds
    buffer_load_dwordx4 v1, s[8:11], s5 offen offset:3072 sc1 lds
    s_waitcnt vmcnt(8)
    s_branch f1_pf_done
f1_nopf:
    s_waitcnt vmcnt(0)
f1_pf_done:
    s_barrier
    v_add_u32 v4, s20, v1
    ds_read_b128 v[72:75], v4 offset:0
    ds_read_b128 v[76:79], v4 offset:16384
    ds_read_b128 v[80:83], v4 offset:1024
    ds_read_b128 v[84:87], v4 offset:17408
    s_waitcnt lgkmcnt(2)
    v_mfma_f32_16x16x32_bf16 v[24:27], a[0:3], v[72:75], v[8:11]
    v_mfma_f32_16x16x32_bf16 v[28:31], a[0:3], v[76:79], v[8:11]
    v_mfma_f32_16x16x32_bf16 v[32:35], a[64:67], v[72:75], v[12:15]
    v_mfma_f32_16x16x32_bf16 v[36:39], a[64:67], v[76:79], v[12:15]
    v_mfma_f32_16x16x32_bf16 v[40:43], a[128:131], v[72:75], v[16:19]
    v_mfma_f32_16x16x32_bf16 v[44:47], a[128:131], v[76:79], v[16:19]
    v_mfma_f32_16x16x32_bf16 v[48:51], a[192:195], v[72:75], v[20:23]
    v_mfma_f32_16x16x32_bf16 v[52:55], a[192:195], v[76:79], v[20:23]
    ds_read_b128 v[72:75], v4 offset:2048
    ds_read_b128 v[76:79], v4 offset:18432
    s_waitcnt lgkmcnt(2)
    v_mfma_f32_16x16x32_bf16 v[24:27], a[4:7], v[80:83], v[24:27]
    v_mfma_f32_16x16x32_bf16 v[28:31], a[4:7], v[84:87], v[28:31]
    v_mfma_f32_16x16x32_bf16 v[32:35], a[68:71], v[80:83], v[32:35]
    v_mfma_f32_16x16x32_bf16 v[36:39], a[68:71], v[84:87], v[36:39]
    v_mfma_f32_16x16x32_bf16 v[40:43], a[132:135], v[80:83], v[40:43]
    v_mfma_f32_16x16x32_bf16 v[44:47], a[132:135], v[84:87], v[44:47]
    v_mfma_f32_16x16x32_bf16 v[48:51], a[196:199], v[80:83], v[48:51]
    v_mfma_f32_16x16x32_bf16 v[52:55], a[196:199], v[84:87], v[52:55]
    ds_read_b128 v[80:83], v4 offset:3072
    ds_read_b128 v[84:87], v4 offset:19456
    s_waitcnt lgkmcnt(2)
    v_mfma_f32_16x16x32_bf16 v[24:27], a[8:11], v[72:75], v[24:27]
    v_mfma_f32_16x16x32_bf16 v[28:31], a[8:11], v[76:79], v[28:31]
    v_mfma_f32_16x16x32_bf16 v[32:35], a[72:75], v[72:75], v[32:35]
    v_mfma_f32_16x16x32_bf16 v[36:39], a[72:75], v[76:79], v[36:39]
    v_mfma_f32_16x16x32_bf16 v[40:43], a[136:139], v[72:75], v[40:43]
    v_mfma_f32_16x16x32_bf16 v[44:47], a[136:139], v[76:79], v[44:47]
    v_mfma_f32_16x16x32_bf16 v[48:51], a[200:203], v[72:75], v[48:51]
    v_mfma_f32_16x16x32_bf16 v[52:55], a[200:203], v[76:79], v[52:55]
    ds_read_b128 v[72:75], v4 offset:4096
    ds_read_b128 v[76:79], v4 offset:20480
    s_waitcnt lgkmcnt(2)
    v_mfma_f32_16x16x32_bf16 v[24:27], a[12:15], v[80:83], v[24:27]
    v_mfma_f32_16x16x32_bf16 v[28:31], a[12:15], v[84:87], v[28:31]
    v_mfma_f32_16x16x32_bf16 v[32:35], a[76:79], v[80:83], v[32:35]
    v_mfma_f32_16x16x32_bf16 v[36:39], a[76:79], v[84:87], v[36:39]
    v_mfma_f32_16x16x32_bf16 v[40:43], a[140:143], v[80:83], v[40:43]
    v_mfma_f32_16x16x32_bf16 v[44:47], a[140:143], v[84:87], v[44:47]
    v_mfma_f32_16x16x32_bf16 v[48:51], a[204:207], v[80:83], v[48:51]
    v_mfma_f32_16x16x32_bf16 v[52:55], a[204:207], v[84:87], v[52:55]
    ds_read_b128 v[80:83], v4 offset:5120
    ds_read_b128 v[84:87], v4 offset:21504
    s_waitcnt lgkmcnt(2)
    v_mfma_f32_16x16x32_bf16 v[24:27], a[16:19], v[72:75], v[24:27]
    v_mfma_f32_16x16x32_bf16 v[28:31], a[16:19], v[76:79], v[28:31]
    v_mfma_f32_16x16x32_bf16 v[32:35], a[80:83], v[72:75], v[32:35]
    v_mfma_f32_16x16x32_bf16 v[36:39], a[80:83], v[76:79], v[36:39]
    v_mfma_f32_16x16x32_bf16 v[40:43], a[144:147], v[72:75], v[40:43]
    v_mfma_f32_16x16x32_bf16 v[44:47], a[144:147], v[76:79], v[44:47]
    v_mfma_f32_16x16x32_bf16 v[48:51], a[208:211], v[72:75], v[48:51]
    v_mfma_f32_16x16x32_bf16 v[52:55], a[208:211], v[76:79], v[52:55]
    ds_read_b128 v[72:75], v4 offset:6144
    ds_read_b128 v[76:79], v4 offset:22528
    s_waitcnt lgkmcnt(2)
    v_mfma_f32_16x16x32_bf16 v[24:27], a[20:23], v[80:83], v[24:27]
    v_mfma_f32_16x16x32_bf16 v[28:31], a[20:23], v[84:87], v[28:31]
    v_mfma_f32_16x16x32_bf16 v[32:35], a[84:87], v[80:83], v[32:35]
    v_mfma_f32_16x16x32_bf16 v[36:39], a[84:87], v[84:87], v[36:39]
    v_mfma_f32_16x16x32_bf16 v[40:43], a[148:151], v[80:83], v[40:43]
    v_mfma_f32_16x16x32_bf16 v[44:47], a[148:151], v[84:87], v[44:47]
    v_mfma_f32_16x16x32_bf16 v[48:51], a[212:215], v[80:83], v[48:51]
    v_mfma_f32_16x16x32_bf16 v[52:55], a[212:215], v[84:87], v[52:55]
    ds_read_b128 v[80:83], v4 offset:7168
    ds_read_b128 v[84:87], v4 offset:23552
    s_waitcnt lgkmcnt(2)
    v_mfma_f32_16x16x32_bf16 v[24:27], a[24:27], v[72:75], v[24:27]
    v_mfma_f32_16x16x32_bf16 v[28:31], a[24:27], v[76:79], v[28:31]
    v_mfma_f32_16x16x32_bf16 v[32:35], a[88:91], v[72:75], v[32:35]
    v_mfma_f32_16x16x32_bf16 v[36:39], a[88:91], v[76:79], v[36:39]
    v_mfma_f32_16x16x32_bf16 v[40:43], a[152:155], v[72:75], v[40:43]
    v_mfma_f32_16x16x32_bf16 v[44:47], a[152:155], v[76:79], v[44:47]
    v_mfma_f32_16x16x32_bf16 v[48:51], a[216:219], v[72:75], v[48:51]
    v_mfma_f32_16x16x32_bf16 v[52:55], a[216:219], v[76:79], v[52:55]
    ds_read_b128 v[72:75], v4 offset:8192
    ds_read_b128 v[76:79], v4 offset:24576
    s_waitcnt lgkmcnt(2)
    v_mfma_f32_16x16x32_bf16 v[24:27], a[28:31], v[80:83], v[24:27]
    v_mfma_f32_16x16x32_bf16 v[28:31], a[28:31], v[84:87], v[28:31]
    v_mfma_f32_16x16x32_bf16 v[32:35], a[92:95], v[80:83], v[32:35]
    v_mfma_f32_16x16x32_bf16 v[36:39], a[92:95], v[84:87], v[36:39]
    v_mfma_f32_16x16x32_bf16 v[40:43], a[156:159], v[80:83], v[40:43]
    v_mfma_f32_16x16x32_bf16 v[44:47], a[156:159], v[84:87], v[44:47]
    v_mfma_f32_16x16x32_bf16 v[48:51], a[220:223], v[80:83], v[48:51]
    v_mfma_f32_16x16x32_bf16 v[52:55], a[220:223], v[84:87], v[52:55]
    ds_read_b128 v[80:83], v4 offset:9216
    ds_read_b128 v[84:87], v4 offset:25600
    s_waitcnt lgkmcnt(2)
    v_mfma_f32_16x16x32_bf16 v[24:27], a[32:35], v[72:75], v[24:27]
    v_mfma_f32_16x16x32_bf16 v[28:31], a[32:35], v[76:79], v[28:31]
    v_mfma_f32_16x16x32_bf16 v[32:35], a[96:99], v[72:75], v[32:35]
    v_mfma_f32_16x16x32_bf16 v[36:39], a[96:99], v[76:79], v[36:39]
    v_mfma_f32_16x16x32_bf16 v[40:43], a[160:163], v[72:75], v[40:43]
    v_mfma_f32_16x16x32_bf16 v[44:47], a[160:163], v[76:79], v[44:47]
    v_mfma_f32_16x16x32_bf16 v[48:51], a[224:227], v[72:75], v[48:51]
    v_mfma_f32_16x16x32_bf16 v[52:55], a[224:227], v[76:79], v[52:55]
    ds_read_b128 v[72:75], v4 offset:10240
    ds_read_b128 v[76:79], v4 offset:26624
    s_waitcnt lgkmcnt(2)
    v_mfma_f32_16x16x32_bf16 v[24:27], a[36:39], v[80:83], v[24:27]
    v_mfma_f32_16x16x32_bf16 v[28:31], a[36:39], v[84:87], v[28:31]
    v_mfma_f32_16x16x32_bf16 v[32:35], a[100:103], v[80:83], v[32:35]
    v_mfma_f32_16x16x32_bf16 v[36:39], a[100:103], v[84:87], v[36:39]
    v_mfma_f32_16x16x32_bf16 v[40:43], a[164:167], v[80:83], v[40:43]
    v_mfma_f32_16x16x32_bf16 v[44:47], a[164:167], v[84:87], v[44:47]
    v_mfma_f32_16x16x32_bf16 v[48:51], a[228:231], v[80:83], v[48:51]
    v_mfma_f32_16x16x32_bf16 v[52:55], a[228:231], v[84:87], v[52:55]
    ds_read_b128 v[80:83], v4 offset:11264
    ds_read_b128 v[84:87], v4 offset:27648
    s_waitcnt lgkmcnt(2)
    v_mfma_f32_16x16x32_bf16 v[24:27], a[40:43], v[72:75], v[24:27]
    v_mfma_f32_16x16x32_bf16 v[28:31], a[40:43], v[76:79], v[28:31]
    v_mfma_f32_16x16x32_bf16 v[32:35], a[104:107], v[72:75], v[32:35]
    v_mfma_f32_16x16x32_bf16 v[36:39], a[104:107], v[76:79], v[36:39]
    v_mfma_f32_16x16x32_bf16 v[40:43], a[168:171], v[72:75], v[40:43]
    v_mfma_f32_16x16x32_bf16 v[44:47], a[168:171], v[76:79], v[44:47]
    v_mfma_f32_16x16x32_bf16 v[48:51], a[232:235], v[72:75], v[48:51]
    v_mfma_f32_16x16x32_bf16 v[52:55], a[232:235], v[76:79], v[52:55]
    ds_read_b128 v[72:75], v4 offset:12288
    ds_read_b128 v[76:79], v4 offset:28672
    s_waitcnt lgkmcnt(2)
    v_mfma_f32_16x16x32_bf16 v[24:27], a[44:47], v[80:83], v[24:27]
    v_mfma_f32_16x16x32_bf16 v[28:31], a[44:47], v[84:87], v[28:31]
    v_mfma_f32_16x16x32_bf16 v[32:35], a[108:111], v[80:83], v[32:35]
    v_mfma_f32_16x16x32_bf16 v[36:39], a[108:111], v[84:87], v[36:39]
    v_mfma_f32_16x16x32_bf16 v[40:43], a[172:175], v[80:83], v[40:43]
    v_mfma_f32_16x16x32_bf16 v[44:47], a[172:175], v[84:87], v[44:47]
    v_mfma_f32_16x16x32_bf16 v[48:51], a[236:239], v[80:83], v[48:51]
    v_mfma_f32_16x16x32_bf16 v[52:55], a[236:239], v[84:87], v[52:55]
    ds_read_b128 v[80:83], v4 offset:13312
    ds_read_b128 v[84:87], v4 offset:29696
    s_waitcnt lgkmcnt(2)
    v_mfma_f32_16x16x32_bf16 v[24:27], a[48:51], v[72:75], v[24:27]
    v_mfma_f32_16x16x32_bf16 v[28:31], a[48:51], v[76:79], v[28:31]
    v_mfma_f32_16x16x32_bf16 v[32:35], a[112:115], v[72:75], v[32:35]
    v_mfma_f32_16x16x32_bf16 v[36:39], a[112:115], v[76:79], v[36:39]
    v_mfma_f32_16x16x32_bf16 v[40:43], a[176:179], v[72:75], v[40:43]
    v_mfma_f32_16x16x32_bf16 v[44:47], a[176:179], v[76:79], v[44:47]
    v_mfma_f32_16x16x32_bf16 v[48:51], a[240:243], v[72:75], v[48:51]
    v_mfma_f32_16x16x32_bf16 v[52:55], a[240:243], v[76:79], v[52:55]
    ds_read_b128 v[72:75], v4 offset:14336
    ds_read_b128 v[76:79], v4 offset:30720
    s_waitcnt lgkmcnt(2)
    v_mfma_f32_16x16x32_bf16 v[24:27], a[52:55], v[80:83], v[24:27]
    v_mfma_f32_16x16x32_bf16 v[28:31], a[52:55], v[84:87], v[28:31]
    v_mfma_f32_16x16x32_bf16 v[32:35], a[116:119], v[80:83], v[32:35]
    v_mfma_f32_16x16x32_bf16 v[36:39], a[116:119], v[84:87], v[36:39]
    v_mfma_f32_16x16x32_bf16 v[40:43], a[180:183], v[80:83], v[40:43]
    v_mfma_f32_16x16x32_bf16 v[44:47], a[180:183], v[84:87], v[44:47]
    v_mfma_f32_16x16x32_bf16 v[48:51], a[244:247], v[80:83], v[48:51]
    v_mfma_f32_16x16x32_bf16 v[52:55], a[244:247], v[84:87], v[52:55]
    ds_read_b128 v[80:83], v4 offset:15360
    ds_read_b128 v[84:87], v4 offset:31744
    s_waitcnt lgkmcnt(2)
    v_mfma_f32_16x16x32_bf16 v[24:27], a[56:59], v[72:75], v[24:27]
    v_mfma_f32_16x16x32_bf16 v[28:31], a[56:59], v[76:79], v[28:31]
    v_mfma_f32_16x16x32_bf16 v[32:35], a[120:123], v[72:75], v[32:35]
    v_mfma_f32_16x16x32_bf16 v[36:39], a[120:123], v[76:79], v[36:39]
    v_mfma_f32_16x16x32_bf16 v[40:43], a[184:187], v[72:75], v[40:43]
    v_mfma_f32_16x16x32_bf16 v[44:47], a[184:187], v[76:79], v[44:47]
    v_mfma_f32_16x16x32_bf16 v[48:51], a[248:251], v[72:75], v[48:51]
    v_mfma_f32_16x16x32_bf16 v[52:55], a[248:251], v[76:79], v[52:55]
    s_waitcnt lgkmcnt(0)
    v_mfma_f32_16x16x32_bf16 v[24:27], a[60:63], v[80:83], v[24:27]
    v_mfma_f32_16x16x32_bf16 v[28:31], a[60:63], v[84:87], v[28:31]
    v_mfma_f32_16x16x32_bf16 v[32:35], a[124:127], v[80:83], v[32:35]
    v_mfma_f32_16x16x32_bf16 v[36:39], a[124:127], v[84:87], v[36:39]
    v_mfma_f32_16x16x32_bf16 v[40:43], a[188:191], v[80:83], v[40:43]
    v_mfma_f32_16x16x32_bf16 v[44:47], a[188:191], v[84:87], v[44:47]
    v_mfma_f32_16x16x32_bf16 v[48:51], a[252:255], v[80:83], v[48:51]
    v_mfma_f32_16x16x32_bf16 v[52:55], a[252:255], v[84:87], v[52:55]
    s_mov_b32 s24, 0xbfb8aa3b
    v_cvt_pk_bf16_f32 v88, v24, v25
    v_cvt_pk_bf16_f32 v89, v26, v27
    v_lshlrev_b32 v24, 16, v88
    v_and_b32 v25, 0xffff0000, v88
    v_lshlrev_b32 v26, 16, v89
    v_and_b32 v27, 0xffff0000, v89
    v_mul_f32 v88, s24, abs(v24)
    v_mul_f32 v89, s24, abs(v25)
    v_mul_f32 v90, s24, abs(v26)
    v_mul_f32 v91, s24, abs(v27)
    v_exp_f32 v88, v88
    v_exp_f32 v89, v89
    v_exp_f32 v90, v90
    v_exp_f32 v91, v91
    v_mul_f32 v92, v88, v88
    v_mul_f32 v93, v89, v89
    v_mul_f32 v94, v90, v90
    v_mul_f32 v95, v91, v91
    v_cmp_le_f32 vcc, 0, v24
    s_nop 1
    v_cndmask_b32 v96, v92, 1.0, vcc
    v_cndmask_b32 v100, 1.0, v92, vcc
    v_cmp_le_f32 vcc, 0, v25
    s_nop 1
    v_cndmask_b32 v97, v93, 1.0, vcc
    v_cndmask_b32 v101, 1.0, v93, vcc
    v_cmp_le_f32 vcc, 0, v26
    s_nop 1
    v_cndmask_b32 v98, v94, 1.0, vcc
    v_cndmask_b32 v102, 1.0, v94, vcc
    v_cmp_le_f32 vcc, 0, v27
    s_nop 1
    v_cndmask_b32 v99, v95, 1.0, vcc
    v_cndmask_b32 v103, 1.0, v95, vcc
    v_fma_f32 v96, v88, 2.0, v96
    v_fma_f32 v97, v89, 2.0, v97
    v_fma_f32 v98, v90, 2.0, v98
    v_fma_f32 v99, v91, 2.0, v99
    v_fma_f32 v100, v100, 2.0, v96
    v_fma_f32 v101, v101, 2.0, v97
    v_fma_f32 v102, v102, 2.0, v98
    v_fma_f32 v103, v103, 2.0, v99
    v_rcp_f32 v100, v100
    v_rcp_f32 v101, v101
    v_rcp_f32 v102, v102
    v_rcp_f32 v103, v103
    v_mul_f32 v96, v96, v24
    v_mul_f32 v97, v97, v25
    v_mul_f32 v98, v98, v26
    v_mul_f32 v99, v99, v27
    v_mul_f32 v24, v96, v100
    v_mul_f32 v25, v97, v101
    v_mul_f32 v26, v98, v102
    v_mul_f32 v27, v99, v103
    v_cvt_pk_bf16_f32 v88, v28, v29
    v_cvt_pk_bf16_f32 v89, v30, v31
    v_lshlrev_b32 v28, 16, v88
    v_and_b32 v29, 0xffff0000, v88
    v_lshlrev_b32 v30, 16, v89
    v_and_b32 v31, 0xffff0000, v89
    v_mul_f32 v88, s24, abs(v28)
    v_mul_f32 v89, s24, abs(v29)
    v_mul_f32 v90, s24, abs(v30)
    v_mul_f32 v91, s24, abs(v31)
    v_exp_f32 v88, v88
    v_exp_f32 v89, v89
    v_exp_f32 v90, v90
    v_exp_f32 v91, v91
    v_mul_f32 v92, v88, v88
    v_mul_f32 v93, v89, v89
    v_mul_f32 v94, v90, v90
    v_mul_f32 v95, v91, v91
    v_cmp_le_f32 vcc, 0, v28
    s_nop 1
    v_cndmask_b32 v96, v92, 1.0, vcc
    v_cndmask_b32 v100, 1.0, v92, vcc
    v_cmp_le_f32 vcc, 0, v29
    s_nop 1
    v_cndmask_b32 v97, v93, 1.0, vcc
    v_cndmask_b32 v101, 1.0, v93, vcc
    v_cmp_le_f32 vcc, 0, v30
    s_nop 1
    v_cndmask_b32 v98, v94, 1.0, vcc
    v_cndmask_b32 v102, 1.0, v94, vcc
    v_cmp_le_f32 vcc, 0, v31
    s_nop 1
    v_cndmask_b32 v99, v95, 1.0, vcc
    v_cndmask_b32 v103, 1.0, v95, vcc
    v_fma_f32 v96, v88, 2.0, v96
    v_fma_f32 v97, v89, 2.0, v97
    v_fma_f32 v98, v90, 2.0, v98
    v_fma_f32 v99, v91, 2.0, v99
    v_fma_f32 v100, v100, 2.0, v96
    v_fma_f32 v101, v101, 2.0, v97
    v_fma_f32 v102, v102, 2.0, v98
    v_fma_f32 v103, v103, 2.0, v99
    v_rcp_f32 v100, v100
    v_rcp_f32 v101, v101
    v_rcp_f32 v102, v102
    v_rcp_f32 v103, v103
    v_mul_f32 v96, v96, v28
    v_mul_f32 v97, v97, v29
    v_mul_f32 v98, v98, v30
    v_mul_f32 v99, v99, v31
    v_mul_f32 v28, v96, v100
    v_mul_f32 v29, v97, v101
    v_mul_f32 v30, v98, v102
    v_mul_f32 v31, v99, v103
    v_cvt_pk_bf16_f32 v88, v32, v33
    v_cvt_pk_bf16_f32 v89, v34, v35
    v_lshlrev_b32 v32, 16, v88
    v_and_b32 v33, 0xffff0000, v88
    v_lshlrev_b32 v34, 16, v89
    v_and_b32 v35, 0xffff0000, v89
    v_mul_f32 v88, s24, abs(v32)
    v_mul_f32 v89, s24, abs(v33)
    v_mul_f32 v90, s24, abs(v34)
    v_mul_f32 v91, s24, abs(v35)
    v_exp_f32 v88, v88
    v_exp_f32 v89, v89
    v_exp_f32 v90, v90
    v_exp_f32 v91, v91
    v_mul_f32 v92, v88, v88
    v_mul_f32 v93, v89, v89
    v_mul_f32 v94, v90, v90
    v_mul_f32 v95, v91, v91
    v_cmp_le_f32 vcc, 0, v32
    s_nop 1
    v_cndmask_b32 v96, v92, 1.0, vcc
    v_cndmask_b32 v100, 1.0, v92, vcc
    v_cmp_le_f32 vcc, 0, v33
    s_nop 1
    v_cndmask_b32 v97, v93, 1.0, vcc
    v_cndmask_b32 v101, 1.0, v93, vcc
    v_cmp_le_f32 vcc, 0, v34
    s_nop 1
    v_cndmask_b32 v98, v94, 1.0, vcc
    v_cndmask_b32 v102, 1.0, v94, vcc
    v_cmp_le_f32 vcc, 0, v35
    s_nop 1
    v_cndmask_b32 v99, v95, 1.0, vcc
    v_cndmask_b32 v103, 1.0, v95, vcc
    v_fma_f32 v96, v88, 2.0, v96
    v_fma_f32 v97, v89, 2.0, v97
    v_fma_f32 v98, v90, 2.0, v98
    v_fma_f32 v99, v91, 2.0, v99
    v_fma_f32 v100, v100, 2.0, v96
    v_fma_f32 v101, v101, 2.0, v97
    v_fma_f32 v102, v102, 2.0, v98
    v_fma_f32 v103, v103, 2.0, v99
    v_rcp_f32 v100, v100
    v_rcp_f32 v101, v101
    v_rcp_f32 v102, v102
    v_rcp_f32 v103, v103
    v_mul_f32 v96, v96, v32
    v_mul_f32 v97, v97, v33
    v_mul_f32 v98, v98, v34
    v_mul_f32 v99, v99, v35
    v_mul_f32 v32, v96, v100
    v_mul_f32 v33, v97, v101
    v_mul_f32 v34, v98, v102
    v_mul_f32 v35, v99, v103
    v_cvt_pk_bf16_f32 v88, v36, v37
    v_cvt_pk_bf16_f32 v89, v38, v39
    v_lshlrev_b32 v36, 16, v88
    v_and_b32 v37, 0xffff0000, v88
    v_lshlrev_b32 v38, 16, v89
    v_and_b32 v39, 0xffff0000, v89
    v_mul_f32 v88, s24, abs(v36)
    v_mul_f32 v89, s24, abs(v37)
    v_mul_f32 v90, s24, abs(v38)
    v_mul_f32 v91, s24, abs(v39)
    v_exp_f32 v88, v88
    v_exp_f32 v89, v89
    v_exp_f32 v90, v90
    v_exp_f32 v91, v91
    v_mul_f32 v92, v88, v88
    v_mul_f32 v93, v89, v89
    v_mul_f32 v94, v90, v90
    v_mul_f32 v95, v91, v91
    v_cmp_le_f32 vcc, 0, v36
    s_nop 1
    v_cndmask_b32 v96, v92, 1.0, vcc
    v_cndmask_b32 v100, 1.0, v92, vcc
    v_cmp_le_f32 vcc, 0, v37
    s_nop 1
    v_cndmask_b32 v97, v93, 1.0, vcc
    v_cndmask_b32 v101, 1.0, v93, vcc
    v_cmp_le_f32 vcc, 0, v38
    s_nop 1
    v_cndmask_b32 v98, v94, 1.0, vcc
    v_cndmask_b32 v102, 1.0, v94, vcc
    v_cmp_le_f32 vcc, 0, v39
    s_nop 1
    v_cndmask_b32 v99, v95, 1.0, vcc
    v_cndmask_b32 v103, 1.0, v95, vcc
    v_fma_f32 v96, v88, 2.0, v96
    v_fma_f32 v97, v89, 2.0, v97
    v_fma_f32 v98, v90, 2.0, v98
    v_fma_f32 v99, v91, 2.0, v99
    v_fma_f32 v100, v100, 2.0, v96
    v_fma_f32 v101, v101, 2.0, v97
    v_fma_f32 v102, v102, 2.0, v98
    v_fma_f32 v103, v103, 2.0, v99
    v_rcp_f32 v100, v100
    v_rcp_f32 v101, v101
    v_rcp_f32 v102, v102
    v_rcp_f32 v103, v103
    v_mul_f32 v96, v96, v36
    v_mul_f32 v97, v97, v37
    v_mul_f32 v98, v98, v38
    v_mul_f32 v99, v99, v39
    v_mul_f32 v36, v96, v100
    v_mul_f32 v37, v97, v101
    v_mul_f32 v38, v98, v102
    v_mul_f32 v39, v99, v103
    v_cvt_pk_bf16_f32 v88, v40, v41
    v_cvt_pk_bf16_f32 v89, v42, v43
    v_lshlrev_b32 v40, 16, v88
    v_and_b32 v41, 0xffff0000, v88
    v_lshlrev_b32 v42, 16, v89
    v_and_b32 v43, 0xffff0000, v89
    v_mul_f32 v88, s24, abs(v40)
    v_mul_f32 v89, s24, abs(v41)
    v_mul_f32 v90, s24, abs(v42)
    v_mul_f32 v91, s24, abs(v43)
    v_exp_f32 v88, v88
    v_exp_f32 v89, v89
    v_exp_f32 v90, v90
    v_exp_f32 v91, v91
    v_mul_f32 v92, v88, v88
    v_mul_f32 v93, v89, v89
    v_mul_f32 v94, v90, v90
    v_mul_f32 v95, v91, v91
    v_cmp_le_f32 vcc, 0, v40
    s_nop 1
    v_cndmask_b32 v96, v92, 1.0, vcc
    v_cndmask_b32 v100, 1.0, v92, vcc
    v_cmp_le_f32 vcc, 0, v41
    s_nop 1
    v_cndmask_b32 v97, v93, 1.0, vcc
    v_cndmask_b32 v101, 1.0, v93, vcc
    v_cmp_le_f32 vcc, 0, v42
    s_nop 1
    v_cndmask_b32 v98, v94, 1.0, vcc
    v_cndmask_b32 v102, 1.0, v94, vcc
    v_cmp_le_f32 vcc, 0, v43
    s_nop 1
    v_cndmask_b32 v99, v95, 1.0, vcc
    v_cndmask_b32 v103, 1.0, v95, vcc
    v_fma_f32 v96, v88, 2.0, v96
    v_fma_f32 v97, v89, 2.0, v97
    v_fma_f32 v98, v90, 2.0, v98
    v_fma_f32 v99, v91, 2.0, v99
    v_fma_f32 v100, v100, 2.0, v96
    v_fma_f32 v101, v101, 2.0, v97
    v_fma_f32 v102, v102, 2.0, v98
    v_fma_f32 v103, v103, 2.0, v99
    v_rcp_f32 v100, v100
    v_rcp_f32 v101, v101
    v_rcp_f32 v102, v102
    v_rcp_f32 v103, v103
    v_mul_f32 v96, v96, v40
    v_mul_f32 v97, v97, v41
    v_mul_f32 v98, v98, v42
    v_mul_f32 v99, v99, v43
    v_mul_f32 v40, v96, v100
    v_mul_f32 v41, v97, v101
    v_mul_f32 v42, v98, v102
    v_mul_f32 v43, v99, v103
    v_cvt_pk_bf16_f32 v88, v44, v45
    v_cvt_pk_bf16_f32 v89, v46, v47
    v_lshlrev_b32 v44, 16, v88
    v_and_b32 v45, 0xffff0000, v88
    v_lshlrev_b32 v46, 16, v89
    v_and_b32 v47, 0xffff0000, v89
    v_mul_f32 v88, s24, abs(v44)
    v_mul_f32 v89, s24, abs(v45)
    v_mul_f32 v90, s24, abs(v46)
    v_mul_f32 v91, s24, abs(v47)
    v_exp_f32 v88, v88
    v_exp_f32 v89, v89
    v_exp_f32 v90, v90
    v_exp_f32 v91, v91
    v_mul_f32 v92, v88, v88
    v_mul_f32 v93, v89, v89
    v_mul_f32 v94, v90, v90
    v_mul_f32 v95, v91, v91
    v_cmp_le_f32 vcc, 0, v44
    s_nop 1
    v_cndmask_b32 v96, v92, 1.0, vcc
    v_cndmask_b32 v100, 1.0, v92, vcc
    v_cmp_le_f32 vcc, 0, v45
    s_nop 1
    v_cndmask_b32 v97, v93, 1.0, vcc
    v_cndmask_b32 v101, 1.0, v93, vcc
    v_cmp_le_f32 vcc, 0, v46
    s_nop 1
    v_cndmask_b32 v98, v94, 1.0, vcc
    v_cndmask_b32 v102, 1.0, v94, vcc
    v_cmp_le_f32 vcc, 0, v47
    s_nop 1
    v_cndmask_b32 v99, v95, 1.0, vcc
    v_cndmask_b32 v103, 1.0, v95, vcc
    v_fma_f32 v96, v88, 2.0, v96
    v_fma_f32 v97, v89, 2.0, v97
    v_fma_f32 v98, v90, 2.0, v98
    v_fma_f32 v99, v91, 2.0, v99
    v_fma_f32 v100, v100, 2.0, v96
    v_fma_f32 v101, v101, 2.0, v97
    v_fma_f32 v102, v102, 2.0, v98
    v_fma_f32 v103, v103, 2.0, v99
    v_rcp_f32 v100, v100
    v_rcp_f32 v101, v101
    v_rcp_f32 v102, v102
    v_rcp_f32 v103, v103
    v_mul_f32 v96, v96, v44
    v_mul_f32 v97, v97, v45
    v_mul_f32 v98, v98, v46
    v_mul_f32 v99, v99, v47
    v_mul_f32 v44, v96, v100
    v_mul_f32 v45, v97, v101
    v_mul_f32 v46, v98, v102
    v_mul_f32 v47, v99, v103
    v_cvt_pk_bf16_f32 v88, v48, v49
    v_cvt_pk_bf16_f32 v89, v50, v51
    v_lshlrev_b32 v48, 16, v88
    v_and_b32 v49, 0xffff0000, v88
    v_lshlrev_b32 v50, 16, v89
    v_and_b32 v51, 0xffff0000, v89
    v_mul_f32 v88, s24, abs(v48)
    v_mul_f32 v89, s24, abs(v49)
    v_mul_f32 v90, s24, abs(v50)
    v_mul_f32 v91, s24, abs(v51)
    v_exp_f32 v88, v88
    v_exp_f32 v89, v89
    v_exp_f32 v90, v90
    v_exp_f32 v91, v91
    v_mul_f32 v92, v88, v88
    v_mul_f32 v93, v89, v89
    v_mul_f32 v94, v90, v90
    v_mul_f32 v95, v91, v91
    v_cmp_le_f32 vcc, 0, v48
    s_nop 1
    v_cndmask_b32 v96, v92, 1.0, vcc
    v_cndmask_b32 v100, 1.0, v92, vcc
    v_cmp_le_f32 vcc, 0, v49
    s_nop 1
    v_cndmask_b32 v97, v93, 1.0, vcc
    v_cndmask_b32 v101, 1.0, v93, vcc
    v_cmp_le_f32 vcc, 0, v50
    s_nop 1
    v_cndmask_b32 v98, v94, 1.0, vcc
    v_cndmask_b32 v102, 1.0, v94, vcc
    v_cmp_le_f32 vcc, 0, v51
    s_nop 1
    v_cndmask_b32 v99, v95, 1.0, vcc
    v_cndmask_b32 v103, 1.0, v95, vcc
    v_fma_f32 v96, v88, 2.0, v96
    v_fma_f32 v97, v89, 2.0, v97
    v_fma_f32 v98, v90, 2.0, v98
    v_fma_f32 v99, v91, 2.0, v99
    v_fma_f32 v100, v100, 2.0, v96
    v_fma_f32 v101, v101, 2.0, v97
    v_fma_f32 v102, v102, 2.0, v98
    v_fma_f32 v103, v103, 2.0, v99
    v_rcp_f32 v100, v100
    v_rcp_f32 v101, v101
    v_rcp_f32 v102, v102
    v_rcp_f32 v103, v103
    v_mul_f32 v96, v96, v48
    v_mul_f32 v97, v97, v49
    v_mul_f32 v98, v98, v50
    v_mul_f32 v99, v99, v51
    v_mul_f32 v48, v96, v100
    v_mul_f32 v49, v97, v101
    v_mul_f32 v50, v98, v102
    v_mul_f32 v51, v99, v103
    v_cvt_pk_bf16_f32 v88, v52, v53
    v_cvt_pk_bf16_f32 v89, v54, v55
    v_lshlrev_b32 v52, 16, v88
    v_and_b32 v53, 0xffff0000, v88
    v_lshlrev_b32 v54, 16, v89
    v_and_b32 v55, 0xffff0000, v89
    v_mul_f32 v88, s24, abs(v52)
    v_mul_f32 v89, s24, abs(v53)
    v_mul_f32 v90, s24, abs(v54)
    v_mul_f32 v91, s24, abs(v55)
    v_exp_f32 v88, v88
    v_exp_f32 v89, v89
    v_exp_f32 v90, v90
    v_exp_f32 v91, v91
    v_mul_f32 v92, v88, v88
    v_mul_f32 v93, v89, v89
    v_mul_f32 v94, v90, v90
    v_mul_f32 v95, v91, v91
    v_cmp_le_f32 vcc, 0, v52
    s_nop 1
    v_cndmask_b32 v96, v92, 1.0, vcc
    v_cndmask_b32 v100, 1.0, v92, vcc
    v_cmp_le_f32 vcc, 0, v53
    s_nop 1
    v_cndmask_b32 v97, v93, 1.0, vcc
    v_cndmask_b32 v101, 1.0, v93, vcc
    v_cmp_le_f32 vcc, 0, v54
    s_nop 1
    v_cndmask_b32 v98, v94, 1.0, vcc
    v_cndmask_b32 v102, 1.0, v94, vcc
    v_cmp_le_f32 vcc, 0, v55
    s_nop 1
    v_cndmask_b32 v99, v95, 1.0, vcc
    v_cndmask_b32 v103, 1.0, v95, vcc
    v_fma_f32 v96, v88, 2.0, v96
    v_fma_f32 v97, v89, 2.0, v97
    v_fma_f32 v98, v90, 2.0, v98
    v_fma_f32 v99, v91, 2.0, v99
    v_fma_f32 v100, v100, 2.0, v96
    v_fma_f32 v101, v101, 2.0, v97
    v_fma_f32 v102, v102, 2.0, v98
    v_fma_f32 v103, v103, 2.0, v99
    v_rcp_f32 v100, v100
    v_rcp_f32 v101, v101
    v_rcp_f32 v102, v102
    v_rcp_f32 v103, v103
    v_mul_f32 v96, v96, v52
    v_mul_f32 v97, v97, v53
    v_mul_f32 v98, v98, v54
    v_mul_f32 v99, v99, v55
    v_mul_f32 v52, v96, v100
    v_mul_f32 v53, v97, v101
    v_mul_f32 v54, v98, v102
    v_mul_f32 v55, v99, v103
    v_cvt_pk_bf16_f32 v72, v24, v25
    v_cvt_pk_bf16_f32 v73, v26, v27
    v_cvt_pk_bf16_f32 v74, v32, v33
    v_cvt_pk_bf16_f32 v75, v34, v35
    v_cvt_pk_bf16_f32 v76, v28, v29
    v_cvt_pk_bf16_f32 v77, v30, v31
    v_cvt_pk_bf16_f32 v78, v36, v37
    v_cvt_pk_bf16_f32 v79, v38, v39
    v_cvt_pk_bf16_f32 v80, v40, v41
    v_cvt_pk_bf16_f32 v81, v42, v43
    v_cvt_pk_bf16_f32 v82, v48, v49
    v_cvt_pk_bf16_f32 v83, v50, v51
    v_cvt_pk_bf16_f32 v84, v44, v45
    v_cvt_pk_bf16_f32 v85, v46, v47
    v_cvt_pk_bf16_f32 v86, v52, v53
    v_cvt_pk_bf16_f32 v87, v54, v55
    s_mul_i32 s5, s18, 114688
    s_lshl_b32 s6, s3, 13
    s_add_u32 s5, s5, s6
    s_lshl_b32 s6, s4, 11
    s_add_u32 s5, s5, s6
    s_add_u32 s5, s5, 16777216
    s_add_u32 s6, s5, 57344
    buffer_store_dwordx4 v[72:75], v1, s[8:11], s5 offen sc1
    buffer_store_dwordx4 v[80:83], v1, s[8:11], s5 offen offset:1024 sc1
    buffer_store_dwordx4 v[76:79], v1, s[8:11], s6 offen sc1
    buffer_store_dwordx4 v[84:87], v1, s[8:11], s6 offen offset:1024 sc1
    s_add_u32 s17, s17, 1
    s_waitcnt vmcnt(0)
    s_barrier
    s_lshl_b32 s5, s16, 5
    s_lshl_b32 s6, s3, 2
    s_add_u32 s5, s5, s6
    s_add_u32 s24, s5, 3072
    s_cmp_lg_u32 s4, 0
    s_cbranch_scc1 f1_pf_22
    v_mov_b32 v6, s17
    v_mov_b32 v7, 0
    s_mov_b64 exec, 1
    buffer_store_dword v6, v7, s[8:11], s24 offen sc1
    s_mov_b64 exec, -1
f1_pf_22:
    s_add_u32 s18, s18, 2
    s_xor_b32 s20, s20, 32768
    s_cmp_lt_u32 s18, 64
    s_cbranch_scc1 f1_loop
    s_waitcnt vmcnt(0)
mg_exit:
    s_endpgm

.section .rodata,"a"
.p2align 6
.amdhsa_kernel recurrent_scan__memory_aug_recurrent_mem_tr__dense_activation_mish__prompt_kernel
  .amdhsa_next_free_vgpr 512
  .amdhsa_next_free_sgpr 102
  .amdhsa_accum_offset 256
  .amdhsa_group_segment_fixed_size 0
  .amdhsa_kernarg_size 112
  .amdhsa_user_sgpr_count 2
  .amdhsa_user_sgpr_kernarg_segment_ptr 1
  .amdhsa_system_sgpr_workgroup_id_x 1
  .amdhsa_float_denorm_mode_32 3
.end_amdhsa_kernel
.text
```
